```python
import torch

def _softmax(x, axis=-1):
    return torch.softmax(x, dim=axis)

def _gelu(x):
    return torch.nn.functional.gelu(x, approximate='tanh')

def _silu(x):
    return torch.nn.functional.silu(x)

def _sigmoid(x):
    return torch.sigmoid(x)

def _layernorm(x, axis=-1, eps=1e-05):
    m = x.mean(dim=axis, keepdim=True)
    v = x.var(dim=axis, keepdim=True, unbiased=False)
    return (x - m) / torch.sqrt(v + eps)

def _scatter_add(tgt, idx, src, axis=0):
    return tgt.clone().index_add_(axis, idx, src)

def _segment_sum(src, seg, n):
    out = torch.zeros((n,) + src.shape[1:], dtype=src.dtype)
    return out.index_add_(0, seg, src)

def _pad(x, pw):
    flat = tuple((v for pair in reversed(pw) for v in pair))
    return torch.nn.functional.pad(x, flat)
kernel_name = 'parallel_sum__memory_aug_recurrent_mem_tr__dense_activation_silu__prompt'

def setup_inputs():

    _w = lambda a: (lambda t: t.to(torch.bfloat16) if t.is_floating_point() else t)(torch.as_tensor(a))

    def _A_setup():
        B, S, Dm = (1, 2048, 448)
        H, Dh = (16, 256)
        M, seg = (8, 32)
        seg = min(seg, S)
        S = S // seg * seg
        return {'x': _w((lambda *s: torch.randn(*s, dtype=torch.bfloat16) * 0.05)(B, S, Dm)), 'mem0': _w((lambda *s: torch.randn(*s, dtype=torch.bfloat16) * 0.2)(B, M, Dm)), 'Wq': _w((lambda *s: torch.randn(*s, dtype=torch.bfloat16) * 1.6)(Dm, H, Dh) * Dm ** (-0.5)), 'Wk': _w((lambda *s: torch.randn(*s, dtype=torch.bfloat16) * 1.6)(Dm, H, Dh) * Dm ** (-0.5)), 'Wv': _w((lambda *s: torch.randn(*s, dtype=torch.bfloat16) * 0.2)(Dm, H, Dh) * Dm ** (-0.5)), 'Wo': _w((lambda *s: torch.randn(*s, dtype=torch.bfloat16) * 0.2)(H, Dh, Dm) * (H * Dh) ** (-0.5)), 'seg_len': seg}
    _A_in = _A_setup()

    def _B_setup():
        B, S, D, F = (1, 2048, 448, 1792)
        return {'x': _w((lambda *s: torch.randn(*s, dtype=torch.bfloat16) * 0.05)(B, S, D)), 'w1': _w((lambda *s: torch.randn(*s, dtype=torch.bfloat16) * 0.8)(D, F) * D ** (-0.5)), 'w2': _w((lambda *s: torch.randn(*s, dtype=torch.bfloat16) * 0.1)(F, D) * F ** (-0.5))}
    _B_in = _B_setup()
    return {'A_x': _A_in['x'], 'A_mem0': _A_in['mem0'], 'A_Wq': _A_in['Wq'], 'A_Wk': _A_in['Wk'], 'A_Wv': _A_in['Wv'], 'A_Wo': _A_in['Wo'], 'A_seg_len': _A_in['seg_len'], 'B_x': _B_in['x'], 'B_w1': _B_in['w1'], 'B_w2': _B_in['w2']}

def reference(A_x, A_mem0, A_Wq, A_Wk, A_Wv, A_Wo, A_seg_len, B_x, B_w1, B_w2):

    def _A_ref(x, mem0, Wq, Wk, Wv, Wo, seg_len):
        B, S, Dm = x.shape
        H, Dh = (Wq.shape[1], Wq.shape[2])
        M = mem0.shape[1]
        scale = Dh ** (-0.5)
        n_seg = S // seg_len
        L = M + seg_len
        idx = torch.arange(L)
        mask = (idx[:, None] < M) | (idx[:, None] >= idx[None, :])
        mem = mem0
        outs = []
        for s in range(n_seg):
            xs = x[:, s * seg_len:(s + 1) * seg_len, :].clone()
            h = torch.concatenate([mem, xs], axis=1)
            q = torch.einsum('btd,dhe->bhte', h, Wq)
            k = torch.einsum('btd,dhe->bhte', h, Wk)
            v = torch.einsum('btd,dhe->bhte', h, Wv)
            scores = torch.einsum('bhqe,bhke->bhqk', q, k) * scale
            scores = torch.where(mask[None, None], scores, -1000000000.0)
            p = _softmax(scores, axis=-1)
            o = torch.einsum('bhqk,bhke->bhqe', p, v)
            o = torch.einsum('bhte,hed->btd', o, Wo)
            mem = o[:, :M, :].clone()
            outs.append(o[:, M:, :])
        return torch.concatenate(outs, axis=1)

    def _B_ref(x, w1, w2):
        h = torch.einsum('bsd,df->bsf', x, w1)
        h = _silu(h)
        out = torch.einsum('bsf,fd->bsd', h, w2)
        return out
    x = A_x
    xn = _layernorm(x, axis=-1)
    return x + _A_ref(xn, A_mem0, A_Wq, A_Wk, A_Wv, A_Wo, A_seg_len) + _B_ref(xn, B_w1, B_w2)
```

```asm
; @launch kernel=main_kernel grid=(256,1,1) block=(256,1,1) lds=143424
.amdgcn_target "amdgcn-amd-amdhsa--gfx950"
.text
.globl main_kernel
.p2align 8
.type main_kernel,@function
main_kernel:
    s_cmp_ge_u32 s2, 256
    s_cbranch_scc0 main_go
    s_endpgm
main_go:
    s_load_dwordx16 s[64:79], s[0:1], 0
    s_load_dwordx4 s[80:83], s[0:1], 64
    s_load_dwordx4 s[84:87], s[0:1], 80
    s_load_dwordx2 s[88:89], s[0:1], 96
    v_lshrrev_b32 v1, 6, v0
    v_and_b32 v0, 63, v0
    v_readfirstlane_b32 s16, v1
    s_getreg_b32 s26, hwreg(HW_REG_XCC_ID)
    s_and_b32 s26, s26, 7
    s_mov_b32 s18, 262144
    v_lshrrev_b32 v3, 4, v0
    v_and_b32 v4, 15, v0
    s_and_b32 s24, s2, 7
    s_lshl_b32 s24, s24, 2
    s_lshr_b32 s25, s2, 3
    s_and_b32 s25, s25, 3
    s_add_u32 s24, s24, s25
    s_lshr_b32 s25, s2, 5
    s_and_b32 s20, s25, 1
    s_lshr_b32 s27, s25, 1
    s_and_b32 s28, s24, 15
    s_lshr_b32 s29, s24, 4
    v_lshrrev_b32 v18, 3, v0
    v_and_b32 v19, 7, v0
    v_lshrrev_b32 v20, 2, v18
    v_and_b32 v21, 3, v18
    v_lshl_add_u32 v20, v20, 3, v21
    v_lshrrev_b32 v21, 1, v18
    v_xor_b32 v21, v21, v19
    v_lshlrev_b32 v20, 13, v20
    v_lshl_add_u32 v5, v21, 4, v20
    v_xor_b32 v6, 64, v5
    v_add_u32 v6, 0x20000, v6
    v_lshrrev_b32 v20, 1, v4
    v_xor_b32 v20, v20, v3
    v_lshlrev_b32 v20, 4, v20
    v_lshl_add_u32 v14, v4, 7, v20
    v_xor_b32 v15, 64, v14
    s_mul_i32 s35, s16, 24576
    s_add_u32 s35, s35, 57344
    v_add_u32 v12, s35, v14
    v_add_u32 v13, s35, v15
    v_lshrrev_b32 v20, 2, v4
    v_lshl_add_u32 v20, v3, 3, v20
    v_mul_u32_u24 v20, 224, v20
    v_and_b32 v21, 3, v4
    v_lshl_add_u32 v16, v21, 3, v20
    v_lshlrev_b32 v17, 4, v0
    s_add_u32 s30, s16, 0
    s_lshl_b32 s56, s30, 10
    s_lshl_b32 s31, s30, 6
    v_add_u32 v20, s31, v0
    v_mul_u32_u24 v21, 4682, v20
    v_lshrrev_b32 v21, 16, v21
    v_mul_u32_u24 v22, 14, v21
    v_sub_u32 v20, v20, v22
    v_mul_u32_u24 v21, 896, v21
    v_lshl_add_u32 v8, v20, 4, v21
    s_lshr_b32 s30, s30, 1
    s_mul_i32 s31, s27, 7
    s_add_u32 s30, s30, s31
    s_lshr_b32 s31, s30, 1
    s_lshl_b32 s31, s31, 3
    s_and_b32 s30, s30, 1
    s_add_u32 s30, s30, s31
    s_lshl_b32 s52, s30, 15
    s_add_u32 s30, s16, 4
    s_lshl_b32 s57, s30, 10
    s_lshl_b32 s31, s30, 6
    v_add_u32 v20, s31, v0
    v_mul_u32_u24 v21, 4682, v20
    v_lshrrev_b32 v21, 16, v21
    v_mul_u32_u24 v22, 14, v21
    v_sub_u32 v20, v20, v22
    v_mul_u32_u24 v21, 896, v21
    v_lshl_add_u32 v9, v20, 4, v21
    s_lshr_b32 s30, s30, 1
    s_mul_i32 s31, s27, 7
    s_add_u32 s30, s30, s31
    s_lshr_b32 s31, s30, 1
    s_lshl_b32 s31, s31, 3
    s_and_b32 s30, s30, 1
    s_add_u32 s30, s30, s31
    s_lshl_b32 s53, s30, 15
    s_add_u32 s30, s16, 8
    s_lshl_b32 s58, s30, 10
    s_lshl_b32 s31, s30, 6
    v_add_u32 v20, s31, v0
    v_mul_u32_u24 v21, 4682, v20
    v_lshrrev_b32 v21, 16, v21
    v_mul_u32_u24 v22, 14, v21
    v_sub_u32 v20, v20, v22
    v_mul_u32_u24 v21, 896, v21
    v_lshl_add_u32 v10, v20, 4, v21
    s_lshr_b32 s30, s30, 1
    s_mul_i32 s31, s27, 7
    s_add_u32 s30, s30, s31
    s_lshr_b32 s31, s30, 1
    s_lshl_b32 s31, s31, 3
    s_and_b32 s30, s30, 1
    s_add_u32 s30, s30, s31
    s_lshl_b32 s54, s30, 15
    s_add_u32 s30, s16, 12
    s_sub_u32 s31, s30, 2
    s_cmp_ge_u32 s30, 14
    s_cselect_b32 s30, s31, s30
    s_lshl_b32 s59, s30, 10
    s_lshl_b32 s31, s30, 6
    v_add_u32 v20, s31, v0
    v_mul_u32_u24 v21, 4682, v20
    v_lshrrev_b32 v21, 16, v21
    v_mul_u32_u24 v22, 14, v21
    v_sub_u32 v20, v20, v22
    v_mul_u32_u24 v21, 896, v21
    v_lshl_add_u32 v11, v20, 4, v21
    s_lshr_b32 s30, s30, 1
    s_mul_i32 s31, s27, 7
    s_add_u32 s30, s30, s31
    s_lshr_b32 s31, s30, 1
    s_lshl_b32 s31, s31, 3
    s_and_b32 s30, s30, 1
    s_add_u32 s30, s30, s31
    s_lshl_b32 s55, s30, 15
    s_lshl_b32 s36, s28, 9
    s_mul_i32 s37, s20, 7
    s_lshl_b32 s30, s16, 1
    s_add_u32 s37, s37, s30
    s_lshl_b32 s38, s37, 18
    s_add_u32 s38, s38, s36
    s_cmp_eq_u32 s29, 0
    s_cbranch_scc0 p0_colB
    s_add_u32 s52, s52, s36
    s_add_u32 s53, s53, s36
    s_add_u32 s54, s54, s36
    s_add_u32 s55, s55, s36
    s_bitcmp1_b32 s16, 0
    s_cselect_b64 vcc, -1, 0
    s_mov_b32 s39, 128
    v_cndmask_b32 v8, v5, v6, vcc
    v_mov_b32 v9, v8
    v_mov_b32 v10, v8
    v_mov_b32 v11, v8
    s_branch p0_colok
p0_colB:
    s_mul_i32 s52, s28, 229376
    s_mul_i32 s30, s27, 224
    s_add_u32 s52, s52, s30
    s_mov_b32 s53, s52
    s_mov_b32 s54, s52
    s_mov_b32 s55, s52
    s_mov_b32 s39, 57344
p0_colok:
    s_waitcnt lgkmcnt(0)
    s_mov_b32 s4, s88
    s_and_b32 s5, s89, 0xffff
    s_mov_b32 s6, 268435456
    s_mov_b32 s7, 0x20000
    s_mov_b32 s8, s64
    s_and_b32 s9, s65, 0xffff
    s_mov_b32 s10, 1835008
    s_mov_b32 s11, 0x20000
    s_mov_b32 s12, s84
    s_and_b32 s13, s85, 0xffff
    s_mov_b32 s14, 1835008
    s_mov_b32 s15, 0x20000
    s_mov_b32 s48, s86
    s_and_b32 s49, s87, 0xffff
    s_mov_b32 s50, 256
    s_mov_b32 s51, 0x20000
    s_cmp_eq_u32 s29, 0
    s_cselect_b32 s30, s68, s72
    s_cselect_b32 s31, s69, s73
    s_cselect_b32 s32, s70, s74
    s_cselect_b32 s33, s71, s75
    s_mov_b32 s40, s30
    s_and_b32 s41, s31, 0xffff
    s_mov_b32 s42, 3670016
    s_mov_b32 s43, 0x20000
    s_mov_b32 s44, s32
    s_and_b32 s45, s33, 0xffff
    s_mov_b32 s46, 3670016
    s_mov_b32 s47, 0x20000
    v_or_b32 v2, s16, v0
    v_cmp_eq_u32 vcc, 0, v2
    v_bfrev_b32 v2, 1
    s_lshl_b32 s30, s26, 5
    v_mov_b32 v1, s30
    v_cndmask_b32 v2, v2, v1, vcc
    v_mov_b32 v1, 1
    v_mov_b32 v248, 0
    v_mov_b32 v249, 0
    v_mov_b32 v250, 0
    v_mov_b32 v251, 0
    s_lshl_b32 s30, s2, 2
    s_add_u32 s30, s30, s16
    s_lshl_b32 s91, s30, 10
    s_add_u32 s91, s91, 69812224
    s_cmp_lt_u32 s30, 64
    s_cselect_b32 s91, s91, 0x7ff00000
    v_mov_b32 v244, -1
    v_mov_b32 v245, -1
    v_mov_b32 v246, -1
    v_mov_b32 v247, -1
    s_mul_i32 s90, s2, 3
    s_add_u32 s90, s90, s16
    s_lshl_b32 s90, s90, 11
    s_add_u32 s90, s90, 65615872
    s_cmp_eq_u32 s16, 3
    s_cbranch_scc1 p0_w3
    s_add_u32 m0, s56, 0
    s_nop 0
    buffer_load_dwordx4 v8, s[44:47], s52 offen lds
    s_add_u32 s52, s52, s39
    s_add_u32 m0, s57, 0
    s_nop 0
    buffer_load_dwordx4 v9, s[44:47], s53 offen lds
    s_add_u32 s53, s53, s39
    s_add_u32 m0, s58, 0
    s_nop 0
    buffer_load_dwordx4 v10, s[44:47], s54 offen lds
    s_add_u32 s54, s54, s39
    s_add_u32 m0, s59, 0
    s_nop 0
    buffer_load_dwordx4 v11, s[44:47], s55 offen lds
    s_add_u32 s55, s55, s39
    s_add_u32 m0, s35, 0
    s_add_u32 s30, s38, 0
    buffer_load_dwordx4 v5, s[40:43], s30 offen lds
    s_add_u32 m0, s35, 1024
    s_nop 0
    buffer_load_dwordx4 v6, s[40:43], s30 offen lds
    s_add_u32 m0, s35, 2048
    s_add_u32 s30, s38, 32768
    buffer_load_dwordx4 v5, s[40:43], s30 offen lds
    s_add_u32 m0, s35, 3072
    s_nop 0
    buffer_load_dwordx4 v6, s[40:43], s30 offen lds
    s_add_u32 m0, s35, 4096
    s_add_u32 s30, s38, 262144
    buffer_load_dwordx4 v5, s[40:43], s30 offen lds
    s_add_u32 m0, s35, 5120
    s_nop 0
    buffer_load_dwordx4 v6, s[40:43], s30 offen lds
    s_add_u32 m0, s35, 6144
    s_add_u32 s30, s38, 294912
    buffer_load_dwordx4 v5, s[40:43], s30 offen lds
    s_add_u32 m0, s35, 7168
    s_nop 0
    buffer_load_dwordx4 v6, s[40:43], s30 offen lds
    s_add_u32 m0, s56, 14336
    s_nop 0
    buffer_load_dwordx4 v8, s[44:47], s52 offen lds
    s_add_u32 s52, s52, s39
    s_add_u32 m0, s57, 14336
    s_nop 0
    buffer_load_dwordx4 v9, s[44:47], s53 offen lds
    s_add_u32 s53, s53, s39
    s_add_u32 m0, s58, 14336
    s_nop 0
    buffer_load_dwordx4 v10, s[44:47], s54 offen lds
    s_add_u32 s54, s54, s39
    s_add_u32 m0, s59, 14336
    s_nop 0
    buffer_load_dwordx4 v11, s[44:47], s55 offen lds
    s_add_u32 s55, s55, s39
    s_add_u32 m0, s35, 8192
    s_add_u32 s30, s38, 128
    buffer_load_dwordx4 v5, s[40:43], s30 offen lds
    s_add_u32 m0, s35, 9216
    s_nop 0
    buffer_load_dwordx4 v6, s[40:43], s30 offen lds
    s_add_u32 m0, s35, 10240
    s_add_u32 s30, s38, 32896
    buffer_load_dwordx4 v5, s[40:43], s30 offen lds
    s_add_u32 m0, s35, 11264
    s_nop 0
    buffer_load_dwordx4 v6, s[40:43], s30 offen lds
    s_add_u32 m0, s35, 12288
    s_add_u32 s30, s38, 262272
    buffer_load_dwordx4 v5, s[40:43], s30 offen lds
    s_add_u32 m0, s35, 13312
    s_nop 0
    buffer_load_dwordx4 v6, s[40:43], s30 offen lds
    s_add_u32 m0, s35, 14336
    s_add_u32 s30, s38, 295040
    buffer_load_dwordx4 v5, s[40:43], s30 offen lds
    s_add_u32 m0, s35, 15360
    s_nop 0
    buffer_load_dwordx4 v6, s[40:43], s30 offen lds
    buffer_store_dwordx4 v[248:251], v17, s[4:7], s91 offen sc1
    buffer_store_dwordx4 v[244:247], v17, s[4:7], s90 offen offset:0 sc1
    buffer_store_dwordx4 v[244:247], v17, s[4:7], s90 offen offset:1024 sc1
    s_cmp_eq_u32 s29, 0
    s_cbranch_scc0 p0_gB
    s_waitcnt vmcnt(15)
    s_barrier
    ds_read_b128 v[32:35], v12 offset:0
    ds_read_b128 v[36:39], v12 offset:2048
    ds_read_b128 v[40:43], v12 offset:4096
    ds_read_b128 v[44:47], v12 offset:6144
    ds_read_b128 v[48:51], v14 offset:0
    ds_read_b128 v[52:55], v14 offset:2048
    ds_read_b128 v[56:59], v14 offset:4096
    ds_read_b128 v[176:179], v13 offset:0
    ds_read_b128 v[180:183], v13 offset:2048
    ds_read_b128 v[184:187], v13 offset:4096
    ds_read_b128 v[188:191], v13 offset:6144
    ds_read_b128 v[60:63], v14 offset:6144
    s_waitcnt lgkmcnt(7)
    v_mfma_f32_16x16x32_bf16 v[64:67], v[32:35], v[48:51], 0
    s_add_u32 m0, s56, 28672
    s_nop 0
    buffer_load_dwordx4 v8, s[44:47], s52 offen lds
    s_add_u32 s52, s52, s39
    v_mfma_f32_16x16x32_bf16 v[68:71], v[36:39], v[48:51], 0
    v_mfma_f32_16x16x32_bf16 v[72:75], v[40:43], v[48:51], 0
    s_add_u32 m0, s57, 28672
    s_nop 0
    buffer_load_dwordx4 v9, s[44:47], s53 offen lds
    s_add_u32 s53, s53, s39
    v_mfma_f32_16x16x32_bf16 v[76:79], v[44:47], v[48:51], 0
    ds_read_b128 v[48:51], v14 offset:8192
    s_waitcnt lgkmcnt(7)
    v_mfma_f32_16x16x32_bf16 v[80:83], v[32:35], v[52:55], 0
    s_add_u32 m0, s58, 28672
    s_nop 0
    buffer_load_dwordx4 v10, s[44:47], s54 offen lds
    s_add_u32 s54, s54, s39
    v_mfma_f32_16x16x32_bf16 v[84:87], v[36:39], v[52:55], 0
    v_mfma_f32_16x16x32_bf16 v[88:91], v[40:43], v[52:55], 0
    s_add_u32 m0, s59, 28672
    s_nop 0
    buffer_load_dwordx4 v11, s[44:47], s55 offen lds
    s_add_u32 s55, s55, s39
    v_mfma_f32_16x16x32_bf16 v[92:95], v[44:47], v[52:55], 0
    ds_read_b128 v[52:55], v14 offset:10240
    s_waitcnt lgkmcnt(7)
    v_mfma_f32_16x16x32_bf16 v[96:99], v[32:35], v[56:59], 0
    s_add_u32 m0, s35, 16384
    s_add_u32 s30, s38, 256
    buffer_load_dwordx4 v5, s[40:43], s30 offen lds
    v_mfma_f32_16x16x32_bf16 v[100:103], v[36:39], v[56:59], 0
    v_mfma_f32_16x16x32_bf16 v[104:107], v[40:43], v[56:59], 0
    s_add_u32 m0, s35, 17408
    s_nop 0
    buffer_load_dwordx4 v6, s[40:43], s30 offen lds
    v_mfma_f32_16x16x32_bf16 v[108:111], v[44:47], v[56:59], 0
    ds_read_b128 v[56:59], v14 offset:12288
    s_waitcnt lgkmcnt(3)
    v_mfma_f32_16x16x32_bf16 v[112:115], v[32:35], v[60:63], 0
    s_add_u32 m0, s35, 18432
    s_add_u32 s30, s38, 33024
    buffer_load_dwordx4 v5, s[40:43], s30 offen lds
    v_mfma_f32_16x16x32_bf16 v[116:119], v[36:39], v[60:63], 0
    v_mfma_f32_16x16x32_bf16 v[120:123], v[40:43], v[60:63], 0
    s_add_u32 m0, s35, 19456
    s_nop 0
    buffer_load_dwordx4 v6, s[40:43], s30 offen lds
    v_mfma_f32_16x16x32_bf16 v[124:127], v[44:47], v[60:63], 0
    ds_read_b128 v[60:63], v15 offset:0
    s_waitcnt lgkmcnt(3)
    v_mfma_f32_16x16x32_bf16 v[128:131], v[32:35], v[48:51], 0
    s_add_u32 m0, s35, 20480
    s_add_u32 s30, s38, 262400
    buffer_load_dwordx4 v5, s[40:43], s30 offen lds
    v_mfma_f32_16x16x32_bf16 v[132:135], v[36:39], v[48:51], 0
    v_mfma_f32_16x16x32_bf16 v[136:139], v[40:43], v[48:51], 0
    s_add_u32 m0, s35, 21504
    s_nop 0
    buffer_load_dwordx4 v6, s[40:43], s30 offen lds
    v_mfma_f32_16x16x32_bf16 v[140:143], v[44:47], v[48:51], 0
    ds_read_b128 v[48:51], v15 offset:2048
    s_waitcnt lgkmcnt(3)
    v_mfma_f32_16x16x32_bf16 v[144:147], v[32:35], v[52:55], 0
    s_add_u32 m0, s35, 22528
    s_add_u32 s30, s38, 295168
    buffer_load_dwordx4 v5, s[40:43], s30 offen lds
    v_mfma_f32_16x16x32_bf16 v[148:151], v[36:39], v[52:55], 0
    v_mfma_f32_16x16x32_bf16 v[152:155], v[40:43], v[52:55], 0
    s_add_u32 m0, s35, 23552
    s_nop 0
    buffer_load_dwordx4 v6, s[40:43], s30 offen lds
    v_mfma_f32_16x16x32_bf16 v[156:159], v[44:47], v[52:55], 0
    ds_read_b128 v[52:55], v15 offset:4096
    s_waitcnt lgkmcnt(3)
    v_mfma_f32_16x16x32_bf16 v[160:163], v[32:35], v[56:59], 0
    v_mfma_f32_16x16x32_bf16 v[164:167], v[36:39], v[56:59], 0
    v_mfma_f32_16x16x32_bf16 v[168:171], v[40:43], v[56:59], 0
    v_mfma_f32_16x16x32_bf16 v[172:175], v[44:47], v[56:59], 0
    ds_read_b128 v[56:59], v15 offset:6144
    s_waitcnt lgkmcnt(3)
    v_mfma_f32_16x16x32_bf16 v[64:67], v[176:179], v[60:63], v[64:67]
    v_mfma_f32_16x16x32_bf16 v[68:71], v[180:183], v[60:63], v[68:71]
    v_mfma_f32_16x16x32_bf16 v[72:75], v[184:187], v[60:63], v[72:75]
    v_mfma_f32_16x16x32_bf16 v[76:79], v[188:191], v[60:63], v[76:79]
    ds_read_b128 v[60:63], v15 offset:8192
    s_waitcnt lgkmcnt(3)
    v_mfma_f32_16x16x32_bf16 v[80:83], v[176:179], v[48:51], v[80:83]
    v_mfma_f32_16x16x32_bf16 v[84:87], v[180:183], v[48:51], v[84:87]
    v_mfma_f32_16x16x32_bf16 v[88:91], v[184:187], v[48:51], v[88:91]
    v_mfma_f32_16x16x32_bf16 v[92:95], v[188:191], v[48:51], v[92:95]
    ds_read_b128 v[48:51], v15 offset:10240
    s_waitcnt lgkmcnt(3)
    v_mfma_f32_16x16x32_bf16 v[96:99], v[176:179], v[52:55], v[96:99]
    v_mfma_f32_16x16x32_bf16 v[100:103], v[180:183], v[52:55], v[100:103]
    v_mfma_f32_16x16x32_bf16 v[104:107], v[184:187], v[52:55], v[104:107]
    v_mfma_f32_16x16x32_bf16 v[108:111], v[188:191], v[52:55], v[108:111]
    ds_read_b128 v[52:55], v15 offset:12288
    s_waitcnt lgkmcnt(3)
    v_mfma_f32_16x16x32_bf16 v[112:115], v[176:179], v[56:59], v[112:115]
    v_mfma_f32_16x16x32_bf16 v[116:119], v[180:183], v[56:59], v[116:119]
    v_mfma_f32_16x16x32_bf16 v[120:123], v[184:187], v[56:59], v[120:123]
    v_mfma_f32_16x16x32_bf16 v[124:127], v[188:191], v[56:59], v[124:127]
    s_waitcnt lgkmcnt(2)
    v_mfma_f32_16x16x32_bf16 v[128:131], v[176:179], v[60:63], v[128:131]
    v_mfma_f32_16x16x32_bf16 v[132:135], v[180:183], v[60:63], v[132:135]
    v_mfma_f32_16x16x32_bf16 v[136:139], v[184:187], v[60:63], v[136:139]
    v_mfma_f32_16x16x32_bf16 v[140:143], v[188:191], v[60:63], v[140:143]
    s_waitcnt lgkmcnt(1)
    v_mfma_f32_16x16x32_bf16 v[144:147], v[176:179], v[48:51], v[144:147]
    v_mfma_f32_16x16x32_bf16 v[148:151], v[180:183], v[48:51], v[148:151]
    v_mfma_f32_16x16x32_bf16 v[152:155], v[184:187], v[48:51], v[152:155]
    v_mfma_f32_16x16x32_bf16 v[156:159], v[188:191], v[48:51], v[156:159]
    s_waitcnt lgkmcnt(0)
    v_mfma_f32_16x16x32_bf16 v[160:163], v[176:179], v[52:55], v[160:163]
    v_mfma_f32_16x16x32_bf16 v[164:167], v[180:183], v[52:55], v[164:167]
    v_mfma_f32_16x16x32_bf16 v[168:171], v[184:187], v[52:55], v[168:171]
    v_mfma_f32_16x16x32_bf16 v[172:175], v[188:191], v[52:55], v[172:175]
    s_waitcnt vmcnt(12)
    s_barrier
    buffer_atomic_add v1, v2, s[48:51], 0 offen sc0 sc1
    ds_read_b128 v[32:35], v12 offset:8192
    ds_read_b128 v[36:39], v12 offset:10240
    ds_read_b128 v[40:43], v12 offset:12288
    ds_read_b128 v[44:47], v12 offset:14336
    ds_read_b128 v[48:51], v14 offset:14336
    ds_read_b128 v[52:55], v14 offset:16384
    ds_read_b128 v[56:59], v14 offset:18432
    ds_read_b128 v[176:179], v13 offset:8192
    ds_read_b128 v[180:183], v13 offset:10240
    ds_read_b128 v[184:187], v13 offset:12288
    ds_read_b128 v[188:191], v13 offset:14336
    ds_read_b128 v[60:63], v14 offset:20480
    s_waitcnt lgkmcnt(7)
    v_mfma_f32_16x16x32_bf16 v[64:67], v[32:35], v[48:51], v[64:67]
    s_add_u32 m0, s56, 43008
    s_nop 0
    buffer_load_dwordx4 v8, s[44:47], s52 offen lds
    s_add_u32 s52, s52, s39
    v_mfma_f32_16x16x32_bf16 v[68:71], v[36:39], v[48:51], v[68:71]
    v_mfma_f32_16x16x32_bf16 v[72:75], v[40:43], v[48:51], v[72:75]
    s_add_u32 m0, s57, 43008
    s_nop 0
    buffer_load_dwordx4 v9, s[44:47], s53 offen lds
    s_add_u32 s53, s53, s39
    v_mfma_f32_16x16x32_bf16 v[76:79], v[44:47], v[48:51], v[76:79]
    ds_read_b128 v[48:51], v14 offset:22528
    s_waitcnt lgkmcnt(7)
    v_mfma_f32_16x16x32_bf16 v[80:83], v[32:35], v[52:55], v[80:83]
    s_add_u32 m0, s58, 43008
    s_nop 0
    buffer_load_dwordx4 v10, s[44:47], s54 offen lds
    s_add_u32 s54, s54, s39
    v_mfma_f32_16x16x32_bf16 v[84:87], v[36:39], v[52:55], v[84:87]
    v_mfma_f32_16x16x32_bf16 v[88:91], v[40:43], v[52:55], v[88:91]
    s_add_u32 m0, s59, 43008
    s_nop 0
    buffer_load_dwordx4 v11, s[44:47], s55 offen lds
    s_add_u32 s55, s55, s39
    v_mfma_f32_16x16x32_bf16 v[92:95], v[44:47], v[52:55], v[92:95]
    ds_read_b128 v[52:55], v14 offset:24576
    s_waitcnt lgkmcnt(7)
    v_mfma_f32_16x16x32_bf16 v[96:99], v[32:35], v[56:59], v[96:99]
    s_add_u32 m0, s35, 0
    s_add_u32 s30, s38, 384
    buffer_load_dwordx4 v5, s[40:43], s30 offen lds
    v_mfma_f32_16x16x32_bf16 v[100:103], v[36:39], v[56:59], v[100:103]
    v_mfma_f32_16x16x32_bf16 v[104:107], v[40:43], v[56:59], v[104:107]
    s_add_u32 m0, s35, 1024
    s_nop 0
    buffer_load_dwordx4 v6, s[40:43], s30 offen lds
    v_mfma_f32_16x16x32_bf16 v[108:111], v[44:47], v[56:59], v[108:111]
    ds_read_b128 v[56:59], v14 offset:26624
    s_waitcnt lgkmcnt(3)
    v_mfma_f32_16x16x32_bf16 v[112:115], v[32:35], v[60:63], v[112:115]
    s_add_u32 m0, s35, 2048
    s_add_u32 s30, s38, 33152
    buffer_load_dwordx4 v5, s[40:43], s30 offen lds
    v_mfma_f32_16x16x32_bf16 v[116:119], v[36:39], v[60:63], v[116:119]
    v_mfma_f32_16x16x32_bf16 v[120:123], v[40:43], v[60:63], v[120:123]
    s_add_u32 m0, s35, 3072
    s_nop 0
    buffer_load_dwordx4 v6, s[40:43], s30 offen lds
    v_mfma_f32_16x16x32_bf16 v[124:127], v[44:47], v[60:63], v[124:127]
    ds_read_b128 v[60:63], v15 offset:14336
    s_waitcnt lgkmcnt(3)
    v_mfma_f32_16x16x32_bf16 v[128:131], v[32:35], v[48:51], v[128:131]
    s_add_u32 m0, s35, 4096
    s_add_u32 s30, s38, 262528
    buffer_load_dwordx4 v5, s[40:43], s30 offen lds
    v_mfma_f32_16x16x32_bf16 v[132:135], v[36:39], v[48:51], v[132:135]
    v_mfma_f32_16x16x32_bf16 v[136:139], v[40:43], v[48:51], v[136:139]
    s_add_u32 m0, s35, 5120
    s_nop 0
    buffer_load_dwordx4 v6, s[40:43], s30 offen lds
    v_mfma_f32_16x16x32_bf16 v[140:143], v[44:47], v[48:51], v[140:143]
    ds_read_b128 v[48:51], v15 offset:16384
    s_waitcnt lgkmcnt(3)
    v_mfma_f32_16x16x32_bf16 v[144:147], v[32:35], v[52:55], v[144:147]
    s_add_u32 m0, s35, 6144
    s_add_u32 s30, s38, 295296
    buffer_load_dwordx4 v5, s[40:43], s30 offen lds
    v_mfma_f32_16x16x32_bf16 v[148:151], v[36:39], v[52:55], v[148:151]
    v_mfma_f32_16x16x32_bf16 v[152:155], v[40:43], v[52:55], v[152:155]
    s_add_u32 m0, s35, 7168
    s_nop 0
    buffer_load_dwordx4 v6, s[40:43], s30 offen lds
    v_mfma_f32_16x16x32_bf16 v[156:159], v[44:47], v[52:55], v[156:159]
    ds_read_b128 v[52:55], v15 offset:18432
    s_waitcnt lgkmcnt(3)
    v_mfma_f32_16x16x32_bf16 v[160:163], v[32:35], v[56:59], v[160:163]
    v_mfma_f32_16x16x32_bf16 v[164:167], v[36:39], v[56:59], v[164:167]
    v_mfma_f32_16x16x32_bf16 v[168:171], v[40:43], v[56:59], v[168:171]
    v_mfma_f32_16x16x32_bf16 v[172:175], v[44:47], v[56:59], v[172:175]
    ds_read_b128 v[56:59], v15 offset:20480
    s_waitcnt lgkmcnt(3)
    v_mfma_f32_16x16x32_bf16 v[64:67], v[176:179], v[60:63], v[64:67]
    v_mfma_f32_16x16x32_bf16 v[68:71], v[180:183], v[60:63], v[68:71]
    v_mfma_f32_16x16x32_bf16 v[72:75], v[184:187], v[60:63], v[72:75]
    v_mfma_f32_16x16x32_bf16 v[76:79], v[188:191], v[60:63], v[76:79]
    ds_read_b128 v[60:63], v15 offset:22528
    s_waitcnt lgkmcnt(3)
    v_mfma_f32_16x16x32_bf16 v[80:83], v[176:179], v[48:51], v[80:83]
    v_mfma_f32_16x16x32_bf16 v[84:87], v[180:183], v[48:51], v[84:87]
    v_mfma_f32_16x16x32_bf16 v[88:91], v[184:187], v[48:51], v[88:91]
    v_mfma_f32_16x16x32_bf16 v[92:95], v[188:191], v[48:51], v[92:95]
    ds_read_b128 v[48:51], v15 offset:24576
    s_waitcnt lgkmcnt(3)
    v_mfma_f32_16x16x32_bf16 v[96:99], v[176:179], v[52:55], v[96:99]
    v_mfma_f32_16x16x32_bf16 v[100:103], v[180:183], v[52:55], v[100:103]
    v_mfma_f32_16x16x32_bf16 v[104:107], v[184:187], v[52:55], v[104:107]
    v_mfma_f32_16x16x32_bf16 v[108:111], v[188:191], v[52:55], v[108:111]
    ds_read_b128 v[52:55], v15 offset:26624
    s_waitcnt lgkmcnt(3)
    v_mfma_f32_16x16x32_bf16 v[112:115], v[176:179], v[56:59], v[112:115]
    v_mfma_f32_16x16x32_bf16 v[116:119], v[180:183], v[56:59], v[116:119]
    v_mfma_f32_16x16x32_bf16 v[120:123], v[184:187], v[56:59], v[120:123]
    v_mfma_f32_16x16x32_bf16 v[124:127], v[188:191], v[56:59], v[124:127]
    s_waitcnt lgkmcnt(2)
    v_mfma_f32_16x16x32_bf16 v[128:131], v[176:179], v[60:63], v[128:131]
    v_mfma_f32_16x16x32_bf16 v[132:135], v[180:183], v[60:63], v[132:135]
    v_mfma_f32_16x16x32_bf16 v[136:139], v[184:187], v[60:63], v[136:139]
    v_mfma_f32_16x16x32_bf16 v[140:143], v[188:191], v[60:63], v[140:143]
    s_waitcnt lgkmcnt(1)
    v_mfma_f32_16x16x32_bf16 v[144:147], v[176:179], v[48:51], v[144:147]
    v_mfma_f32_16x16x32_bf16 v[148:151], v[180:183], v[48:51], v[148:151]
    v_mfma_f32_16x16x32_bf16 v[152:155], v[184:187], v[48:51], v[152:155]
    v_mfma_f32_16x16x32_bf16 v[156:159], v[188:191], v[48:51], v[156:159]
    s_waitcnt lgkmcnt(0)
    v_mfma_f32_16x16x32_bf16 v[160:163], v[176:179], v[52:55], v[160:163]
    v_mfma_f32_16x16x32_bf16 v[164:167], v[180:183], v[52:55], v[164:167]
    v_mfma_f32_16x16x32_bf16 v[168:171], v[184:187], v[52:55], v[168:171]
    v_mfma_f32_16x16x32_bf16 v[172:175], v[188:191], v[52:55], v[172:175]
    s_waitcnt vmcnt(13)
    s_barrier
    ds_read_b128 v[32:35], v12 offset:16384
    ds_read_b128 v[36:39], v12 offset:18432
    ds_read_b128 v[40:43], v12 offset:20480
    ds_read_b128 v[44:47], v12 offset:22528
    ds_read_b128 v[48:51], v14 offset:28672
    ds_read_b128 v[52:55], v14 offset:30720
    ds_read_b128 v[56:59], v14 offset:32768
    ds_read_b128 v[176:179], v13 offset:16384
    ds_read_b128 v[180:183], v13 offset:18432
    ds_read_b128 v[184:187], v13 offset:20480
    ds_read_b128 v[188:191], v13 offset:22528
    ds_read_b128 v[60:63], v14 offset:34816
    s_waitcnt lgkmcnt(7)
    v_mfma_f32_16x16x32_bf16 v[64:67], v[32:35], v[48:51], v[64:67]
    v_mfma_f32_16x16x32_bf16 v[68:71], v[36:39], v[48:51], v[68:71]
    v_mfma_f32_16x16x32_bf16 v[72:75], v[40:43], v[48:51], v[72:75]
    v_mfma_f32_16x16x32_bf16 v[76:79], v[44:47], v[48:51], v[76:79]
    ds_read_b128 v[48:51], v14 offset:36864
    s_waitcnt lgkmcnt(7)
    v_mfma_f32_16x16x32_bf16 v[80:83], v[32:35], v[52:55], v[80:83]
    v_mfma_f32_16x16x32_bf16 v[84:87], v[36:39], v[52:55], v[84:87]
    v_mfma_f32_16x16x32_bf16 v[88:91], v[40:43], v[52:55], v[88:91]
    v_mfma_f32_16x16x32_bf16 v[92:95], v[44:47], v[52:55], v[92:95]
    ds_read_b128 v[52:55], v14 offset:38912
    s_waitcnt lgkmcnt(7)
    v_mfma_f32_16x16x32_bf16 v[96:99], v[32:35], v[56:59], v[96:99]
    v_mfma_f32_16x16x32_bf16 v[100:103], v[36:39], v[56:59], v[100:103]
    v_mfma_f32_16x16x32_bf16 v[104:107], v[40:43], v[56:59], v[104:107]
    v_mfma_f32_16x16x32_bf16 v[108:111], v[44:47], v[56:59], v[108:111]
    ds_read_b128 v[56:59], v14 offset:40960
    s_waitcnt lgkmcnt(3)
    v_mfma_f32_16x16x32_bf16 v[112:115], v[32:35], v[60:63], v[112:115]
    v_mfma_f32_16x16x32_bf16 v[116:119], v[36:39], v[60:63], v[116:119]
    v_mfma_f32_16x16x32_bf16 v[120:123], v[40:43], v[60:63], v[120:123]
    v_mfma_f32_16x16x32_bf16 v[124:127], v[44:47], v[60:63], v[124:127]
    ds_read_b128 v[60:63], v15 offset:28672
    s_waitcnt lgkmcnt(3)
    v_mfma_f32_16x16x32_bf16 v[128:131], v[32:35], v[48:51], v[128:131]
    v_mfma_f32_16x16x32_bf16 v[132:135], v[36:39], v[48:51], v[132:135]
    v_mfma_f32_16x16x32_bf16 v[136:139], v[40:43], v[48:51], v[136:139]
    v_mfma_f32_16x16x32_bf16 v[140:143], v[44:47], v[48:51], v[140:143]
    ds_read_b128 v[48:51], v15 offset:30720
    s_waitcnt lgkmcnt(3)
    v_mfma_f32_16x16x32_bf16 v[144:147], v[32:35], v[52:55], v[144:147]
    v_mfma_f32_16x16x32_bf16 v[148:151], v[36:39], v[52:55], v[148:151]
    v_mfma_f32_16x16x32_bf16 v[152:155], v[40:43], v[52:55], v[152:155]
    v_mfma_f32_16x16x32_bf16 v[156:159], v[44:47], v[52:55], v[156:159]
    ds_read_b128 v[52:55], v15 offset:32768
    s_waitcnt lgkmcnt(3)
    v_mfma_f32_16x16x32_bf16 v[160:163], v[32:35], v[56:59], v[160:163]
    v_mfma_f32_16x16x32_bf16 v[164:167], v[36:39], v[56:59], v[164:167]
    v_mfma_f32_16x16x32_bf16 v[168:171], v[40:43], v[56:59], v[168:171]
    v_mfma_f32_16x16x32_bf16 v[172:175], v[44:47], v[56:59], v[172:175]
    ds_read_b128 v[56:59], v15 offset:34816
    s_waitcnt lgkmcnt(3)
    v_mfma_f32_16x16x32_bf16 v[64:67], v[176:179], v[60:63], v[64:67]
    v_mfma_f32_16x16x32_bf16 v[68:71], v[180:183], v[60:63], v[68:71]
    v_mfma_f32_16x16x32_bf16 v[72:75], v[184:187], v[60:63], v[72:75]
    v_mfma_f32_16x16x32_bf16 v[76:79], v[188:191], v[60:63], v[76:79]
    ds_read_b128 v[60:63], v15 offset:36864
    s_waitcnt lgkmcnt(3)
    v_mfma_f32_16x16x32_bf16 v[80:83], v[176:179], v[48:51], v[80:83]
    v_mfma_f32_16x16x32_bf16 v[84:87], v[180:183], v[48:51], v[84:87]
    v_mfma_f32_16x16x32_bf16 v[88:91], v[184:187], v[48:51], v[88:91]
    v_mfma_f32_16x16x32_bf16 v[92:95], v[188:191], v[48:51], v[92:95]
    ds_read_b128 v[48:51], v15 offset:38912
    s_waitcnt lgkmcnt(3)
    v_mfma_f32_16x16x32_bf16 v[96:99], v[176:179], v[52:55], v[96:99]
    v_mfma_f32_16x16x32_bf16 v[100:103], v[180:183], v[52:55], v[100:103]
    v_mfma_f32_16x16x32_bf16 v[104:107], v[184:187], v[52:55], v[104:107]
    v_mfma_f32_16x16x32_bf16 v[108:111], v[188:191], v[52:55], v[108:111]
    ds_read_b128 v[52:55], v15 offset:40960
    s_waitcnt lgkmcnt(3)
    v_mfma_f32_16x16x32_bf16 v[112:115], v[176:179], v[56:59], v[112:115]
    v_mfma_f32_16x16x32_bf16 v[116:119], v[180:183], v[56:59], v[116:119]
    v_mfma_f32_16x16x32_bf16 v[120:123], v[184:187], v[56:59], v[120:123]
    v_mfma_f32_16x16x32_bf16 v[124:127], v[188:191], v[56:59], v[124:127]
    s_waitcnt lgkmcnt(2)
    v_mfma_f32_16x16x32_bf16 v[128:131], v[176:179], v[60:63], v[128:131]
    v_mfma_f32_16x16x32_bf16 v[132:135], v[180:183], v[60:63], v[132:135]
    v_mfma_f32_16x16x32_bf16 v[136:139], v[184:187], v[60:63], v[136:139]
    v_mfma_f32_16x16x32_bf16 v[140:143], v[188:191], v[60:63], v[140:143]
    s_waitcnt lgkmcnt(1)
    v_mfma_f32_16x16x32_bf16 v[144:147], v[176:179], v[48:51], v[144:147]
    v_mfma_f32_16x16x32_bf16 v[148:151], v[180:183], v[48:51], v[148:151]
    v_mfma_f32_16x16x32_bf16 v[152:155], v[184:187], v[48:51], v[152:155]
    v_mfma_f32_16x16x32_bf16 v[156:159], v[188:191], v[48:51], v[156:159]
    s_waitcnt lgkmcnt(0)
    v_mfma_f32_16x16x32_bf16 v[160:163], v[176:179], v[52:55], v[160:163]
    v_mfma_f32_16x16x32_bf16 v[164:167], v[180:183], v[52:55], v[164:167]
    v_mfma_f32_16x16x32_bf16 v[168:171], v[184:187], v[52:55], v[168:171]
    v_mfma_f32_16x16x32_bf16 v[172:175], v[188:191], v[52:55], v[172:175]
    s_waitcnt vmcnt(0)
    s_barrier
    ds_read_b128 v[32:35], v12 offset:0
    ds_read_b128 v[36:39], v12 offset:2048
    ds_read_b128 v[40:43], v12 offset:4096
    ds_read_b128 v[44:47], v12 offset:6144
    ds_read_b128 v[48:51], v14 offset:43008
    ds_read_b128 v[52:55], v14 offset:45056
    ds_read_b128 v[56:59], v14 offset:47104
    ds_read_b128 v[176:179], v13 offset:0
    ds_read_b128 v[180:183], v13 offset:2048
    ds_read_b128 v[184:187], v13 offset:4096
    ds_read_b128 v[188:191], v13 offset:6144
    ds_read_b128 v[60:63], v14 offset:49152
    s_waitcnt lgkmcnt(7)
    v_mfma_f32_16x16x32_bf16 v[64:67], v[32:35], v[48:51], v[64:67]
    v_mfma_f32_16x16x32_bf16 v[68:71], v[36:39], v[48:51], v[68:71]
    v_mfma_f32_16x16x32_bf16 v[72:75], v[40:43], v[48:51], v[72:75]
    v_mfma_f32_16x16x32_bf16 v[76:79], v[44:47], v[48:51], v[76:79]
    ds_read_b128 v[48:51], v14 offset:51200
    s_waitcnt lgkmcnt(7)
    v_mfma_f32_16x16x32_bf16 v[80:83], v[32:35], v[52:55], v[80:83]
    v_mfma_f32_16x16x32_bf16 v[84:87], v[36:39], v[52:55], v[84:87]
    v_mfma_f32_16x16x32_bf16 v[88:91], v[40:43], v[52:55], v[88:91]
    v_mfma_f32_16x16x32_bf16 v[92:95], v[44:47], v[52:55], v[92:95]
    ds_read_b128 v[52:55], v14 offset:53248
    s_waitcnt lgkmcnt(7)
    v_mfma_f32_16x16x32_bf16 v[96:99], v[32:35], v[56:59], v[96:99]
    v_mfma_f32_16x16x32_bf16 v[100:103], v[36:39], v[56:59], v[100:103]
    v_mfma_f32_16x16x32_bf16 v[104:107], v[40:43], v[56:59], v[104:107]
    v_mfma_f32_16x16x32_bf16 v[108:111], v[44:47], v[56:59], v[108:111]
    ds_read_b128 v[56:59], v14 offset:55296
    s_waitcnt lgkmcnt(3)
    v_mfma_f32_16x16x32_bf16 v[112:115], v[32:35], v[60:63], v[112:115]
    v_mfma_f32_16x16x32_bf16 v[116:119], v[36:39], v[60:63], v[116:119]
    v_mfma_f32_16x16x32_bf16 v[120:123], v[40:43], v[60:63], v[120:123]
    v_mfma_f32_16x16x32_bf16 v[124:127], v[44:47], v[60:63], v[124:127]
    ds_read_b128 v[60:63], v15 offset:43008
    s_waitcnt lgkmcnt(3)
    v_mfma_f32_16x16x32_bf16 v[128:131], v[32:35], v[48:51], v[128:131]
    v_mfma_f32_16x16x32_bf16 v[132:135], v[36:39], v[48:51], v[132:135]
    v_mfma_f32_16x16x32_bf16 v[136:139], v[40:43], v[48:51], v[136:139]
    v_mfma_f32_16x16x32_bf16 v[140:143], v[44:47], v[48:51], v[140:143]
    ds_read_b128 v[48:51], v15 offset:45056
    s_waitcnt lgkmcnt(3)
    v_mfma_f32_16x16x32_bf16 v[144:147], v[32:35], v[52:55], v[144:147]
    v_mfma_f32_16x16x32_bf16 v[148:151], v[36:39], v[52:55], v[148:151]
    v_mfma_f32_16x16x32_bf16 v[152:155], v[40:43], v[52:55], v[152:155]
    v_mfma_f32_16x16x32_bf16 v[156:159], v[44:47], v[52:55], v[156:159]
    ds_read_b128 v[52:55], v15 offset:47104
    s_waitcnt lgkmcnt(3)
    v_mfma_f32_16x16x32_bf16 v[160:163], v[32:35], v[56:59], v[160:163]
    v_mfma_f32_16x16x32_bf16 v[164:167], v[36:39], v[56:59], v[164:167]
    v_mfma_f32_16x16x32_bf16 v[168:171], v[40:43], v[56:59], v[168:171]
    v_mfma_f32_16x16x32_bf16 v[172:175], v[44:47], v[56:59], v[172:175]
    ds_read_b128 v[56:59], v15 offset:49152
    s_waitcnt lgkmcnt(3)
    v_mfma_f32_16x16x32_bf16 v[64:67], v[176:179], v[60:63], v[64:67]
    v_mfma_f32_16x16x32_bf16 v[68:71], v[180:183], v[60:63], v[68:71]
    v_mfma_f32_16x16x32_bf16 v[72:75], v[184:187], v[60:63], v[72:75]
    v_mfma_f32_16x16x32_bf16 v[76:79], v[188:191], v[60:63], v[76:79]
    ds_read_b128 v[60:63], v15 offset:51200
    s_waitcnt lgkmcnt(3)
    v_mfma_f32_16x16x32_bf16 v[80:83], v[176:179], v[48:51], v[80:83]
    v_mfma_f32_16x16x32_bf16 v[84:87], v[180:183], v[48:51], v[84:87]
    v_mfma_f32_16x16x32_bf16 v[88:91], v[184:187], v[48:51], v[88:91]
    v_mfma_f32_16x16x32_bf16 v[92:95], v[188:191], v[48:51], v[92:95]
    ds_read_b128 v[48:51], v15 offset:53248
    s_waitcnt lgkmcnt(3)
    v_mfma_f32_16x16x32_bf16 v[96:99], v[176:179], v[52:55], v[96:99]
    v_mfma_f32_16x16x32_bf16 v[100:103], v[180:183], v[52:55], v[100:103]
    v_mfma_f32_16x16x32_bf16 v[104:107], v[184:187], v[52:55], v[104:107]
    v_mfma_f32_16x16x32_bf16 v[108:111], v[188:191], v[52:55], v[108:111]
    ds_read_b128 v[52:55], v15 offset:55296
    s_waitcnt lgkmcnt(3)
    v_mfma_f32_16x16x32_bf16 v[112:115], v[176:179], v[56:59], v[112:115]
    v_mfma_f32_16x16x32_bf16 v[116:119], v[180:183], v[56:59], v[116:119]
    v_mfma_f32_16x16x32_bf16 v[120:123], v[184:187], v[56:59], v[120:123]
    v_mfma_f32_16x16x32_bf16 v[124:127], v[188:191], v[56:59], v[124:127]
    s_waitcnt lgkmcnt(2)
    v_mfma_f32_16x16x32_bf16 v[128:131], v[176:179], v[60:63], v[128:131]
    v_mfma_f32_16x16x32_bf16 v[132:135], v[180:183], v[60:63], v[132:135]
    v_mfma_f32_16x16x32_bf16 v[136:139], v[184:187], v[60:63], v[136:139]
    v_mfma_f32_16x16x32_bf16 v[140:143], v[188:191], v[60:63], v[140:143]
    s_waitcnt lgkmcnt(1)
    v_mfma_f32_16x16x32_bf16 v[144:147], v[176:179], v[48:51], v[144:147]
    v_mfma_f32_16x16x32_bf16 v[148:151], v[180:183], v[48:51], v[148:151]
    v_mfma_f32_16x16x32_bf16 v[152:155], v[184:187], v[48:51], v[152:155]
    v_mfma_f32_16x16x32_bf16 v[156:159], v[188:191], v[48:51], v[156:159]
    s_waitcnt lgkmcnt(0)
    v_mfma_f32_16x16x32_bf16 v[160:163], v[176:179], v[52:55], v[160:163]
    v_mfma_f32_16x16x32_bf16 v[164:167], v[180:183], v[52:55], v[164:167]
    v_mfma_f32_16x16x32_bf16 v[168:171], v[184:187], v[52:55], v[168:171]
    v_mfma_f32_16x16x32_bf16 v[172:175], v[188:191], v[52:55], v[172:175]
    s_branch p0_e
p0_gB:
    s_waitcnt vmcnt(15)
    s_barrier
    ds_read_b128 v[32:35], v12 offset:0
    ds_read_b128 v[36:39], v12 offset:2048
    ds_read_b128 v[40:43], v12 offset:4096
    ds_read_b128 v[44:47], v12 offset:6144
    ds_read_b64_tr_b16 v[48:49], v16 offset:0
    ds_read_b64_tr_b16 v[50:51], v16 offset:896
    ds_read_b64_tr_b16 v[52:53], v16 offset:32
    ds_read_b64_tr_b16 v[54:55], v16 offset:928
    ds_read_b64_tr_b16 v[56:57], v16 offset:64
    ds_read_b64_tr_b16 v[58:59], v16 offset:960
    ds_read_b128 v[176:179], v13 offset:0
    ds_read_b128 v[180:183], v13 offset:2048
    ds_read_b128 v[184:187], v13 offset:4096
    ds_read_b128 v[188:191], v13 offset:6144
    ds_read_b64_tr_b16 v[60:61], v16 offset:96
    ds_read_b64_tr_b16 v[62:63], v16 offset:992
    s_waitcnt lgkmcnt(10)
    v_mfma_f32_16x16x32_bf16 v[64:67], v[32:35], v[48:51], 0
    s_add_u32 m0, s56, 28672
    s_nop 0
    buffer_load_dwordx4 v8, s[44:47], s52 offen lds
    s_add_u32 s52, s52, s39
    v_mfma_f32_16x16x32_bf16 v[68:71], v[36:39], v[48:51], 0
    v_mfma_f32_16x16x32_bf16 v[72:75], v[40:43], v[48:51], 0
    s_add_u32 m0, s57, 28672
    s_nop 0
    buffer_load_dwordx4 v9, s[44:47], s53 offen lds
    s_add_u32 s53, s53, s39
    v_mfma_f32_16x16x32_bf16 v[76:79], v[44:47], v[48:51], 0
    ds_read_b64_tr_b16 v[48:49], v16 offset:128
    ds_read_b64_tr_b16 v[50:51], v16 offset:1024
    s_waitcnt lgkmcnt(10)
    v_mfma_f32_16x16x32_bf16 v[80:83], v[32:35], v[52:55], 0
    s_add_u32 m0, s58, 28672
    s_nop 0
    buffer_load_dwordx4 v10, s[44:47], s54 offen lds
    s_add_u32 s54, s54, s39
    v_mfma_f32_16x16x32_bf16 v[84:87], v[36:39], v[52:55], 0
    v_mfma_f32_16x16x32_bf16 v[88:91], v[40:43], v[52:55], 0
    s_add_u32 m0, s59, 28672
    s_nop 0
    buffer_load_dwordx4 v11, s[44:47], s55 offen lds
    s_add_u32 s55, s55, s39
    v_mfma_f32_16x16x32_bf16 v[92:95], v[44:47], v[52:55], 0
    ds_read_b64_tr_b16 v[52:53], v16 offset:160
    ds_read_b64_tr_b16 v[54:55], v16 offset:1056
    s_waitcnt lgkmcnt(10)
    v_mfma_f32_16x16x32_bf16 v[96:99], v[32:35], v[56:59], 0
    s_add_u32 m0, s35, 16384
    s_add_u32 s30, s38, 256
    buffer_load_dwordx4 v5, s[40:43], s30 offen lds
    v_mfma_f32_16x16x32_bf16 v[100:103], v[36:39], v[56:59], 0
    v_mfma_f32_16x16x32_bf16 v[104:107], v[40:43], v[56:59], 0
    s_add_u32 m0, s35, 17408
    s_nop 0
    buffer_load_dwordx4 v6, s[40:43], s30 offen lds
    v_mfma_f32_16x16x32_bf16 v[108:111], v[44:47], v[56:59], 0
    ds_read_b64_tr_b16 v[56:57], v16 offset:192
    ds_read_b64_tr_b16 v[58:59], v16 offset:1088
    s_waitcnt lgkmcnt(6)
    v_mfma_f32_16x16x32_bf16 v[112:115], v[32:35], v[60:63], 0
    s_add_u32 m0, s35, 18432
    s_add_u32 s30, s38, 33024
    buffer_load_dwordx4 v5, s[40:43], s30 offen lds
    v_mfma_f32_16x16x32_bf16 v[116:119], v[36:39], v[60:63], 0
    v_mfma_f32_16x16x32_bf16 v[120:123], v[40:43], v[60:63], 0
    s_add_u32 m0, s35, 19456
    s_nop 0
    buffer_load_dwordx4 v6, s[40:43], s30 offen lds
    v_mfma_f32_16x16x32_bf16 v[124:127], v[44:47], v[60:63], 0
    ds_read_b64_tr_b16 v[60:61], v16 offset:7168
    ds_read_b64_tr_b16 v[62:63], v16 offset:8064
    s_waitcnt lgkmcnt(6)
    v_mfma_f32_16x16x32_bf16 v[128:131], v[32:35], v[48:51], 0
    s_add_u32 m0, s35, 20480
    s_add_u32 s30, s38, 262400
    buffer_load_dwordx4 v5, s[40:43], s30 offen lds
    v_mfma_f32_16x16x32_bf16 v[132:135], v[36:39], v[48:51], 0
    v_mfma_f32_16x16x32_bf16 v[136:139], v[40:43], v[48:51], 0
    s_add_u32 m0, s35, 21504
    s_nop 0
    buffer_load_dwordx4 v6, s[40:43], s30 offen lds
    v_mfma_f32_16x16x32_bf16 v[140:143], v[44:47], v[48:51], 0
    ds_read_b64_tr_b16 v[48:49], v16 offset:7200
    ds_read_b64_tr_b16 v[50:51], v16 offset:8096
    s_waitcnt lgkmcnt(6)
    v_mfma_f32_16x16x32_bf16 v[144:147], v[32:35], v[52:55], 0
    s_add_u32 m0, s35, 22528
    s_add_u32 s30, s38, 295168
    buffer_load_dwordx4 v5, s[40:43], s30 offen lds
    v_mfma_f32_16x16x32_bf16 v[148:151], v[36:39], v[52:55], 0
    v_mfma_f32_16x16x32_bf16 v[152:155], v[40:43], v[52:55], 0
    s_add_u32 m0, s35, 23552
    s_nop 0
    buffer_load_dwordx4 v6, s[40:43], s30 offen lds
    v_mfma_f32_16x16x32_bf16 v[156:159], v[44:47], v[52:55], 0
    ds_read_b64_tr_b16 v[52:53], v16 offset:7232
    ds_read_b64_tr_b16 v[54:55], v16 offset:8128
    s_waitcnt lgkmcnt(6)
    v_mfma_f32_16x16x32_bf16 v[160:163], v[32:35], v[56:59], 0
    v_mfma_f32_16x16x32_bf16 v[164:167], v[36:39], v[56:59], 0
    v_mfma_f32_16x16x32_bf16 v[168:171], v[40:43], v[56:59], 0
    v_mfma_f32_16x16x32_bf16 v[172:175], v[44:47], v[56:59], 0
    ds_read_b64_tr_b16 v[56:57], v16 offset:7264
    ds_read_b64_tr_b16 v[58:59], v16 offset:8160
    s_waitcnt lgkmcnt(6)
    v_mfma_f32_16x16x32_bf16 v[64:67], v[176:179], v[60:63], v[64:67]
    v_mfma_f32_16x16x32_bf16 v[68:71], v[180:183], v[60:63], v[68:71]
    v_mfma_f32_16x16x32_bf16 v[72:75], v[184:187], v[60:63], v[72:75]
    v_mfma_f32_16x16x32_bf16 v[76:79], v[188:191], v[60:63], v[76:79]
    ds_read_b64_tr_b16 v[60:61], v16 offset:7296
    ds_read_b64_tr_b16 v[62:63], v16 offset:8192
    s_waitcnt lgkmcnt(6)
    v_mfma_f32_16x16x32_bf16 v[80:83], v[176:179], v[48:51], v[80:83]
    v_mfma_f32_16x16x32_bf16 v[84:87], v[180:183], v[48:51], v[84:87]
    v_mfma_f32_16x16x32_bf16 v[88:91], v[184:187], v[48:51], v[88:91]
    v_mfma_f32_16x16x32_bf16 v[92:95], v[188:191], v[48:51], v[92:95]
    ds_read_b64_tr_b16 v[48:49], v16 offset:7328
    ds_read_b64_tr_b16 v[50:51], v16 offset:8224
    s_waitcnt lgkmcnt(6)
    v_mfma_f32_16x16x32_bf16 v[96:99], v[176:179], v[52:55], v[96:99]
    v_mfma_f32_16x16x32_bf16 v[100:103], v[180:183], v[52:55], v[100:103]
    v_mfma_f32_16x16x32_bf16 v[104:107], v[184:187], v[52:55], v[104:107]
    v_mfma_f32_16x16x32_bf16 v[108:111], v[188:191], v[52:55], v[108:111]
    ds_read_b64_tr_b16 v[52:53], v16 offset:7360
    ds_read_b64_tr_b16 v[54:55], v16 offset:8256
    s_waitcnt lgkmcnt(6)
    v_mfma_f32_16x16x32_bf16 v[112:115], v[176:179], v[56:59], v[112:115]
    v_mfma_f32_16x16x32_bf16 v[116:119], v[180:183], v[56:59], v[116:119]
    v_mfma_f32_16x16x32_bf16 v[120:123], v[184:187], v[56:59], v[120:123]
    v_mfma_f32_16x16x32_bf16 v[124:127], v[188:191], v[56:59], v[124:127]
    s_waitcnt lgkmcnt(4)
    v_mfma_f32_16x16x32_bf16 v[128:131], v[176:179], v[60:63], v[128:131]
    v_mfma_f32_16x16x32_bf16 v[132:135], v[180:183], v[60:63], v[132:135]
    v_mfma_f32_16x16x32_bf16 v[136:139], v[184:187], v[60:63], v[136:139]
    v_mfma_f32_16x16x32_bf16 v[140:143], v[188:191], v[60:63], v[140:143]
    s_waitcnt lgkmcnt(2)
    v_mfma_f32_16x16x32_bf16 v[144:147], v[176:179], v[48:51], v[144:147]
    v_mfma_f32_16x16x32_bf16 v[148:151], v[180:183], v[48:51], v[148:151]
    v_mfma_f32_16x16x32_bf16 v[152:155], v[184:187], v[48:51], v[152:155]
    v_mfma_f32_16x16x32_bf16 v[156:159], v[188:191], v[48:51], v[156:159]
    s_waitcnt lgkmcnt(0)
    v_mfma_f32_16x16x32_bf16 v[160:163], v[176:179], v[52:55], v[160:163]
    v_mfma_f32_16x16x32_bf16 v[164:167], v[180:183], v[52:55], v[164:167]
    v_mfma_f32_16x16x32_bf16 v[168:171], v[184:187], v[52:55], v[168:171]
    v_mfma_f32_16x16x32_bf16 v[172:175], v[188:191], v[52:55], v[172:175]
    s_waitcnt vmcnt(12)
    s_barrier
    buffer_atomic_add v1, v2, s[48:51], 0 offen sc0 sc1
    ds_read_b128 v[32:35], v12 offset:8192
    ds_read_b128 v[36:39], v12 offset:10240
    ds_read_b128 v[40:43], v12 offset:12288
    ds_read_b128 v[44:47], v12 offset:14336
    ds_read_b64_tr_b16 v[48:49], v16 offset:14336
    ds_read_b64_tr_b16 v[50:51], v16 offset:15232
    ds_read_b64_tr_b16 v[52:53], v16 offset:14368
    ds_read_b64_tr_b16 v[54:55], v16 offset:15264
    ds_read_b64_tr_b16 v[56:57], v16 offset:14400
    ds_read_b64_tr_b16 v[58:59], v16 offset:15296
    ds_read_b128 v[176:179], v13 offset:8192
    ds_read_b128 v[180:183], v13 offset:10240
    ds_read_b128 v[184:187], v13 offset:12288
    ds_read_b128 v[188:191], v13 offset:14336
    ds_read_b64_tr_b16 v[60:61], v16 offset:14432
    ds_read_b64_tr_b16 v[62:63], v16 offset:15328
    s_waitcnt lgkmcnt(10)
    v_mfma_f32_16x16x32_bf16 v[64:67], v[32:35], v[48:51], v[64:67]
    s_add_u32 m0, s56, 43008
    s_nop 0
    buffer_load_dwordx4 v8, s[44:47], s52 offen lds
    s_add_u32 s52, s52, s39
    v_mfma_f32_16x16x32_bf16 v[68:71], v[36:39], v[48:51], v[68:71]
    v_mfma_f32_16x16x32_bf16 v[72:75], v[40:43], v[48:51], v[72:75]
    s_add_u32 m0, s57, 43008
    s_nop 0
    buffer_load_dwordx4 v9, s[44:47], s53 offen lds
    s_add_u32 s53, s53, s39
    v_mfma_f32_16x16x32_bf16 v[76:79], v[44:47], v[48:51], v[76:79]
    ds_read_b64_tr_b16 v[48:49], v16 offset:14464
    ds_read_b64_tr_b16 v[50:51], v16 offset:15360
    s_waitcnt lgkmcnt(10)
    v_mfma_f32_16x16x32_bf16 v[80:83], v[32:35], v[52:55], v[80:83]
    s_add_u32 m0, s58, 43008
    s_nop 0
    buffer_load_dwordx4 v10, s[44:47], s54 offen lds
    s_add_u32 s54, s54, s39
    v_mfma_f32_16x16x32_bf16 v[84:87], v[36:39], v[52:55], v[84:87]
    v_mfma_f32_16x16x32_bf16 v[88:91], v[40:43], v[52:55], v[88:91]
    s_add_u32 m0, s59, 43008
    s_nop 0
    buffer_load_dwordx4 v11, s[44:47], s55 offen lds
    s_add_u32 s55, s55, s39
    v_mfma_f32_16x16x32_bf16 v[92:95], v[44:47], v[52:55], v[92:95]
    ds_read_b64_tr_b16 v[52:53], v16 offset:14496
    ds_read_b64_tr_b16 v[54:55], v16 offset:15392
    s_waitcnt lgkmcnt(10)
    v_mfma_f32_16x16x32_bf16 v[96:99], v[32:35], v[56:59], v[96:99]
    s_add_u32 m0, s35, 0
    s_add_u32 s30, s38, 384
    buffer_load_dwordx4 v5, s[40:43], s30 offen lds
    v_mfma_f32_16x16x32_bf16 v[100:103], v[36:39], v[56:59], v[100:103]
    v_mfma_f32_16x16x32_bf16 v[104:107], v[40:43], v[56:59], v[104:107]
    s_add_u32 m0, s35, 1024
    s_nop 0
    buffer_load_dwordx4 v6, s[40:43], s30 offen lds
    v_mfma_f32_16x16x32_bf16 v[108:111], v[44:47], v[56:59], v[108:111]
    ds_read_b64_tr_b16 v[56:57], v16 offset:14528
    ds_read_b64_tr_b16 v[58:59], v16 offset:15424
    s_waitcnt lgkmcnt(6)
    v_mfma_f32_16x16x32_bf16 v[112:115], v[32:35], v[60:63], v[112:115]
    s_add_u32 m0, s35, 2048
    s_add_u32 s30, s38, 33152
    buffer_load_dwordx4 v5, s[40:43], s30 offen lds
    v_mfma_f32_16x16x32_bf16 v[116:119], v[36:39], v[60:63], v[116:119]
    v_mfma_f32_16x16x32_bf16 v[120:123], v[40:43], v[60:63], v[120:123]
    s_add_u32 m0, s35, 3072
    s_nop 0
    buffer_load_dwordx4 v6, s[40:43], s30 offen lds
    v_mfma_f32_16x16x32_bf16 v[124:127], v[44:47], v[60:63], v[124:127]
    ds_read_b64_tr_b16 v[60:61], v16 offset:21504
    ds_read_b64_tr_b16 v[62:63], v16 offset:22400
    s_waitcnt lgkmcnt(6)
    v_mfma_f32_16x16x32_bf16 v[128:131], v[32:35], v[48:51], v[128:131]
    s_add_u32 m0, s35, 4096
    s_add_u32 s30, s38, 262528
    buffer_load_dwordx4 v5, s[40:43], s30 offen lds
    v_mfma_f32_16x16x32_bf16 v[132:135], v[36:39], v[48:51], v[132:135]
    v_mfma_f32_16x16x32_bf16 v[136:139], v[40:43], v[48:51], v[136:139]
    s_add_u32 m0, s35, 5120
    s_nop 0
    buffer_load_dwordx4 v6, s[40:43], s30 offen lds
    v_mfma_f32_16x16x32_bf16 v[140:143], v[44:47], v[48:51], v[140:143]
    ds_read_b64_tr_b16 v[48:49], v16 offset:21536
    ds_read_b64_tr_b16 v[50:51], v16 offset:22432
    s_waitcnt lgkmcnt(6)
    v_mfma_f32_16x16x32_bf16 v[144:147], v[32:35], v[52:55], v[144:147]
    s_add_u32 m0, s35, 6144
    s_add_u32 s30, s38, 295296
    buffer_load_dwordx4 v5, s[40:43], s30 offen lds
    v_mfma_f32_16x16x32_bf16 v[148:151], v[36:39], v[52:55], v[148:151]
    v_mfma_f32_16x16x32_bf16 v[152:155], v[40:43], v[52:55], v[152:155]
    s_add_u32 m0, s35, 7168
    s_nop 0
    buffer_load_dwordx4 v6, s[40:43], s30 offen lds
    v_mfma_f32_16x16x32_bf16 v[156:159], v[44:47], v[52:55], v[156:159]
    ds_read_b64_tr_b16 v[52:53], v16 offset:21568
    ds_read_b64_tr_b16 v[54:55], v16 offset:22464
    s_waitcnt lgkmcnt(6)
    v_mfma_f32_16x16x32_bf16 v[160:163], v[32:35], v[56:59], v[160:163]
    v_mfma_f32_16x16x32_bf16 v[164:167], v[36:39], v[56:59], v[164:167]
    v_mfma_f32_16x16x32_bf16 v[168:171], v[40:43], v[56:59], v[168:171]
    v_mfma_f32_16x16x32_bf16 v[172:175], v[44:47], v[56:59], v[172:175]
    ds_read_b64_tr_b16 v[56:57], v16 offset:21600
    ds_read_b64_tr_b16 v[58:59], v16 offset:22496
    s_waitcnt lgkmcnt(6)
    v_mfma_f32_16x16x32_bf16 v[64:67], v[176:179], v[60:63], v[64:67]
    v_mfma_f32_16x16x32_bf16 v[68:71], v[180:183], v[60:63], v[68:71]
    v_mfma_f32_16x16x32_bf16 v[72:75], v[184:187], v[60:63], v[72:75]
    v_mfma_f32_16x16x32_bf16 v[76:79], v[188:191], v[60:63], v[76:79]
    ds_read_b64_tr_b16 v[60:61], v16 offset:21632
    ds_read_b64_tr_b16 v[62:63], v16 offset:22528
    s_waitcnt lgkmcnt(6)
    v_mfma_f32_16x16x32_bf16 v[80:83], v[176:179], v[48:51], v[80:83]
    v_mfma_f32_16x16x32_bf16 v[84:87], v[180:183], v[48:51], v[84:87]
    v_mfma_f32_16x16x32_bf16 v[88:91], v[184:187], v[48:51], v[88:91]
    v_mfma_f32_16x16x32_bf16 v[92:95], v[188:191], v[48:51], v[92:95]
    ds_read_b64_tr_b16 v[48:49], v16 offset:21664
    ds_read_b64_tr_b16 v[50:51], v16 offset:22560
    s_waitcnt lgkmcnt(6)
    v_mfma_f32_16x16x32_bf16 v[96:99], v[176:179], v[52:55], v[96:99]
    v_mfma_f32_16x16x32_bf16 v[100:103], v[180:183], v[52:55], v[100:103]
    v_mfma_f32_16x16x32_bf16 v[104:107], v[184:187], v[52:55], v[104:107]
    v_mfma_f32_16x16x32_bf16 v[108:111], v[188:191], v[52:55], v[108:111]
    ds_read_b64_tr_b16 v[52:53], v16 offset:21696
    ds_read_b64_tr_b16 v[54:55], v16 offset:22592
    s_waitcnt lgkmcnt(6)
    v_mfma_f32_16x16x32_bf16 v[112:115], v[176:179], v[56:59], v[112:115]
    v_mfma_f32_16x16x32_bf16 v[116:119], v[180:183], v[56:59], v[116:119]
    v_mfma_f32_16x16x32_bf16 v[120:123], v[184:187], v[56:59], v[120:123]
    v_mfma_f32_16x16x32_bf16 v[124:127], v[188:191], v[56:59], v[124:127]
    s_waitcnt lgkmcnt(4)
    v_mfma_f32_16x16x32_bf16 v[128:131], v[176:179], v[60:63], v[128:131]
    v_mfma_f32_16x16x32_bf16 v[132:135], v[180:183], v[60:63], v[132:135]
    v_mfma_f32_16x16x32_bf16 v[136:139], v[184:187], v[60:63], v[136:139]
    v_mfma_f32_16x16x32_bf16 v[140:143], v[188:191], v[60:63], v[140:143]
    s_waitcnt lgkmcnt(2)
    v_mfma_f32_16x16x32_bf16 v[144:147], v[176:179], v[48:51], v[144:147]
    v_mfma_f32_16x16x32_bf16 v[148:151], v[180:183], v[48:51], v[148:151]
    v_mfma_f32_16x16x32_bf16 v[152:155], v[184:187], v[48:51], v[152:155]
    v_mfma_f32_16x16x32_bf16 v[156:159], v[188:191], v[48:51], v[156:159]
    s_waitcnt lgkmcnt(0)
    v_mfma_f32_16x16x32_bf16 v[160:163], v[176:179], v[52:55], v[160:163]
    v_mfma_f32_16x16x32_bf16 v[164:167], v[180:183], v[52:55], v[164:167]
    v_mfma_f32_16x16x32_bf16 v[168:171], v[184:187], v[52:55], v[168:171]
    v_mfma_f32_16x16x32_bf16 v[172:175], v[188:191], v[52:55], v[172:175]
    s_waitcnt vmcnt(13)
    s_barrier
    ds_read_b128 v[32:35], v12 offset:16384
    ds_read_b128 v[36:39], v12 offset:18432
    ds_read_b128 v[40:43], v12 offset:20480
    ds_read_b128 v[44:47], v12 offset:22528
    ds_read_b64_tr_b16 v[48:49], v16 offset:28672
    ds_read_b64_tr_b16 v[50:51], v16 offset:29568
    ds_read_b64_tr_b16 v[52:53], v16 offset:28704
    ds_read_b64_tr_b16 v[54:55], v16 offset:29600
    ds_read_b64_tr_b16 v[56:57], v16 offset:28736
    ds_read_b64_tr_b16 v[58:59], v16 offset:29632
    ds_read_b128 v[176:179], v13 offset:16384
    ds_read_b128 v[180:183], v13 offset:18432
    ds_read_b128 v[184:187], v13 offset:20480
    ds_read_b128 v[188:191], v13 offset:22528
    ds_read_b64_tr_b16 v[60:61], v16 offset:28768
    ds_read_b64_tr_b16 v[62:63], v16 offset:29664
    s_waitcnt lgkmcnt(10)
    v_mfma_f32_16x16x32_bf16 v[64:67], v[32:35], v[48:51], v[64:67]
    v_mfma_f32_16x16x32_bf16 v[68:71], v[36:39], v[48:51], v[68:71]
    v_mfma_f32_16x16x32_bf16 v[72:75], v[40:43], v[48:51], v[72:75]
    v_mfma_f32_16x16x32_bf16 v[76:79], v[44:47], v[48:51], v[76:79]
    ds_read_b64_tr_b16 v[48:49], v16 offset:28800
    ds_read_b64_tr_b16 v[50:51], v16 offset:29696
    s_waitcnt lgkmcnt(10)
    v_mfma_f32_16x16x32_bf16 v[80:83], v[32:35], v[52:55], v[80:83]
    v_mfma_f32_16x16x32_bf16 v[84:87], v[36:39], v[52:55], v[84:87]
    v_mfma_f32_16x16x32_bf16 v[88:91], v[40:43], v[52:55], v[88:91]
    v_mfma_f32_16x16x32_bf16 v[92:95], v[44:47], v[52:55], v[92:95]
    ds_read_b64_tr_b16 v[52:53], v16 offset:28832
    ds_read_b64_tr_b16 v[54:55], v16 offset:29728
    s_waitcnt lgkmcnt(10)
    v_mfma_f32_16x16x32_bf16 v[96:99], v[32:35], v[56:59], v[96:99]
    v_mfma_f32_16x16x32_bf16 v[100:103], v[36:39], v[56:59], v[100:103]
    v_mfma_f32_16x16x32_bf16 v[104:107], v[40:43], v[56:59], v[104:107]
    v_mfma_f32_16x16x32_bf16 v[108:111], v[44:47], v[56:59], v[108:111]
    ds_read_b64_tr_b16 v[56:57], v16 offset:28864
    ds_read_b64_tr_b16 v[58:59], v16 offset:29760
    s_waitcnt lgkmcnt(6)
    v_mfma_f32_16x16x32_bf16 v[112:115], v[32:35], v[60:63], v[112:115]
    v_mfma_f32_16x16x32_bf16 v[116:119], v[36:39], v[60:63], v[116:119]
    v_mfma_f32_16x16x32_bf16 v[120:123], v[40:43], v[60:63], v[120:123]
    v_mfma_f32_16x16x32_bf16 v[124:127], v[44:47], v[60:63], v[124:127]
    ds_read_b64_tr_b16 v[60:61], v16 offset:35840
    ds_read_b64_tr_b16 v[62:63], v16 offset:36736
    s_waitcnt lgkmcnt(6)
    v_mfma_f32_16x16x32_bf16 v[128:131], v[32:35], v[48:51], v[128:131]
    v_mfma_f32_16x16x32_bf16 v[132:135], v[36:39], v[48:51], v[132:135]
    v_mfma_f32_16x16x32_bf16 v[136:139], v[40:43], v[48:51], v[136:139]
    v_mfma_f32_16x16x32_bf16 v[140:143], v[44:47], v[48:51], v[140:143]
    ds_read_b64_tr_b16 v[48:49], v16 offset:35872
    ds_read_b64_tr_b16 v[50:51], v16 offset:36768
    s_waitcnt lgkmcnt(6)
    v_mfma_f32_16x16x32_bf16 v[144:147], v[32:35], v[52:55], v[144:147]
    v_mfma_f32_16x16x32_bf16 v[148:151], v[36:39], v[52:55], v[148:151]
    v_mfma_f32_16x16x32_bf16 v[152:155], v[40:43], v[52:55], v[152:155]
    v_mfma_f32_16x16x32_bf16 v[156:159], v[44:47], v[52:55], v[156:159]
    ds_read_b64_tr_b16 v[52:53], v16 offset:35904
    ds_read_b64_tr_b16 v[54:55], v16 offset:36800
    s_waitcnt lgkmcnt(6)
    v_mfma_f32_16x16x32_bf16 v[160:163], v[32:35], v[56:59], v[160:163]
    v_mfma_f32_16x16x32_bf16 v[164:167], v[36:39], v[56:59], v[164:167]
    v_mfma_f32_16x16x32_bf16 v[168:171], v[40:43], v[56:59], v[168:171]
    v_mfma_f32_16x16x32_bf16 v[172:175], v[44:47], v[56:59], v[172:175]
    ds_read_b64_tr_b16 v[56:57], v16 offset:35936
    ds_read_b64_tr_b16 v[58:59], v16 offset:36832
    s_waitcnt lgkmcnt(6)
    v_mfma_f32_16x16x32_bf16 v[64:67], v[176:179], v[60:63], v[64:67]
    v_mfma_f32_16x16x32_bf16 v[68:71], v[180:183], v[60:63], v[68:71]
    v_mfma_f32_16x16x32_bf16 v[72:75], v[184:187], v[60:63], v[72:75]
    v_mfma_f32_16x16x32_bf16 v[76:79], v[188:191], v[60:63], v[76:79]
    ds_read_b64_tr_b16 v[60:61], v16 offset:35968
    ds_read_b64_tr_b16 v[62:63], v16 offset:36864
    s_waitcnt lgkmcnt(6)
    v_mfma_f32_16x16x32_bf16 v[80:83], v[176:179], v[48:51], v[80:83]
    v_mfma_f32_16x16x32_bf16 v[84:87], v[180:183], v[48:51], v[84:87]
    v_mfma_f32_16x16x32_bf16 v[88:91], v[184:187], v[48:51], v[88:91]
    v_mfma_f32_16x16x32_bf16 v[92:95], v[188:191], v[48:51], v[92:95]
    ds_read_b64_tr_b16 v[48:49], v16 offset:36000
    ds_read_b64_tr_b16 v[50:51], v16 offset:36896
    s_waitcnt lgkmcnt(6)
    v_mfma_f32_16x16x32_bf16 v[96:99], v[176:179], v[52:55], v[96:99]
    v_mfma_f32_16x16x32_bf16 v[100:103], v[180:183], v[52:55], v[100:103]
    v_mfma_f32_16x16x32_bf16 v[104:107], v[184:187], v[52:55], v[104:107]
    v_mfma_f32_16x16x32_bf16 v[108:111], v[188:191], v[52:55], v[108:111]
    ds_read_b64_tr_b16 v[52:53], v16 offset:36032
    ds_read_b64_tr_b16 v[54:55], v16 offset:36928
    s_waitcnt lgkmcnt(6)
    v_mfma_f32_16x16x32_bf16 v[112:115], v[176:179], v[56:59], v[112:115]
    v_mfma_f32_16x16x32_bf16 v[116:119], v[180:183], v[56:59], v[116:119]
    v_mfma_f32_16x16x32_bf16 v[120:123], v[184:187], v[56:59], v[120:123]
    v_mfma_f32_16x16x32_bf16 v[124:127], v[188:191], v[56:59], v[124:127]
    s_waitcnt lgkmcnt(4)
    v_mfma_f32_16x16x32_bf16 v[128:131], v[176:179], v[60:63], v[128:131]
    v_mfma_f32_16x16x32_bf16 v[132:135], v[180:183], v[60:63], v[132:135]
    v_mfma_f32_16x16x32_bf16 v[136:139], v[184:187], v[60:63], v[136:139]
    v_mfma_f32_16x16x32_bf16 v[140:143], v[188:191], v[60:63], v[140:143]
    s_waitcnt lgkmcnt(2)
    v_mfma_f32_16x16x32_bf16 v[144:147], v[176:179], v[48:51], v[144:147]
    v_mfma_f32_16x16x32_bf16 v[148:151], v[180:183], v[48:51], v[148:151]
    v_mfma_f32_16x16x32_bf16 v[152:155], v[184:187], v[48:51], v[152:155]
    v_mfma_f32_16x16x32_bf16 v[156:159], v[188:191], v[48:51], v[156:159]
    s_waitcnt lgkmcnt(0)
    v_mfma_f32_16x16x32_bf16 v[160:163], v[176:179], v[52:55], v[160:163]
    v_mfma_f32_16x16x32_bf16 v[164:167], v[180:183], v[52:55], v[164:167]
    v_mfma_f32_16x16x32_bf16 v[168:171], v[184:187], v[52:55], v[168:171]
    v_mfma_f32_16x16x32_bf16 v[172:175], v[188:191], v[52:55], v[172:175]
    s_waitcnt vmcnt(0)
    s_barrier
    ds_read_b128 v[32:35], v12 offset:0
    ds_read_b128 v[36:39], v12 offset:2048
    ds_read_b128 v[40:43], v12 offset:4096
    ds_read_b128 v[44:47], v12 offset:6144
    ds_read_b64_tr_b16 v[48:49], v16 offset:43008
    ds_read_b64_tr_b16 v[50:51], v16 offset:43904
    ds_read_b64_tr_b16 v[52:53], v16 offset:43040
    ds_read_b64_tr_b16 v[54:55], v16 offset:43936
    ds_read_b64_tr_b16 v[56:57], v16 offset:43072
    ds_read_b64_tr_b16 v[58:59], v16 offset:43968
    ds_read_b128 v[176:179], v13 offset:0
    ds_read_b128 v[180:183], v13 offset:2048
    ds_read_b128 v[184:187], v13 offset:4096
    ds_read_b128 v[188:191], v13 offset:6144
    ds_read_b64_tr_b16 v[60:61], v16 offset:43104
    ds_read_b64_tr_b16 v[62:63], v16 offset:44000
    s_waitcnt lgkmcnt(10)
    v_mfma_f32_16x16x32_bf16 v[64:67], v[32:35], v[48:51], v[64:67]
    v_mfma_f32_16x16x32_bf16 v[68:71], v[36:39], v[48:51], v[68:71]
    v_mfma_f32_16x16x32_bf16 v[72:75], v[40:43], v[48:51], v[72:75]
    v_mfma_f32_16x16x32_bf16 v[76:79], v[44:47], v[48:51], v[76:79]
    ds_read_b64_tr_b16 v[48:49], v16 offset:43136
    ds_read_b64_tr_b16 v[50:51], v16 offset:44032
    s_waitcnt lgkmcnt(10)
    v_mfma_f32_16x16x32_bf16 v[80:83], v[32:35], v[52:55], v[80:83]
    v_mfma_f32_16x16x32_bf16 v[84:87], v[36:39], v[52:55], v[84:87]
    v_mfma_f32_16x16x32_bf16 v[88:91], v[40:43], v[52:55], v[88:91]
    v_mfma_f32_16x16x32_bf16 v[92:95], v[44:47], v[52:55], v[92:95]
    ds_read_b64_tr_b16 v[52:53], v16 offset:43168
    ds_read_b64_tr_b16 v[54:55], v16 offset:44064
    s_waitcnt lgkmcnt(10)
    v_mfma_f32_16x16x32_bf16 v[96:99], v[32:35], v[56:59], v[96:99]
    v_mfma_f32_16x16x32_bf16 v[100:103], v[36:39], v[56:59], v[100:103]
    v_mfma_f32_16x16x32_bf16 v[104:107], v[40:43], v[56:59], v[104:107]
    v_mfma_f32_16x16x32_bf16 v[108:111], v[44:47], v[56:59], v[108:111]
    ds_read_b64_tr_b16 v[56:57], v16 offset:43200
    ds_read_b64_tr_b16 v[58:59], v16 offset:44096
    s_waitcnt lgkmcnt(6)
    v_mfma_f32_16x16x32_bf16 v[112:115], v[32:35], v[60:63], v[112:115]
    v_mfma_f32_16x16x32_bf16 v[116:119], v[36:39], v[60:63], v[116:119]
    v_mfma_f32_16x16x32_bf16 v[120:123], v[40:43], v[60:63], v[120:123]
    v_mfma_f32_16x16x32_bf16 v[124:127], v[44:47], v[60:63], v[124:127]
    ds_read_b64_tr_b16 v[60:61], v16 offset:50176
    ds_read_b64_tr_b16 v[62:63], v16 offset:51072
    s_waitcnt lgkmcnt(6)
    v_mfma_f32_16x16x32_bf16 v[128:131], v[32:35], v[48:51], v[128:131]
    v_mfma_f32_16x16x32_bf16 v[132:135], v[36:39], v[48:51], v[132:135]
    v_mfma_f32_16x16x32_bf16 v[136:139], v[40:43], v[48:51], v[136:139]
    v_mfma_f32_16x16x32_bf16 v[140:143], v[44:47], v[48:51], v[140:143]
    ds_read_b64_tr_b16 v[48:49], v16 offset:50208
    ds_read_b64_tr_b16 v[50:51], v16 offset:51104
    s_waitcnt lgkmcnt(6)
    v_mfma_f32_16x16x32_bf16 v[144:147], v[32:35], v[52:55], v[144:147]
    v_mfma_f32_16x16x32_bf16 v[148:151], v[36:39], v[52:55], v[148:151]
    v_mfma_f32_16x16x32_bf16 v[152:155], v[40:43], v[52:55], v[152:155]
    v_mfma_f32_16x16x32_bf16 v[156:159], v[44:47], v[52:55], v[156:159]
    ds_read_b64_tr_b16 v[52:53], v16 offset:50240
    ds_read_b64_tr_b16 v[54:55], v16 offset:51136
    s_waitcnt lgkmcnt(6)
    v_mfma_f32_16x16x32_bf16 v[160:163], v[32:35], v[56:59], v[160:163]
    v_mfma_f32_16x16x32_bf16 v[164:167], v[36:39], v[56:59], v[164:167]
    v_mfma_f32_16x16x32_bf16 v[168:171], v[40:43], v[56:59], v[168:171]
    v_mfma_f32_16x16x32_bf16 v[172:175], v[44:47], v[56:59], v[172:175]
    ds_read_b64_tr_b16 v[56:57], v16 offset:50272
    ds_read_b64_tr_b16 v[58:59], v16 offset:51168
    s_waitcnt lgkmcnt(6)
    v_mfma_f32_16x16x32_bf16 v[64:67], v[176:179], v[60:63], v[64:67]
    v_mfma_f32_16x16x32_bf16 v[68:71], v[180:183], v[60:63], v[68:71]
    v_mfma_f32_16x16x32_bf16 v[72:75], v[184:187], v[60:63], v[72:75]
    v_mfma_f32_16x16x32_bf16 v[76:79], v[188:191], v[60:63], v[76:79]
    ds_read_b64_tr_b16 v[60:61], v16 offset:50304
    ds_read_b64_tr_b16 v[62:63], v16 offset:51200
    s_waitcnt lgkmcnt(6)
    v_mfma_f32_16x16x32_bf16 v[80:83], v[176:179], v[48:51], v[80:83]
    v_mfma_f32_16x16x32_bf16 v[84:87], v[180:183], v[48:51], v[84:87]
    v_mfma_f32_16x16x32_bf16 v[88:91], v[184:187], v[48:51], v[88:91]
    v_mfma_f32_16x16x32_bf16 v[92:95], v[188:191], v[48:51], v[92:95]
    ds_read_b64_tr_b16 v[48:49], v16 offset:50336
    ds_read_b64_tr_b16 v[50:51], v16 offset:51232
    s_waitcnt lgkmcnt(6)
    v_mfma_f32_16x16x32_bf16 v[96:99], v[176:179], v[52:55], v[96:99]
    v_mfma_f32_16x16x32_bf16 v[100:103], v[180:183], v[52:55], v[100:103]
    v_mfma_f32_16x16x32_bf16 v[104:107], v[184:187], v[52:55], v[104:107]
    v_mfma_f32_16x16x32_bf16 v[108:111], v[188:191], v[52:55], v[108:111]
    ds_read_b64_tr_b16 v[52:53], v16 offset:50368
    ds_read_b64_tr_b16 v[54:55], v16 offset:51264
    s_waitcnt lgkmcnt(6)
    v_mfma_f32_16x16x32_bf16 v[112:115], v[176:179], v[56:59], v[112:115]
    v_mfma_f32_16x16x32_bf16 v[116:119], v[180:183], v[56:59], v[116:119]
    v_mfma_f32_16x16x32_bf16 v[120:123], v[184:187], v[56:59], v[120:123]
    v_mfma_f32_16x16x32_bf16 v[124:127], v[188:191], v[56:59], v[124:127]
    s_waitcnt lgkmcnt(4)
    v_mfma_f32_16x16x32_bf16 v[128:131], v[176:179], v[60:63], v[128:131]
    v_mfma_f32_16x16x32_bf16 v[132:135], v[180:183], v[60:63], v[132:135]
    v_mfma_f32_16x16x32_bf16 v[136:139], v[184:187], v[60:63], v[136:139]
    v_mfma_f32_16x16x32_bf16 v[140:143], v[188:191], v[60:63], v[140:143]
    s_waitcnt lgkmcnt(2)
    v_mfma_f32_16x16x32_bf16 v[144:147], v[176:179], v[48:51], v[144:147]
    v_mfma_f32_16x16x32_bf16 v[148:151], v[180:183], v[48:51], v[148:151]
    v_mfma_f32_16x16x32_bf16 v[152:155], v[184:187], v[48:51], v[152:155]
    v_mfma_f32_16x16x32_bf16 v[156:159], v[188:191], v[48:51], v[156:159]
    s_waitcnt lgkmcnt(0)
    v_mfma_f32_16x16x32_bf16 v[160:163], v[176:179], v[52:55], v[160:163]
    v_mfma_f32_16x16x32_bf16 v[164:167], v[180:183], v[52:55], v[164:167]
    v_mfma_f32_16x16x32_bf16 v[168:171], v[184:187], v[52:55], v[168:171]
    v_mfma_f32_16x16x32_bf16 v[172:175], v[188:191], v[52:55], v[172:175]
p0_e:
    s_cmp_eq_u32 s29, 0
    s_cbranch_scc0 p0_e2
    s_nop 5
    v_mul_f32 v64, 0x3db8aa3b, v64
    v_mul_f32 v65, 0x3db8aa3b, v65
    v_mul_f32 v66, 0x3db8aa3b, v66
    v_mul_f32 v67, 0x3db8aa3b, v67
    v_mul_f32 v68, 0x3db8aa3b, v68
    v_mul_f32 v69, 0x3db8aa3b, v69
    v_mul_f32 v70, 0x3db8aa3b, v70
    v_mul_f32 v71, 0x3db8aa3b, v71
    v_mul_f32 v72, 0x3db8aa3b, v72
    v_mul_f32 v73, 0x3db8aa3b, v73
    v_mul_f32 v74, 0x3db8aa3b, v74
    v_mul_f32 v75, 0x3db8aa3b, v75
    v_mul_f32 v76, 0x3db8aa3b, v76
    v_mul_f32 v77, 0x3db8aa3b, v77
    v_mul_f32 v78, 0x3db8aa3b, v78
    v_mul_f32 v79, 0x3db8aa3b, v79
    v_mul_f32 v80, 0x3db8aa3b, v80
    v_mul_f32 v81, 0x3db8aa3b, v81
    v_mul_f32 v82, 0x3db8aa3b, v82
    v_mul_f32 v83, 0x3db8aa3b, v83
    v_mul_f32 v84, 0x3db8aa3b, v84
    v_mul_f32 v85, 0x3db8aa3b, v85
    v_mul_f32 v86, 0x3db8aa3b, v86
    v_mul_f32 v87, 0x3db8aa3b, v87
    v_mul_f32 v88, 0x3db8aa3b, v88
    v_mul_f32 v89, 0x3db8aa3b, v89
    v_mul_f32 v90, 0x3db8aa3b, v90
    v_mul_f32 v91, 0x3db8aa3b, v91
    v_mul_f32 v92, 0x3db8aa3b, v92
    v_mul_f32 v93, 0x3db8aa3b, v93
    v_mul_f32 v94, 0x3db8aa3b, v94
    v_mul_f32 v95, 0x3db8aa3b, v95
    v_mul_f32 v96, 0x3db8aa3b, v96
    v_mul_f32 v97, 0x3db8aa3b, v97
    v_mul_f32 v98, 0x3db8aa3b, v98
    v_mul_f32 v99, 0x3db8aa3b, v99
    v_mul_f32 v100, 0x3db8aa3b, v100
    v_mul_f32 v101, 0x3db8aa3b, v101
    v_mul_f32 v102, 0x3db8aa3b, v102
    v_mul_f32 v103, 0x3db8aa3b, v103
    v_mul_f32 v104, 0x3db8aa3b, v104
    v_mul_f32 v105, 0x3db8aa3b, v105
    v_mul_f32 v106, 0x3db8aa3b, v106
    v_mul_f32 v107, 0x3db8aa3b, v107
    v_mul_f32 v108, 0x3db8aa3b, v108
    v_mul_f32 v109, 0x3db8aa3b, v109
    v_mul_f32 v110, 0x3db8aa3b, v110
    v_mul_f32 v111, 0x3db8aa3b, v111
    v_mul_f32 v112, 0x3db8aa3b, v112
    v_mul_f32 v113, 0x3db8aa3b, v113
    v_mul_f32 v114, 0x3db8aa3b, v114
    v_mul_f32 v115, 0x3db8aa3b, v115
    v_mul_f32 v116, 0x3db8aa3b, v116
    v_mul_f32 v117, 0x3db8aa3b, v117
    v_mul_f32 v118, 0x3db8aa3b, v118
    v_mul_f32 v119, 0x3db8aa3b, v119
    v_mul_f32 v120, 0x3db8aa3b, v120
    v_mul_f32 v121, 0x3db8aa3b, v121
    v_mul_f32 v122, 0x3db8aa3b, v122
    v_mul_f32 v123, 0x3db8aa3b, v123
    v_mul_f32 v124, 0x3db8aa3b, v124
    v_mul_f32 v125, 0x3db8aa3b, v125
    v_mul_f32 v126, 0x3db8aa3b, v126
    v_mul_f32 v127, 0x3db8aa3b, v127
    v_mul_f32 v128, 0x3db8aa3b, v128
    v_mul_f32 v129, 0x3db8aa3b, v129
    v_mul_f32 v130, 0x3db8aa3b, v130
    v_mul_f32 v131, 0x3db8aa3b, v131
    v_mul_f32 v132, 0x3db8aa3b, v132
    v_mul_f32 v133, 0x3db8aa3b, v133
    v_mul_f32 v134, 0x3db8aa3b, v134
    v_mul_f32 v135, 0x3db8aa3b, v135
    v_mul_f32 v136, 0x3db8aa3b, v136
    v_mul_f32 v137, 0x3db8aa3b, v137
    v_mul_f32 v138, 0x3db8aa3b, v138
    v_mul_f32 v139, 0x3db8aa3b, v139
    v_mul_f32 v140, 0x3db8aa3b, v140
    v_mul_f32 v141, 0x3db8aa3b, v141
    v_mul_f32 v142, 0x3db8aa3b, v142
    v_mul_f32 v143, 0x3db8aa3b, v143
    v_mul_f32 v144, 0x3db8aa3b, v144
    v_mul_f32 v145, 0x3db8aa3b, v145
    v_mul_f32 v146, 0x3db8aa3b, v146
    v_mul_f32 v147, 0x3db8aa3b, v147
    v_mul_f32 v148, 0x3db8aa3b, v148
    v_mul_f32 v149, 0x3db8aa3b, v149
    v_mul_f32 v150, 0x3db8aa3b, v150
    v_mul_f32 v151, 0x3db8aa3b, v151
    v_mul_f32 v152, 0x3db8aa3b, v152
    v_mul_f32 v153, 0x3db8aa3b, v153
    v_mul_f32 v154, 0x3db8aa3b, v154
    v_mul_f32 v155, 0x3db8aa3b, v155
    v_mul_f32 v156, 0x3db8aa3b, v156
    v_mul_f32 v157, 0x3db8aa3b, v157
    v_mul_f32 v158, 0x3db8aa3b, v158
    v_mul_f32 v159, 0x3db8aa3b, v159
    v_mul_f32 v160, 0x3db8aa3b, v160
    v_mul_f32 v161, 0x3db8aa3b, v161
    v_mul_f32 v162, 0x3db8aa3b, v162
    v_mul_f32 v163, 0x3db8aa3b, v163
    v_mul_f32 v164, 0x3db8aa3b, v164
    v_mul_f32 v165, 0x3db8aa3b, v165
    v_mul_f32 v166, 0x3db8aa3b, v166
    v_mul_f32 v167, 0x3db8aa3b, v167
    v_mul_f32 v168, 0x3db8aa3b, v168
    v_mul_f32 v169, 0x3db8aa3b, v169
    v_mul_f32 v170, 0x3db8aa3b, v170
    v_mul_f32 v171, 0x3db8aa3b, v171
    v_mul_f32 v172, 0x3db8aa3b, v172
    v_mul_f32 v173, 0x3db8aa3b, v173
    v_mul_f32 v174, 0x3db8aa3b, v174
    v_mul_f32 v175, 0x3db8aa3b, v175
p0_e2:
    s_mul_i32 s30, s24, 28
    s_mul_i32 s31, s27, 7
    s_add_u32 s30, s30, s31
    s_mul_i32 s30, s30, 14336
    s_lshl_b32 s31, s37, 10
    s_add_u32 s30, s30, s31
    s_nop 1
    v_cvt_pk_bf16_f32 v64, v64, v65
    v_cvt_pk_bf16_f32 v65, v66, v67
    v_cvt_pk_bf16_f32 v66, v68, v69
    v_cvt_pk_bf16_f32 v67, v70, v71
    buffer_store_dwordx4 v[64:67], v17, s[4:7], s30 offen offset:0 sc1
    v_cvt_pk_bf16_f32 v72, v72, v73
    v_cvt_pk_bf16_f32 v73, v74, v75
    v_cvt_pk_bf16_f32 v74, v76, v77
    v_cvt_pk_bf16_f32 v75, v78, v79
    buffer_store_dwordx4 v[72:75], v17, s[4:7], s30 offen offset:1024 sc1
    s_add_u32 s30, s30, 14336
    v_cvt_pk_bf16_f32 v80, v80, v81
    v_cvt_pk_bf16_f32 v81, v82, v83
    v_cvt_pk_bf16_f32 v82, v84, v85
    v_cvt_pk_bf16_f32 v83, v86, v87
    buffer_store_dwordx4 v[80:83], v17, s[4:7], s30 offen offset:0 sc1
    v_cvt_pk_bf16_f32 v88, v88, v89
    v_cvt_pk_bf16_f32 v89, v90, v91
    v_cvt_pk_bf16_f32 v90, v92, v93
    v_cvt_pk_bf16_f32 v91, v94, v95
    buffer_store_dwordx4 v[88:91], v17, s[4:7], s30 offen offset:1024 sc1
    s_add_u32 s30, s30, 14336
    v_cvt_pk_bf16_f32 v96, v96, v97
    v_cvt_pk_bf16_f32 v97, v98, v99
    v_cvt_pk_bf16_f32 v98, v100, v101
    v_cvt_pk_bf16_f32 v99, v102, v103
    buffer_store_dwordx4 v[96:99], v17, s[4:7], s30 offen offset:0 sc1
    v_cvt_pk_bf16_f32 v104, v104, v105
    v_cvt_pk_bf16_f32 v105, v106, v107
    v_cvt_pk_bf16_f32 v106, v108, v109
    v_cvt_pk_bf16_f32 v107, v110, v111
    buffer_store_dwordx4 v[104:107], v17, s[4:7], s30 offen offset:1024 sc1
    s_add_u32 s30, s30, 14336
    v_cvt_pk_bf16_f32 v112, v112, v113
    v_cvt_pk_bf16_f32 v113, v114, v115
    v_cvt_pk_bf16_f32 v114, v116, v117
    v_cvt_pk_bf16_f32 v115, v118, v119
    buffer_store_dwordx4 v[112:115], v17, s[4:7], s30 offen offset:0 sc1
    v_cvt_pk_bf16_f32 v120, v120, v121
    v_cvt_pk_bf16_f32 v121, v122, v123
    v_cvt_pk_bf16_f32 v122, v124, v125
    v_cvt_pk_bf16_f32 v123, v126, v127
    buffer_store_dwordx4 v[120:123], v17, s[4:7], s30 offen offset:1024 sc1
    s_add_u32 s30, s30, 14336
    v_cvt_pk_bf16_f32 v128, v128, v129
    v_cvt_pk_bf16_f32 v129, v130, v131
    v_cvt_pk_bf16_f32 v130, v132, v133
    v_cvt_pk_bf16_f32 v131, v134, v135
    buffer_store_dwordx4 v[128:131], v17, s[4:7], s30 offen offset:0 sc1
    v_cvt_pk_bf16_f32 v136, v136, v137
    v_cvt_pk_bf16_f32 v137, v138, v139
    v_cvt_pk_bf16_f32 v138, v140, v141
    v_cvt_pk_bf16_f32 v139, v142, v143
    buffer_store_dwordx4 v[136:139], v17, s[4:7], s30 offen offset:1024 sc1
    s_add_u32 s30, s30, 14336
    v_cvt_pk_bf16_f32 v144, v144, v145
    v_cvt_pk_bf16_f32 v145, v146, v147
    v_cvt_pk_bf16_f32 v146, v148, v149
    v_cvt_pk_bf16_f32 v147, v150, v151
    buffer_store_dwordx4 v[144:147], v17, s[4:7], s30 offen offset:0 sc1
    v_cvt_pk_bf16_f32 v152, v152, v153
    v_cvt_pk_bf16_f32 v153, v154, v155
    v_cvt_pk_bf16_f32 v154, v156, v157
    v_cvt_pk_bf16_f32 v155, v158, v159
    buffer_store_dwordx4 v[152:155], v17, s[4:7], s30 offen offset:1024 sc1
    s_add_u32 s30, s30, 14336
    v_cvt_pk_bf16_f32 v160, v160, v161
    v_cvt_pk_bf16_f32 v161, v162, v163
    v_cvt_pk_bf16_f32 v162, v164, v165
    v_cvt_pk_bf16_f32 v163, v166, v167
    buffer_store_dwordx4 v[160:163], v17, s[4:7], s30 offen offset:0 sc1
    v_cvt_pk_bf16_f32 v168, v168, v169
    v_cvt_pk_bf16_f32 v169, v170, v171
    v_cvt_pk_bf16_f32 v170, v172, v173
    v_cvt_pk_bf16_f32 v171, v174, v175
    buffer_store_dwordx4 v[168:171], v17, s[4:7], s30 offen offset:1024 sc1
    s_add_u32 s30, s30, 14336
    s_branch p0_done
p0_w3:
    v_and_b32 v18, 7, v0
    v_lshrrev_b32 v19, 3, v0
    s_lshl_b32 s34, s2, 3
    v_add_u32 v7, s34, v18
    v_mul_u32_u24 v7, 896, v7
    v_lshl_add_u32 v7, v19, 4, v7
    buffer_load_dwordx4 v[200:203], v7, s[8:11], 0 offen offset:0
    buffer_load_dwordx4 v[204:207], v7, s[8:11], 0 offen offset:128
    buffer_load_dwordx4 v[208:211], v7, s[8:11], 0 offen offset:256
    buffer_load_dwordx4 v[212:215], v7, s[8:11], 0 offen offset:384
    buffer_load_dwordx4 v[216:219], v7, s[8:11], 0 offen offset:512
    buffer_load_dwordx4 v[220:223], v7, s[8:11], 0 offen offset:640
    buffer_load_dwordx4 v[224:227], v7, s[8:11], 0 offen offset:768
    s_add_u32 m0, s56, 0
    s_nop 0
    buffer_load_dwordx4 v8, s[44:47], s52 offen lds
    s_add_u32 s52, s52, s39
    s_add_u32 m0, s57, 0
    s_nop 0
    buffer_load_dwordx4 v9, s[44:47], s53 offen lds
    s_add_u32 s53, s53, s39
    s_add_u32 m0, s58, 0
    s_nop 0
    buffer_load_dwordx4 v10, s[44:47], s54 offen lds
    s_add_u32 s54, s54, s39
    s_add_u32 m0, s59, 0
    s_nop 0
    buffer_load_dwordx4 v11, s[44:47], s55 offen lds
    s_add_u32 s55, s55, s39
    s_add_u32 m0, s35, 0
    s_add_u32 s30, s38, 0
    buffer_load_dwordx4 v5, s[40:43], s30 offen lds
    s_add_u32 m0, s35, 1024
    s_nop 0
    buffer_load_dwordx4 v6, s[40:43], s30 offen lds
    s_add_u32 m0, s35, 2048
    s_add_u32 s30, s38, 32768
    buffer_load_dwordx4 v5, s[40:43], s30 offen lds
    s_add_u32 m0, s35, 3072
    s_nop 0
    buffer_load_dwordx4 v6, s[40:43], s30 offen lds
    s_add_u32 m0, s56, 14336
    s_nop 0
    buffer_load_dwordx4 v8, s[44:47], s52 offen lds
    s_add_u32 s52, s52, s39
    s_add_u32 m0, s57, 14336
    s_nop 0
    buffer_load_dwordx4 v9, s[44:47], s53 offen lds
    s_add_u32 s53, s53, s39
    s_add_u32 m0, s58, 14336
    s_nop 0
    buffer_load_dwordx4 v10, s[44:47], s54 offen lds
    s_add_u32 s54, s54, s39
    s_add_u32 m0, s59, 14336
    s_nop 0
    buffer_load_dwordx4 v11, s[44:47], s55 offen lds
    s_add_u32 s55, s55, s39
    s_add_u32 m0, s35, 4096
    s_add_u32 s30, s38, 128
    buffer_load_dwordx4 v5, s[40:43], s30 offen lds
    s_add_u32 m0, s35, 5120
    s_nop 0
    buffer_load_dwordx4 v6, s[40:43], s30 offen lds
    s_add_u32 m0, s35, 6144
    s_add_u32 s30, s38, 32896
    buffer_load_dwordx4 v5, s[40:43], s30 offen lds
    s_add_u32 m0, s35, 7168
    s_nop 0
    buffer_load_dwordx4 v6, s[40:43], s30 offen lds
    buffer_store_dwordx4 v[248:251], v17, s[4:7], s91 offen sc1
    s_cmp_eq_u32 s29, 0
    s_cbranch_scc0 p0_gB3
    s_waitcnt vmcnt(9)
    s_barrier
    ds_read_b128 v[32:35], v12 offset:0
    ds_read_b128 v[36:39], v12 offset:2048
    ds_read_b128 v[48:51], v14 offset:0
    ds_read_b128 v[52:55], v14 offset:2048
    ds_read_b128 v[56:59], v14 offset:4096
    ds_read_b128 v[176:179], v13 offset:0
    ds_read_b128 v[180:183], v13 offset:2048
    ds_read_b128 v[60:63], v14 offset:6144
    s_waitcnt lgkmcnt(5)
    v_mfma_f32_16x16x32_bf16 v[64:67], v[32:35], v[48:51], 0
    s_add_u32 m0, s56, 28672
    s_nop 0
    buffer_load_dwordx4 v8, s[44:47], s52 offen lds
    s_add_u32 s52, s52, s39
    s_mov_b32 s92, 0xffff0000
    v_lshlrev_b32 v72, 16, v200
    v_and_b32 v73, s92, v200
    v_lshlrev_b32 v74, 16, v201
    v_and_b32 v75, s92, v201
    v_lshlrev_b32 v76, 16, v202
    v_and_b32 v77, s92, v202
    v_lshlrev_b32 v78, 16, v203
    v_mfma_f32_16x16x32_bf16 v[68:71], v[36:39], v[48:51], 0
    s_add_u32 m0, s57, 28672
    s_nop 0
    buffer_load_dwordx4 v9, s[44:47], s53 offen lds
    s_add_u32 s53, s53, s39
    v_and_b32 v79, s92, v203
    v_lshlrev_b32 v88, 16, v204
    v_and_b32 v89, s92, v204
    v_lshlrev_b32 v90, 16, v205
    v_and_b32 v91, s92, v205
    v_lshlrev_b32 v92, 16, v206
    v_and_b32 v93, s92, v206
    v_lshlrev_b32 v94, 16, v207
    v_and_b32 v95, s92, v207
    ds_read_b128 v[48:51], v14 offset:8192
    s_waitcnt lgkmcnt(5)
    v_mfma_f32_16x16x32_bf16 v[80:83], v[32:35], v[52:55], 0
    s_add_u32 m0, s58, 28672
    s_nop 0
    buffer_load_dwordx4 v10, s[44:47], s54 offen lds
    s_add_u32 s54, s54, s39
    v_lshlrev_b32 v104, 16, v208
    v_and_b32 v105, s92, v208
    v_lshlrev_b32 v106, 16, v209
    v_and_b32 v107, s92, v209
    v_lshlrev_b32 v108, 16, v210
    v_and_b32 v109, s92, v210
    v_lshlrev_b32 v110, 16, v211
    v_and_b32 v111, s92, v211
    v_lshlrev_b32 v120, 16, v212
    v_mfma_f32_16x16x32_bf16 v[84:87], v[36:39], v[52:55], 0
    s_add_u32 m0, s59, 28672
    s_nop 0
    buffer_load_dwordx4 v11, s[44:47], s55 offen lds
    s_add_u32 s55, s55, s39
    v_and_b32 v121, s92, v212
    v_lshlrev_b32 v122, 16, v213
    v_and_b32 v123, s92, v213
    v_lshlrev_b32 v124, 16, v214
    v_and_b32 v125, s92, v214
    v_lshlrev_b32 v126, 16, v215
    v_and_b32 v127, s92, v215
    v_lshlrev_b32 v136, 16, v216
    ds_read_b128 v[52:55], v14 offset:10240
    s_waitcnt lgkmcnt(5)
    v_mfma_f32_16x16x32_bf16 v[96:99], v[32:35], v[56:59], 0
    s_add_u32 m0, s35, 8192
    s_add_u32 s30, s38, 256
    buffer_load_dwordx4 v5, s[40:43], s30 offen lds
    v_and_b32 v137, s92, v216
    v_lshlrev_b32 v138, 16, v217
    v_and_b32 v139, s92, v217
    v_lshlrev_b32 v140, 16, v218
    v_and_b32 v141, s92, v218
    v_lshlrev_b32 v142, 16, v219
    v_and_b32 v143, s92, v219
    v_lshlrev_b32 v152, 16, v220
    v_and_b32 v153, s92, v220
    v_mfma_f32_16x16x32_bf16 v[100:103], v[36:39], v[56:59], 0
    s_add_u32 m0, s35, 9216
    s_nop 0
    buffer_load_dwordx4 v6, s[40:43], s30 offen lds
    v_lshlrev_b32 v154, 16, v221
    v_and_b32 v155, s92, v221
    v_lshlrev_b32 v156, 16, v222
    v_and_b32 v157, s92, v222
    v_lshlrev_b32 v158, 16, v223
    v_and_b32 v159, s92, v223
    v_lshlrev_b32 v168, 16, v224
    v_and_b32 v169, s92, v224
    v_lshlrev_b32 v170, 16, v225
    ds_read_b128 v[56:59], v14 offset:12288
    s_waitcnt lgkmcnt(3)
    v_mfma_f32_16x16x32_bf16 v[112:115], v[32:35], v[60:63], 0
    s_add_u32 m0, s35, 10240
    s_add_u32 s30, s38, 33024
    buffer_load_dwordx4 v5, s[40:43], s30 offen lds
    v_and_b32 v171, s92, v225
    v_lshlrev_b32 v172, 16, v226
    v_and_b32 v173, s92, v226
    v_lshlrev_b32 v174, 16, v227
    v_and_b32 v175, s92, v227
    v_add_f32 v228, v72, v73
    v_add_f32 v229, v74, v75
    v_add_f32 v228, v228, v76
    v_add_f32 v229, v229, v77
    v_mfma_f32_16x16x32_bf16 v[116:119], v[36:39], v[60:63], 0
    s_add_u32 m0, s35, 11264
    s_nop 0
    buffer_load_dwordx4 v6, s[40:43], s30 offen lds
    v_add_f32 v228, v228, v78
    v_add_f32 v229, v229, v79
    v_add_f32 v228, v228, v88
    v_add_f32 v229, v229, v89
    v_add_f32 v228, v228, v90
    v_add_f32 v229, v229, v91
    v_add_f32 v228, v228, v92
    v_add_f32 v229, v229, v93
    ds_read_b128 v[60:63], v15 offset:0
    s_waitcnt lgkmcnt(3)
    v_mfma_f32_16x16x32_bf16 v[128:131], v[32:35], v[48:51], 0
    v_add_f32 v228, v228, v94
    v_add_f32 v229, v229, v95
    v_add_f32 v228, v228, v104
    v_add_f32 v229, v229, v105
    v_add_f32 v228, v228, v106
    v_add_f32 v229, v229, v107
    v_add_f32 v228, v228, v108
    v_add_f32 v229, v229, v109
    v_add_f32 v228, v228, v110
    v_mfma_f32_16x16x32_bf16 v[132:135], v[36:39], v[48:51], 0
    v_add_f32 v229, v229, v111
    v_add_f32 v228, v228, v120
    v_add_f32 v229, v229, v121
    v_add_f32 v228, v228, v122
    v_add_f32 v229, v229, v123
    v_add_f32 v228, v228, v124
    v_add_f32 v229, v229, v125
    v_add_f32 v228, v228, v126
    v_add_f32 v229, v229, v127
    ds_read_b128 v[48:51], v15 offset:2048
    s_waitcnt lgkmcnt(3)
    v_mfma_f32_16x16x32_bf16 v[144:147], v[32:35], v[52:55], 0
    v_add_f32 v228, v228, v136
    v_add_f32 v229, v229, v137
    v_add_f32 v228, v228, v138
    v_add_f32 v229, v229, v139
    v_add_f32 v228, v228, v140
    v_add_f32 v229, v229, v141
    v_add_f32 v228, v228, v142
    v_add_f32 v229, v229, v143
    v_mfma_f32_16x16x32_bf16 v[148:151], v[36:39], v[52:55], 0
    v_add_f32 v228, v228, v152
    v_add_f32 v229, v229, v153
    v_add_f32 v228, v228, v154
    v_add_f32 v229, v229, v155
    v_add_f32 v228, v228, v156
    v_add_f32 v229, v229, v157
    v_add_f32 v228, v228, v158
    v_add_f32 v229, v229, v159
    v_add_f32 v228, v228, v168
    ds_read_b128 v[52:55], v15 offset:4096
    s_waitcnt lgkmcnt(3)
    v_mfma_f32_16x16x32_bf16 v[160:163], v[32:35], v[56:59], 0
    v_add_f32 v229, v229, v169
    v_add_f32 v228, v228, v170
    v_add_f32 v229, v229, v171
    v_add_f32 v228, v228, v172
    v_add_f32 v229, v229, v173
    v_add_f32 v228, v228, v174
    v_add_f32 v229, v229, v175
    v_add_f32 v228, v228, v229
    s_nop 1
    v_add_f32_dpp v228, v228, v228 row_ror:8 row_mask:0xf bank_mask:0xf
    v_mfma_f32_16x16x32_bf16 v[164:167], v[36:39], v[56:59], 0
    v_mov_b32 v229, v228
    s_nop 1
    v_permlane16_swap_b32 v228, v229
    v_add_f32 v228, v228, v229
    v_mov_b32 v229, v228
    s_nop 1
    v_permlane32_swap_b32 v228, v229
    v_add_f32 v228, v228, v229
    v_mul_f32 v228, 0x3b124925, v228
    v_mov_b32 v230, 0
    v_mov_b32 v231, 0
    ds_read_b128 v[56:59], v15 offset:6144
    s_waitcnt lgkmcnt(3)
    v_mfma_f32_16x16x32_bf16 v[64:67], v[176:179], v[60:63], v[64:67]
    v_sub_f32 v20, v72, v228
    v_sub_f32 v21, v73, v228
    v_fmac_f32 v230, v20, v20
    v_fmac_f32 v231, v21, v21
    v_sub_f32 v20, v74, v228
    v_sub_f32 v21, v75, v228
    v_fmac_f32 v230, v20, v20
    v_fmac_f32 v231, v21, v21
    v_mfma_f32_16x16x32_bf16 v[68:71], v[180:183], v[60:63], v[68:71]
    v_sub_f32 v20, v76, v228
    v_sub_f32 v21, v77, v228
    v_fmac_f32 v230, v20, v20
    v_fmac_f32 v231, v21, v21
    v_sub_f32 v20, v78, v228
    v_sub_f32 v21, v79, v228
    v_fmac_f32 v230, v20, v20
    v_fmac_f32 v231, v21, v21
    v_sub_f32 v20, v88, v228
    ds_read_b128 v[60:63], v15 offset:8192
    s_waitcnt lgkmcnt(3)
    v_mfma_f32_16x16x32_bf16 v[80:83], v[176:179], v[48:51], v[80:83]
    v_sub_f32 v21, v89, v228
    v_fmac_f32 v230, v20, v20
    v_fmac_f32 v231, v21, v21
    v_sub_f32 v20, v90, v228
    v_sub_f32 v21, v91, v228
    v_fmac_f32 v230, v20, v20
    v_fmac_f32 v231, v21, v21
    v_sub_f32 v20, v92, v228
    v_sub_f32 v21, v93, v228
    v_mfma_f32_16x16x32_bf16 v[84:87], v[180:183], v[48:51], v[84:87]
    v_fmac_f32 v230, v20, v20
    v_fmac_f32 v231, v21, v21
    v_sub_f32 v20, v94, v228
    v_sub_f32 v21, v95, v228
    v_fmac_f32 v230, v20, v20
    v_fmac_f32 v231, v21, v21
    v_sub_f32 v20, v104, v228
    v_sub_f32 v21, v105, v228
    ds_read_b128 v[48:51], v15 offset:10240
    s_waitcnt lgkmcnt(3)
    v_mfma_f32_16x16x32_bf16 v[96:99], v[176:179], v[52:55], v[96:99]
    v_fmac_f32 v230, v20, v20
    v_fmac_f32 v231, v21, v21
    v_sub_f32 v20, v106, v228
    v_sub_f32 v21, v107, v228
    v_fmac_f32 v230, v20, v20
    v_fmac_f32 v231, v21, v21
    v_sub_f32 v20, v108, v228
    v_sub_f32 v21, v109, v228
    v_fmac_f32 v230, v20, v20
    v_mfma_f32_16x16x32_bf16 v[100:103], v[180:183], v[52:55], v[100:103]
    v_fmac_f32 v231, v21, v21
    v_sub_f32 v20, v110, v228
    v_sub_f32 v21, v111, v228
    v_fmac_f32 v230, v20, v20
    v_fmac_f32 v231, v21, v21
    v_sub_f32 v20, v120, v228
    v_sub_f32 v21, v121, v228
    v_fmac_f32 v230, v20, v20
    v_fmac_f32 v231, v21, v21
    ds_read_b128 v[52:55], v15 offset:12288
    s_waitcnt lgkmcnt(3)
    v_mfma_f32_16x16x32_bf16 v[112:115], v[176:179], v[56:59], v[112:115]
    v_sub_f32 v20, v122, v228
    v_sub_f32 v21, v123, v228
    v_fmac_f32 v230, v20, v20
    v_fmac_f32 v231, v21, v21
    v_sub_f32 v20, v124, v228
    v_sub_f32 v21, v125, v228
    v_fmac_f32 v230, v20, v20
    v_fmac_f32 v231, v21, v21
    v_sub_f32 v20, v126, v228
    v_mfma_f32_16x16x32_bf16 v[116:119], v[180:183], v[56:59], v[116:119]
    v_sub_f32 v21, v127, v228
    v_fmac_f32 v230, v20, v20
    v_fmac_f32 v231, v21, v21
    v_sub_f32 v20, v136, v228
    v_sub_f32 v21, v137, v228
    v_fmac_f32 v230, v20, v20
    v_fmac_f32 v231, v21, v21
    v_sub_f32 v20, v138, v228
    s_waitcnt lgkmcnt(2)
    v_mfma_f32_16x16x32_bf16 v[128:131], v[176:179], v[60:63], v[128:131]
    v_sub_f32 v21, v139, v228
    v_fmac_f32 v230, v20, v20
    v_fmac_f32 v231, v21, v21
    v_sub_f32 v20, v140, v228
    v_sub_f32 v21, v141, v228
    v_fmac_f32 v230, v20, v20
    v_fmac_f32 v231, v21, v21
    v_sub_f32 v20, v142, v228
    v_sub_f32 v21, v143, v228
    v_mfma_f32_16x16x32_bf16 v[132:135], v[180:183], v[60:63], v[132:135]
    v_fmac_f32 v230, v20, v20
    v_fmac_f32 v231, v21, v21
    v_sub_f32 v20, v152, v228
    v_sub_f32 v21, v153, v228
    v_fmac_f32 v230, v20, v20
    v_fmac_f32 v231, v21, v21
    v_sub_f32 v20, v154, v228
    v_sub_f32 v21, v155, v228
    v_fmac_f32 v230, v20, v20
    s_waitcnt lgkmcnt(1)
    v_mfma_f32_16x16x32_bf16 v[144:147], v[176:179], v[48:51], v[144:147]
    v_fmac_f32 v231, v21, v21
    v_sub_f32 v20, v156, v228
    v_sub_f32 v21, v157, v228
    v_fmac_f32 v230, v20, v20
    v_fmac_f32 v231, v21, v21
    v_sub_f32 v20, v158, v228
    v_sub_f32 v21, v159, v228
    v_fmac_f32 v230, v20, v20
    v_mfma_f32_16x16x32_bf16 v[148:151], v[180:183], v[48:51], v[148:151]
    v_fmac_f32 v231, v21, v21
    v_sub_f32 v20, v168, v228
    v_sub_f32 v21, v169, v228
    v_fmac_f32 v230, v20, v20
    v_fmac_f32 v231, v21, v21
    v_sub_f32 v20, v170, v228
    v_sub_f32 v21, v171, v228
    v_fmac_f32 v230, v20, v20
    v_fmac_f32 v231, v21, v21
    s_waitcnt lgkmcnt(0)
    v_mfma_f32_16x16x32_bf16 v[160:163], v[176:179], v[52:55], v[160:163]
    v_sub_f32 v20, v172, v228
    v_sub_f32 v21, v173, v228
    v_fmac_f32 v230, v20, v20
    v_fmac_f32 v231, v21, v21
    v_sub_f32 v20, v174, v228
    v_sub_f32 v21, v175, v228
    v_fmac_f32 v230, v20, v20
    v_fmac_f32 v231, v21, v21
    v_add_f32 v230, v230, v231
    v_mfma_f32_16x16x32_bf16 v[164:167], v[180:183], v[52:55], v[164:167]
    s_nop 0
    v_add_f32_dpp v230, v230, v230 row_ror:8 row_mask:0xf bank_mask:0xf
    v_mov_b32 v229, v230
    s_nop 1
    v_permlane16_swap_b32 v230, v229
    v_add_f32 v230, v230, v229
    v_mov_b32 v229, v230
    s_nop 1
    v_permlane32_swap_b32 v230, v229
    v_add_f32 v230, v230, v229
    v_mul_f32 v230, 0x3b124925, v230
    v_cvt_pk_bf16_f32 v228, v228, v228
    s_waitcnt vmcnt(8)
    s_barrier
    buffer_atomic_add v1, v2, s[48:51], 0 offen sc0 sc1
    ds_read_b128 v[32:35], v12 offset:4096
    ds_read_b128 v[36:39], v12 offset:6144
    ds_read_b128 v[48:51], v14 offset:14336
    ds_read_b128 v[52:55], v14 offset:16384
    ds_read_b128 v[56:59], v14 offset:18432
    ds_read_b128 v[176:179], v13 offset:4096
    ds_read_b128 v[180:183], v13 offset:6144
    ds_read_b128 v[60:63], v14 offset:20480
    s_waitcnt lgkmcnt(5)
    v_mfma_f32_16x16x32_bf16 v[64:67], v[32:35], v[48:51], v[64:67]
    s_add_u32 m0, s56, 43008
    s_nop 0
    buffer_load_dwordx4 v8, s[44:47], s52 offen lds
    s_add_u32 s52, s52, s39
    v_lshlrev_b32 v228, 16, v228
    v_cvt_pk_bf16_f32 v230, v230, v230
    v_lshlrev_b32 v230, 16, v230
    v_add_f32 v230, 0x3727c5ac, v230
    v_cvt_pk_bf16_f32 v230, v230, v230
    v_lshlrev_b32 v230, 16, v230
    v_sqrt_f32 v230, v230
    s_nop 0
    v_cvt_pk_bf16_f32 v230, v230, v230
    v_mfma_f32_16x16x32_bf16 v[68:71], v[36:39], v[48:51], v[68:71]
    s_add_u32 m0, s57, 43008
    s_nop 0
    buffer_load_dwordx4 v9, s[44:47], s53 offen lds
    s_add_u32 s53, s53, s39
    v_lshlrev_b32 v230, 16, v230
    v_rcp_f32 v230, v230
    v_sub_f32 v20, v72, v228
    v_sub_f32 v21, v73, v228
    v_cvt_pk_bf16_f32 v20, v20, v21
    v_and_b32 v21, s92, v20
    v_lshlrev_b32 v20, 16, v20
    v_mul_f32 v20, v20, v230
    v_mul_f32 v21, v21, v230
    ds_read_b128 v[48:51], v14 offset:22528
    s_waitcnt lgkmcnt(5)
    v_mfma_f32_16x16x32_bf16 v[80:83], v[32:35], v[52:55], v[80:83]
    s_add_u32 m0, s58, 43008
    s_nop 0
    buffer_load_dwordx4 v10, s[44:47], s54 offen lds
    s_add_u32 s54, s54, s39
    v_cvt_pk_bf16_f32 v200, v20, v21
    v_sub_f32 v20, v74, v228
    v_sub_f32 v21, v75, v228
    v_cvt_pk_bf16_f32 v20, v20, v21
    v_and_b32 v21, s92, v20
    v_lshlrev_b32 v20, 16, v20
    v_mul_f32 v20, v20, v230
    v_mul_f32 v21, v21, v230
    v_cvt_pk_bf16_f32 v201, v20, v21
    v_mfma_f32_16x16x32_bf16 v[84:87], v[36:39], v[52:55], v[84:87]
    s_add_u32 m0, s59, 43008
    s_nop 0
    buffer_load_dwordx4 v11, s[44:47], s55 offen lds
    s_add_u32 s55, s55, s39
    v_sub_f32 v20, v76, v228
    v_sub_f32 v21, v77, v228
    v_cvt_pk_bf16_f32 v20, v20, v21
    v_and_b32 v21, s92, v20
    v_lshlrev_b32 v20, 16, v20
    v_mul_f32 v20, v20, v230
    v_mul_f32 v21, v21, v230
    v_cvt_pk_bf16_f32 v202, v20, v21
    ds_read_b128 v[52:55], v14 offset:24576
    s_waitcnt lgkmcnt(5)
    v_mfma_f32_16x16x32_bf16 v[96:99], v[32:35], v[56:59], v[96:99]
    s_add_u32 m0, s35, 0
    s_add_u32 s30, s38, 384
    buffer_load_dwordx4 v5, s[40:43], s30 offen lds
    v_sub_f32 v20, v78, v228
    v_sub_f32 v21, v79, v228
    v_cvt_pk_bf16_f32 v20, v20, v21
    v_and_b32 v21, s92, v20
    v_lshlrev_b32 v20, 16, v20
    v_mul_f32 v20, v20, v230
    v_mul_f32 v21, v21, v230
    v_cvt_pk_bf16_f32 v203, v20, v21
    v_sub_f32 v20, v88, v228
    v_mfma_f32_16x16x32_bf16 v[100:103], v[36:39], v[56:59], v[100:103]
    s_add_u32 m0, s35, 1024
    s_nop 0
    buffer_load_dwordx4 v6, s[40:43], s30 offen lds
    v_sub_f32 v21, v89, v228
    v_cvt_pk_bf16_f32 v20, v20, v21
    v_and_b32 v21, s92, v20
    v_lshlrev_b32 v20, 16, v20
    v_mul_f32 v20, v20, v230
    v_mul_f32 v21, v21, v230
    v_cvt_pk_bf16_f32 v204, v20, v21
    v_sub_f32 v20, v90, v228
    v_sub_f32 v21, v91, v228
    ds_read_b128 v[56:59], v14 offset:26624
    s_waitcnt lgkmcnt(3)
    v_mfma_f32_16x16x32_bf16 v[112:115], v[32:35], v[60:63], v[112:115]
    s_add_u32 m0, s35, 2048
    s_add_u32 s30, s38, 33152
    buffer_load_dwordx4 v5, s[40:43], s30 offen lds
    v_cvt_pk_bf16_f32 v20, v20, v21
    v_and_b32 v21, s92, v20
    v_lshlrev_b32 v20, 16, v20
    v_mul_f32 v20, v20, v230
    v_mul_f32 v21, v21, v230
    v_cvt_pk_bf16_f32 v205, v20, v21
    v_sub_f32 v20, v92, v228
    v_sub_f32 v21, v93, v228
    v_cvt_pk_bf16_f32 v20, v20, v21
    v_mfma_f32_16x16x32_bf16 v[116:119], v[36:39], v[60:63], v[116:119]
    s_add_u32 m0, s35, 3072
    s_nop 0
    buffer_load_dwordx4 v6, s[40:43], s30 offen lds
    v_and_b32 v21, s92, v20
    v_lshlrev_b32 v20, 16, v20
    v_mul_f32 v20, v20, v230
    v_mul_f32 v21, v21, v230
    v_cvt_pk_bf16_f32 v206, v20, v21
    v_sub_f32 v20, v94, v228
    v_sub_f32 v21, v95, v228
    v_cvt_pk_bf16_f32 v20, v20, v21
    ds_read_b128 v[60:63], v15 offset:14336
    s_waitcnt lgkmcnt(3)
    v_mfma_f32_16x16x32_bf16 v[128:131], v[32:35], v[48:51], v[128:131]
    v_and_b32 v21, s92, v20
    v_lshlrev_b32 v20, 16, v20
    v_mul_f32 v20, v20, v230
    v_mul_f32 v21, v21, v230
    v_cvt_pk_bf16_f32 v207, v20, v21
    v_sub_f32 v20, v104, v228
    v_sub_f32 v21, v105, v228
    v_cvt_pk_bf16_f32 v20, v20, v21
    v_and_b32 v21, s92, v20
    v_mfma_f32_16x16x32_bf16 v[132:135], v[36:39], v[48:51], v[132:135]
    v_lshlrev_b32 v20, 16, v20
    v_mul_f32 v20, v20, v230
    v_mul_f32 v21, v21, v230
    v_cvt_pk_bf16_f32 v208, v20, v21
    v_sub_f32 v20, v106, v228
    v_sub_f32 v21, v107, v228
    v_cvt_pk_bf16_f32 v20, v20, v21
    v_and_b32 v21, s92, v20
    v_lshlrev_b32 v20, 16, v20
    ds_read_b128 v[48:51], v15 offset:16384
    s_waitcnt lgkmcnt(3)
    v_mfma_f32_16x16x32_bf16 v[144:147], v[32:35], v[52:55], v[144:147]
    v_mul_f32 v20, v20, v230
    v_mul_f32 v21, v21, v230
    v_cvt_pk_bf16_f32 v209, v20, v21
    v_sub_f32 v20, v108, v228
    v_sub_f32 v21, v109, v228
    v_cvt_pk_bf16_f32 v20, v20, v21
    v_and_b32 v21, s92, v20
    v_lshlrev_b32 v20, 16, v20
    v_mfma_f32_16x16x32_bf16 v[148:151], v[36:39], v[52:55], v[148:151]
    v_mul_f32 v20, v20, v230
    v_mul_f32 v21, v21, v230
    v_cvt_pk_bf16_f32 v210, v20, v21
    v_sub_f32 v20, v110, v228
    v_sub_f32 v21, v111, v228
    v_cvt_pk_bf16_f32 v20, v20, v21
    v_and_b32 v21, s92, v20
    v_lshlrev_b32 v20, 16, v20
    v_mul_f32 v20, v20, v230
    ds_read_b128 v[52:55], v15 offset:18432
    s_waitcnt lgkmcnt(3)
    v_mfma_f32_16x16x32_bf16 v[160:163], v[32:35], v[56:59], v[160:163]
    v_mul_f32 v21, v21, v230
    v_cvt_pk_bf16_f32 v211, v20, v21
    v_sub_f32 v20, v120, v228
    v_sub_f32 v21, v121, v228
    v_cvt_pk_bf16_f32 v20, v20, v21
    v_and_b32 v21, s92, v20
    v_lshlrev_b32 v20, 16, v20
    v_mul_f32 v20, v20, v230
    v_mul_f32 v21, v21, v230
    v_mfma_f32_16x16x32_bf16 v[164:167], v[36:39], v[56:59], v[164:167]
    v_cvt_pk_bf16_f32 v212, v20, v21
    v_sub_f32 v20, v122, v228
    v_sub_f32 v21, v123, v228
    v_cvt_pk_bf16_f32 v20, v20, v21
    v_and_b32 v21, s92, v20
    v_lshlrev_b32 v20, 16, v20
    v_mul_f32 v20, v20, v230
    v_mul_f32 v21, v21, v230
    v_cvt_pk_bf16_f32 v213, v20, v21
    ds_read_b128 v[56:59], v15 offset:20480
    s_waitcnt lgkmcnt(3)
    v_mfma_f32_16x16x32_bf16 v[64:67], v[176:179], v[60:63], v[64:67]
    v_sub_f32 v20, v124, v228
    v_sub_f32 v21, v125, v228
    v_cvt_pk_bf16_f32 v20, v20, v21
    v_and_b32 v21, s92, v20
    v_lshlrev_b32 v20, 16, v20
    v_mul_f32 v20, v20, v230
    v_mul_f32 v21, v21, v230
    v_cvt_pk_bf16_f32 v214, v20, v21
    v_mfma_f32_16x16x32_bf16 v[68:71], v[180:183], v[60:63], v[68:71]
    v_sub_f32 v20, v126, v228
    v_sub_f32 v21, v127, v228
    v_cvt_pk_bf16_f32 v20, v20, v21
    v_and_b32 v21, s92, v20
    v_lshlrev_b32 v20, 16, v20
    v_mul_f32 v20, v20, v230
    v_mul_f32 v21, v21, v230
    v_cvt_pk_bf16_f32 v215, v20, v21
    v_sub_f32 v20, v136, v228
    ds_read_b128 v[60:63], v15 offset:22528
    s_waitcnt lgkmcnt(3)
    v_mfma_f32_16x16x32_bf16 v[80:83], v[176:179], v[48:51], v[80:83]
    v_sub_f32 v21, v137, v228
    v_cvt_pk_bf16_f32 v20, v20, v21
    v_and_b32 v21, s92, v20
    v_lshlrev_b32 v20, 16, v20
    v_mul_f32 v20, v20, v230
    v_mul_f32 v21, v21, v230
    v_cvt_pk_bf16_f32 v216, v20, v21
    v_sub_f32 v20, v138, v228
    v_sub_f32 v21, v139, v228
    v_mfma_f32_16x16x32_bf16 v[84:87], v[180:183], v[48:51], v[84:87]
    v_cvt_pk_bf16_f32 v20, v20, v21
    v_and_b32 v21, s92, v20
    v_lshlrev_b32 v20, 16, v20
    v_mul_f32 v20, v20, v230
    v_mul_f32 v21, v21, v230
    v_cvt_pk_bf16_f32 v217, v20, v21
    v_sub_f32 v20, v140, v228
    v_sub_f32 v21, v141, v228
    ds_read_b128 v[48:51], v15 offset:24576
    s_waitcnt lgkmcnt(3)
    v_mfma_f32_16x16x32_bf16 v[96:99], v[176:179], v[52:55], v[96:99]
    v_cvt_pk_bf16_f32 v20, v20, v21
    v_and_b32 v21, s92, v20
    v_lshlrev_b32 v20, 16, v20
    v_mul_f32 v20, v20, v230
    v_mul_f32 v21, v21, v230
    v_cvt_pk_bf16_f32 v218, v20, v21
    v_sub_f32 v20, v142, v228
    v_sub_f32 v21, v143, v228
    v_cvt_pk_bf16_f32 v20, v20, v21
    v_mfma_f32_16x16x32_bf16 v[100:103], v[180:183], v[52:55], v[100:103]
    v_and_b32 v21, s92, v20
    v_lshlrev_b32 v20, 16, v20
    v_mul_f32 v20, v20, v230
    v_mul_f32 v21, v21, v230
    v_cvt_pk_bf16_f32 v219, v20, v21
    v_sub_f32 v20, v152, v228
    v_sub_f32 v21, v153, v228
    v_cvt_pk_bf16_f32 v20, v20, v21
    v_and_b32 v21, s92, v20
    ds_read_b128 v[52:55], v15 offset:26624
    s_waitcnt lgkmcnt(3)
    v_mfma_f32_16x16x32_bf16 v[112:115], v[176:179], v[56:59], v[112:115]
    v_lshlrev_b32 v20, 16, v20
    v_mul_f32 v20, v20, v230
    v_mul_f32 v21, v21, v230
    v_cvt_pk_bf16_f32 v220, v20, v21
    v_sub_f32 v20, v154, v228
    v_sub_f32 v21, v155, v228
    v_cvt_pk_bf16_f32 v20, v20, v21
    v_and_b32 v21, s92, v20
    v_lshlrev_b32 v20, 16, v20
    v_mfma_f32_16x16x32_bf16 v[116:119], v[180:183], v[56:59], v[116:119]
    v_mul_f32 v20, v20, v230
    v_mul_f32 v21, v21, v230
    v_cvt_pk_bf16_f32 v221, v20, v21
    v_sub_f32 v20, v156, v228
    v_sub_f32 v21, v157, v228
    v_cvt_pk_bf16_f32 v20, v20, v21
    v_and_b32 v21, s92, v20
    v_lshlrev_b32 v20, 16, v20
    s_waitcnt lgkmcnt(2)
    v_mfma_f32_16x16x32_bf16 v[128:131], v[176:179], v[60:63], v[128:131]
    v_mul_f32 v20, v20, v230
    v_mul_f32 v21, v21, v230
    v_cvt_pk_bf16_f32 v222, v20, v21
    v_sub_f32 v20, v158, v228
    v_sub_f32 v21, v159, v228
    v_cvt_pk_bf16_f32 v20, v20, v21
    v_and_b32 v21, s92, v20
    v_lshlrev_b32 v20, 16, v20
    v_mul_f32 v20, v20, v230
    v_mfma_f32_16x16x32_bf16 v[132:135], v[180:183], v[60:63], v[132:135]
    v_mul_f32 v21, v21, v230
    v_cvt_pk_bf16_f32 v223, v20, v21
    v_sub_f32 v20, v168, v228
    v_sub_f32 v21, v169, v228
    v_cvt_pk_bf16_f32 v20, v20, v21
    v_and_b32 v21, s92, v20
    v_lshlrev_b32 v20, 16, v20
    v_mul_f32 v20, v20, v230
    v_mul_f32 v21, v21, v230
    s_waitcnt lgkmcnt(1)
    v_mfma_f32_16x16x32_bf16 v[144:147], v[176:179], v[48:51], v[144:147]
    v_cvt_pk_bf16_f32 v224, v20, v21
    v_sub_f32 v20, v170, v228
    v_sub_f32 v21, v171, v228
    v_cvt_pk_bf16_f32 v20, v20, v21
    v_and_b32 v21, s92, v20
    v_lshlrev_b32 v20, 16, v20
    v_mul_f32 v20, v20, v230
    v_mul_f32 v21, v21, v230
    v_mfma_f32_16x16x32_bf16 v[148:151], v[180:183], v[48:51], v[148:151]
    v_cvt_pk_bf16_f32 v225, v20, v21
    v_sub_f32 v20, v172, v228
    v_sub_f32 v21, v173, v228
    v_cvt_pk_bf16_f32 v20, v20, v21
    v_and_b32 v21, s92, v20
    v_lshlrev_b32 v20, 16, v20
    v_mul_f32 v20, v20, v230
    v_mul_f32 v21, v21, v230
    v_cvt_pk_bf16_f32 v226, v20, v21
    s_waitcnt lgkmcnt(0)
    v_mfma_f32_16x16x32_bf16 v[160:163], v[176:179], v[52:55], v[160:163]
    v_sub_f32 v20, v174, v228
    v_sub_f32 v21, v175, v228
    v_cvt_pk_bf16_f32 v20, v20, v21
    v_and_b32 v21, s92, v20
    v_lshlrev_b32 v20, 16, v20
    v_mul_f32 v20, v20, v230
    v_mul_f32 v21, v21, v230
    v_cvt_pk_bf16_f32 v227, v20, v21
    v_and_b32 v228, 1, v19
    v_mfma_f32_16x16x32_bf16 v[164:167], v[180:183], v[52:55], v[164:167]
    v_cmp_eq_u32 s[100:101], 1, v228
    s_lshr_b32 s93, s2, 2
    s_mul_i32 s93, s93, 28672
    s_and_b32 s92, s2, 3
    s_lshl_b32 s92, s92, 7
    s_add_u32 s93, s93, s92
    v_lshlrev_b32 v228, 9, v19
    v_lshl_add_u32 v228, v18, 4, v228
    v_add_u32 v228, s93, v228
    s_waitcnt vmcnt(9)
    s_barrier
    ds_read_b128 v[32:35], v12 offset:8192
    ds_read_b128 v[36:39], v12 offset:10240
    ds_read_b128 v[48:51], v14 offset:28672
    ds_read_b128 v[52:55], v14 offset:30720
    ds_read_b128 v[56:59], v14 offset:32768
    ds_read_b128 v[176:179], v13 offset:8192
    ds_read_b128 v[180:183], v13 offset:10240
    ds_read_b128 v[60:63], v14 offset:34816
    s_waitcnt lgkmcnt(5)
    v_mfma_f32_16x16x32_bf16 v[64:67], v[32:35], v[48:51], v[64:67]
    s_mov_b32 s33, 16056320
    buffer_store_dwordx4 v[200:203], v228, s[4:7], s33 offen sc1
    v_cndmask_b32 v24, v201, v200, s[100:101]
    v_mfma_f32_16x16x32_bf16 v[68:71], v[36:39], v[48:51], v[68:71]
    v_cndmask_b32 v25, v203, v202, s[100:101]
    v_mov_b32_dpp v24, v24 row_ror:8 row_mask:0xf bank_mask:0xf
    s_nop 0
    v_mov_b32_dpp v25, v25 row_ror:8 row_mask:0xf bank_mask:0xf
    ds_read_b128 v[48:51], v14 offset:36864
    s_waitcnt lgkmcnt(5)
    v_mfma_f32_16x16x32_bf16 v[80:83], v[32:35], v[52:55], v[80:83]
    v_cndmask_b32 v20, v200, v24, s[100:101]
    v_cndmask_b32 v21, v202, v25, s[100:101]
    v_cndmask_b32 v22, v24, v201, s[100:101]
    v_mfma_f32_16x16x32_bf16 v[84:87], v[36:39], v[52:55], v[84:87]
    v_cndmask_b32 v23, v25, v203, s[100:101]
    s_mov_b32 s34, 17891328
    buffer_store_dwordx4 v[20:23], v228, s[4:7], s34 offen sc1
    ds_read_b128 v[52:55], v14 offset:38912
    s_waitcnt lgkmcnt(5)
    v_mfma_f32_16x16x32_bf16 v[96:99], v[32:35], v[56:59], v[96:99]
    s_mov_b32 s33, 16060416
    buffer_store_dwordx4 v[204:207], v228, s[4:7], s33 offen sc1
    v_cndmask_b32 v30, v205, v204, s[100:101]
    v_mfma_f32_16x16x32_bf16 v[100:103], v[36:39], v[56:59], v[100:103]
    v_cndmask_b32 v31, v207, v206, s[100:101]
    v_mov_b32_dpp v30, v30 row_ror:8 row_mask:0xf bank_mask:0xf
    s_nop 0
    v_mov_b32_dpp v31, v31 row_ror:8 row_mask:0xf bank_mask:0xf
    ds_read_b128 v[56:59], v14 offset:40960
    s_waitcnt lgkmcnt(3)
    v_mfma_f32_16x16x32_bf16 v[112:115], v[32:35], v[60:63], v[112:115]
    v_cndmask_b32 v26, v204, v30, s[100:101]
    v_cndmask_b32 v27, v206, v31, s[100:101]
    v_cndmask_b32 v28, v30, v205, s[100:101]
    v_mfma_f32_16x16x32_bf16 v[116:119], v[36:39], v[60:63], v[116:119]
    v_cndmask_b32 v29, v31, v207, s[100:101]
    s_mov_b32 s34, 17895424
    buffer_store_dwordx4 v[26:29], v228, s[4:7], s34 offen sc1
    ds_read_b128 v[60:63], v15 offset:28672
    s_waitcnt lgkmcnt(3)
    v_mfma_f32_16x16x32_bf16 v[128:131], v[32:35], v[48:51], v[128:131]
    s_mov_b32 s33, 16064512
    buffer_store_dwordx4 v[208:211], v228, s[4:7], s33 offen sc1
    v_cndmask_b32 v24, v209, v208, s[100:101]
    v_mfma_f32_16x16x32_bf16 v[132:135], v[36:39], v[48:51], v[132:135]
    v_cndmask_b32 v25, v211, v210, s[100:101]
    v_mov_b32_dpp v24, v24 row_ror:8 row_mask:0xf bank_mask:0xf
    s_nop 0
    v_mov_b32_dpp v25, v25 row_ror:8 row_mask:0xf bank_mask:0xf
    ds_read_b128 v[48:51], v15 offset:30720
    s_waitcnt lgkmcnt(3)
    v_mfma_f32_16x16x32_bf16 v[144:147], v[32:35], v[52:55], v[144:147]
    v_cndmask_b32 v20, v208, v24, s[100:101]
    v_cndmask_b32 v21, v210, v25, s[100:101]
    v_cndmask_b32 v22, v24, v209, s[100:101]
    v_mfma_f32_16x16x32_bf16 v[148:151], v[36:39], v[52:55], v[148:151]
    v_cndmask_b32 v23, v25, v211, s[100:101]
    s_mov_b32 s34, 17899520
    buffer_store_dwordx4 v[20:23], v228, s[4:7], s34 offen sc1
    ds_read_b128 v[52:55], v15 offset:32768
    s_waitcnt lgkmcnt(3)
    v_mfma_f32_16x16x32_bf16 v[160:163], v[32:35], v[56:59], v[160:163]
    s_mov_b32 s33, 16068608
    buffer_store_dwordx4 v[212:215], v228, s[4:7], s33 offen sc1
    v_cndmask_b32 v30, v213, v212, s[100:101]
    v_mfma_f32_16x16x32_bf16 v[164:167], v[36:39], v[56:59], v[164:167]
    v_cndmask_b32 v31, v215, v214, s[100:101]
    v_mov_b32_dpp v30, v30 row_ror:8 row_mask:0xf bank_mask:0xf
    s_nop 0
    v_mov_b32_dpp v31, v31 row_ror:8 row_mask:0xf bank_mask:0xf
    ds_read_b128 v[56:59], v15 offset:34816
    s_waitcnt lgkmcnt(3)
    v_mfma_f32_16x16x32_bf16 v[64:67], v[176:179], v[60:63], v[64:67]
    v_cndmask_b32 v26, v212, v30, s[100:101]
    v_cndmask_b32 v27, v214, v31, s[100:101]
    v_cndmask_b32 v28, v30, v213, s[100:101]
    v_mfma_f32_16x16x32_bf16 v[68:71], v[180:183], v[60:63], v[68:71]
    v_cndmask_b32 v29, v31, v215, s[100:101]
    s_mov_b32 s34, 17903616
    buffer_store_dwordx4 v[26:29], v228, s[4:7], s34 offen sc1
    ds_read_b128 v[60:63], v15 offset:36864
    s_waitcnt lgkmcnt(3)
    v_mfma_f32_16x16x32_bf16 v[80:83], v[176:179], v[48:51], v[80:83]
    s_mov_b32 s33, 16072704
    buffer_store_dwordx4 v[216:219], v228, s[4:7], s33 offen sc1
    v_cndmask_b32 v24, v217, v216, s[100:101]
    v_mfma_f32_16x16x32_bf16 v[84:87], v[180:183], v[48:51], v[84:87]
    v_cndmask_b32 v25, v219, v218, s[100:101]
    v_mov_b32_dpp v24, v24 row_ror:8 row_mask:0xf bank_mask:0xf
    s_nop 0
    v_mov_b32_dpp v25, v25 row_ror:8 row_mask:0xf bank_mask:0xf
    ds_read_b128 v[48:51], v15 offset:38912
    s_waitcnt lgkmcnt(3)
    v_mfma_f32_16x16x32_bf16 v[96:99], v[176:179], v[52:55], v[96:99]
    v_cndmask_b32 v20, v216, v24, s[100:101]
    v_cndmask_b32 v21, v218, v25, s[100:101]
    v_cndmask_b32 v22, v24, v217, s[100:101]
    v_mfma_f32_16x16x32_bf16 v[100:103], v[180:183], v[52:55], v[100:103]
    v_cndmask_b32 v23, v25, v219, s[100:101]
    s_mov_b32 s34, 17907712
    buffer_store_dwordx4 v[20:23], v228, s[4:7], s34 offen sc1
    ds_read_b128 v[52:55], v15 offset:40960
    s_waitcnt lgkmcnt(3)
    v_mfma_f32_16x16x32_bf16 v[112:115], v[176:179], v[56:59], v[112:115]
    s_mov_b32 s33, 16076800
    buffer_store_dwordx4 v[220:223], v228, s[4:7], s33 offen sc1
    v_cndmask_b32 v30, v221, v220, s[100:101]
    v_mfma_f32_16x16x32_bf16 v[116:119], v[180:183], v[56:59], v[116:119]
    v_cndmask_b32 v31, v223, v222, s[100:101]
    v_mov_b32_dpp v30, v30 row_ror:8 row_mask:0xf bank_mask:0xf
    s_nop 0
    v_mov_b32_dpp v31, v31 row_ror:8 row_mask:0xf bank_mask:0xf
    s_waitcnt lgkmcnt(2)
    v_mfma_f32_16x16x32_bf16 v[128:131], v[176:179], v[60:63], v[128:131]
    v_cndmask_b32 v26, v220, v30, s[100:101]
    v_cndmask_b32 v27, v222, v31, s[100:101]
    v_cndmask_b32 v28, v30, v221, s[100:101]
    v_mfma_f32_16x16x32_bf16 v[132:135], v[180:183], v[60:63], v[132:135]
    v_cndmask_b32 v29, v31, v223, s[100:101]
    s_mov_b32 s34, 17911808
    buffer_store_dwordx4 v[26:29], v228, s[4:7], s34 offen sc1
    s_waitcnt lgkmcnt(1)
    v_mfma_f32_16x16x32_bf16 v[144:147], v[176:179], v[48:51], v[144:147]
    s_mov_b32 s33, 16080896
    buffer_store_dwordx4 v[224:227], v228, s[4:7], s33 offen sc1
    v_cndmask_b32 v24, v225, v224, s[100:101]
    v_mfma_f32_16x16x32_bf16 v[148:151], v[180:183], v[48:51], v[148:151]
    v_cndmask_b32 v25, v227, v226, s[100:101]
    v_mov_b32_dpp v24, v24 row_ror:8 row_mask:0xf bank_mask:0xf
    s_nop 0
    v_mov_b32_dpp v25, v25 row_ror:8 row_mask:0xf bank_mask:0xf
    s_waitcnt lgkmcnt(0)
    v_mfma_f32_16x16x32_bf16 v[160:163], v[176:179], v[52:55], v[160:163]
    v_cndmask_b32 v20, v224, v24, s[100:101]
    v_cndmask_b32 v21, v226, v25, s[100:101]
    v_cndmask_b32 v22, v24, v225, s[100:101]
    v_mfma_f32_16x16x32_bf16 v[164:167], v[180:183], v[52:55], v[164:167]
    v_cndmask_b32 v23, v25, v227, s[100:101]
    s_mov_b32 s34, 17915904
    buffer_store_dwordx4 v[20:23], v228, s[4:7], s34 offen sc1
    s_waitcnt vmcnt(14)
    s_barrier
    ds_read_b128 v[32:35], v12 offset:0
    ds_read_b128 v[36:39], v12 offset:2048
    ds_read_b128 v[48:51], v14 offset:43008
    ds_read_b128 v[52:55], v14 offset:45056
    ds_read_b128 v[56:59], v14 offset:47104
    ds_read_b128 v[176:179], v13 offset:0
    ds_read_b128 v[180:183], v13 offset:2048
    ds_read_b128 v[60:63], v14 offset:49152
    s_waitcnt lgkmcnt(5)
    v_mfma_f32_16x16x32_bf16 v[64:67], v[32:35], v[48:51], v[64:67]
    v_mfma_f32_16x16x32_bf16 v[68:71], v[36:39], v[48:51], v[68:71]
    ds_read_b128 v[48:51], v14 offset:51200
    s_waitcnt lgkmcnt(5)
    v_mfma_f32_16x16x32_bf16 v[80:83], v[32:35], v[52:55], v[80:83]
    v_mfma_f32_16x16x32_bf16 v[84:87], v[36:39], v[52:55], v[84:87]
    ds_read_b128 v[52:55], v14 offset:53248
    s_waitcnt lgkmcnt(5)
    v_mfma_f32_16x16x32_bf16 v[96:99], v[32:35], v[56:59], v[96:99]
    v_mfma_f32_16x16x32_bf16 v[100:103], v[36:39], v[56:59], v[100:103]
    ds_read_b128 v[56:59], v14 offset:55296
    s_waitcnt lgkmcnt(3)
    v_mfma_f32_16x16x32_bf16 v[112:115], v[32:35], v[60:63], v[112:115]
    v_mfma_f32_16x16x32_bf16 v[116:119], v[36:39], v[60:63], v[116:119]
    ds_read_b128 v[60:63], v15 offset:43008
    s_waitcnt lgkmcnt(3)
    v_mfma_f32_16x16x32_bf16 v[128:131], v[32:35], v[48:51], v[128:131]
    v_mfma_f32_16x16x32_bf16 v[132:135], v[36:39], v[48:51], v[132:135]
    ds_read_b128 v[48:51], v15 offset:45056
    s_waitcnt lgkmcnt(3)
    v_mfma_f32_16x16x32_bf16 v[144:147], v[32:35], v[52:55], v[144:147]
    v_mfma_f32_16x16x32_bf16 v[148:151], v[36:39], v[52:55], v[148:151]
    ds_read_b128 v[52:55], v15 offset:47104
    s_waitcnt lgkmcnt(3)
    v_mfma_f32_16x16x32_bf16 v[160:163], v[32:35], v[56:59], v[160:163]
    v_mfma_f32_16x16x32_bf16 v[164:167], v[36:39], v[56:59], v[164:167]
    ds_read_b128 v[56:59], v15 offset:49152
    s_waitcnt lgkmcnt(3)
    v_mfma_f32_16x16x32_bf16 v[64:67], v[176:179], v[60:63], v[64:67]
    v_mfma_f32_16x16x32_bf16 v[68:71], v[180:183], v[60:63], v[68:71]
    ds_read_b128 v[60:63], v15 offset:51200
    s_waitcnt lgkmcnt(3)
    v_mfma_f32_16x16x32_bf16 v[80:83], v[176:179], v[48:51], v[80:83]
    v_mfma_f32_16x16x32_bf16 v[84:87], v[180:183], v[48:51], v[84:87]
    ds_read_b128 v[48:51], v15 offset:53248
    s_waitcnt lgkmcnt(3)
    v_mfma_f32_16x16x32_bf16 v[96:99], v[176:179], v[52:55], v[96:99]
    v_mfma_f32_16x16x32_bf16 v[100:103], v[180:183], v[52:55], v[100:103]
    ds_read_b128 v[52:55], v15 offset:55296
    s_waitcnt lgkmcnt(3)
    v_mfma_f32_16x16x32_bf16 v[112:115], v[176:179], v[56:59], v[112:115]
    v_mfma_f32_16x16x32_bf16 v[116:119], v[180:183], v[56:59], v[116:119]
    s_waitcnt lgkmcnt(2)
    v_mfma_f32_16x16x32_bf16 v[128:131], v[176:179], v[60:63], v[128:131]
    v_mfma_f32_16x16x32_bf16 v[132:135], v[180:183], v[60:63], v[132:135]
    s_waitcnt lgkmcnt(1)
    v_mfma_f32_16x16x32_bf16 v[144:147], v[176:179], v[48:51], v[144:147]
    v_mfma_f32_16x16x32_bf16 v[148:151], v[180:183], v[48:51], v[148:151]
    s_waitcnt lgkmcnt(0)
    v_mfma_f32_16x16x32_bf16 v[160:163], v[176:179], v[52:55], v[160:163]
    v_mfma_f32_16x16x32_bf16 v[164:167], v[180:183], v[52:55], v[164:167]
    s_branch p0_e3
p0_gB3:
    s_waitcnt vmcnt(9)
    s_barrier
    ds_read_b128 v[32:35], v12 offset:0
    ds_read_b128 v[36:39], v12 offset:2048
    ds_read_b64_tr_b16 v[48:49], v16 offset:0
    ds_read_b64_tr_b16 v[50:51], v16 offset:896
    ds_read_b64_tr_b16 v[52:53], v16 offset:32
    ds_read_b64_tr_b16 v[54:55], v16 offset:928
    ds_read_b64_tr_b16 v[56:57], v16 offset:64
    ds_read_b64_tr_b16 v[58:59], v16 offset:960
    ds_read_b128 v[176:179], v13 offset:0
    ds_read_b128 v[180:183], v13 offset:2048
    ds_read_b64_tr_b16 v[60:61], v16 offset:96
    ds_read_b64_tr_b16 v[62:63], v16 offset:992
    s_waitcnt lgkmcnt(8)
    v_mfma_f32_16x16x32_bf16 v[64:67], v[32:35], v[48:51], 0
    s_add_u32 m0, s56, 28672
    s_nop 0
    buffer_load_dwordx4 v8, s[44:47], s52 offen lds
    s_add_u32 s52, s52, s39
    s_mov_b32 s92, 0xffff0000
    v_lshlrev_b32 v72, 16, v200
    v_and_b32 v73, s92, v200
    v_lshlrev_b32 v74, 16, v201
    v_and_b32 v75, s92, v201
    v_lshlrev_b32 v76, 16, v202
    v_and_b32 v77, s92, v202
    v_lshlrev_b32 v78, 16, v203
    v_mfma_f32_16x16x32_bf16 v[68:71], v[36:39], v[48:51], 0
    s_add_u32 m0, s57, 28672
    s_nop 0
    buffer_load_dwordx4 v9, s[44:47], s53 offen lds
    s_add_u32 s53, s53, s39
    v_and_b32 v79, s92, v203
    v_lshlrev_b32 v88, 16, v204
    v_and_b32 v89, s92, v204
    v_lshlrev_b32 v90, 16, v205
    v_and_b32 v91, s92, v205
    v_lshlrev_b32 v92, 16, v206
    v_and_b32 v93, s92, v206
    v_lshlrev_b32 v94, 16, v207
    v_and_b32 v95, s92, v207
    ds_read_b64_tr_b16 v[48:49], v16 offset:128
    ds_read_b64_tr_b16 v[50:51], v16 offset:1024
    s_waitcnt lgkmcnt(8)
    v_mfma_f32_16x16x32_bf16 v[80:83], v[32:35], v[52:55], 0
    s_add_u32 m0, s58, 28672
    s_nop 0
    buffer_load_dwordx4 v10, s[44:47], s54 offen lds
    s_add_u32 s54, s54, s39
    v_lshlrev_b32 v104, 16, v208
    v_and_b32 v105, s92, v208
    v_lshlrev_b32 v106, 16, v209
    v_and_b32 v107, s92, v209
    v_lshlrev_b32 v108, 16, v210
    v_and_b32 v109, s92, v210
    v_lshlrev_b32 v110, 16, v211
    v_and_b32 v111, s92, v211
    v_lshlrev_b32 v120, 16, v212
    v_mfma_f32_16x16x32_bf16 v[84:87], v[36:39], v[52:55], 0
    s_add_u32 m0, s59, 28672
    s_nop 0
    buffer_load_dwordx4 v11, s[44:47], s55 offen lds
    s_add_u32 s55, s55, s39
    v_and_b32 v121, s92, v212
    v_lshlrev_b32 v122, 16, v213
    v_and_b32 v123, s92, v213
    v_lshlrev_b32 v124, 16, v214
    v_and_b32 v125, s92, v214
    v_lshlrev_b32 v126, 16, v215
    v_and_b32 v127, s92, v215
    v_lshlrev_b32 v136, 16, v216
    ds_read_b64_tr_b16 v[52:53], v16 offset:160
    ds_read_b64_tr_b16 v[54:55], v16 offset:1056
    s_waitcnt lgkmcnt(8)
    v_mfma_f32_16x16x32_bf16 v[96:99], v[32:35], v[56:59], 0
    s_add_u32 m0, s35, 8192
    s_add_u32 s30, s38, 256
    buffer_load_dwordx4 v5, s[40:43], s30 offen lds
    v_and_b32 v137, s92, v216
    v_lshlrev_b32 v138, 16, v217
    v_and_b32 v139, s92, v217
    v_lshlrev_b32 v140, 16, v218
    v_and_b32 v141, s92, v218
    v_lshlrev_b32 v142, 16, v219
    v_and_b32 v143, s92, v219
    v_lshlrev_b32 v152, 16, v220
    v_and_b32 v153, s92, v220
    v_mfma_f32_16x16x32_bf16 v[100:103], v[36:39], v[56:59], 0
    s_add_u32 m0, s35, 9216
    s_nop 0
    buffer_load_dwordx4 v6, s[40:43], s30 offen lds
    v_lshlrev_b32 v154, 16, v221
    v_and_b32 v155, s92, v221
    v_lshlrev_b32 v156, 16, v222
    v_and_b32 v157, s92, v222
    v_lshlrev_b32 v158, 16, v223
    v_and_b32 v159, s92, v223
    v_lshlrev_b32 v168, 16, v224
    v_and_b32 v169, s92, v224
    v_lshlrev_b32 v170, 16, v225
    ds_read_b64_tr_b16 v[56:57], v16 offset:192
    ds_read_b64_tr_b16 v[58:59], v16 offset:1088
    s_waitcnt lgkmcnt(6)
    v_mfma_f32_16x16x32_bf16 v[112:115], v[32:35], v[60:63], 0
    s_add_u32 m0, s35, 10240
    s_add_u32 s30, s38, 33024
    buffer_load_dwordx4 v5, s[40:43], s30 offen lds
    v_and_b32 v171, s92, v225
    v_lshlrev_b32 v172, 16, v226
    v_and_b32 v173, s92, v226
    v_lshlrev_b32 v174, 16, v227
    v_and_b32 v175, s92, v227
    v_add_f32 v228, v72, v73
    v_add_f32 v229, v74, v75
    v_add_f32 v228, v228, v76
    v_add_f32 v229, v229, v77
    v_mfma_f32_16x16x32_bf16 v[116:119], v[36:39], v[60:63], 0
    s_add_u32 m0, s35, 11264
    s_nop 0
    buffer_load_dwordx4 v6, s[40:43], s30 offen lds
    v_add_f32 v228, v228, v78
    v_add_f32 v229, v229, v79
    v_add_f32 v228, v228, v88
    v_add_f32 v229, v229, v89
    v_add_f32 v228, v228, v90
    v_add_f32 v229, v229, v91
    v_add_f32 v228, v228, v92
    v_add_f32 v229, v229, v93
    ds_read_b64_tr_b16 v[60:61], v16 offset:7168
    ds_read_b64_tr_b16 v[62:63], v16 offset:8064
    s_waitcnt lgkmcnt(6)
    v_mfma_f32_16x16x32_bf16 v[128:131], v[32:35], v[48:51], 0
    v_add_f32 v228, v228, v94
    v_add_f32 v229, v229, v95
    v_add_f32 v228, v228, v104
    v_add_f32 v229, v229, v105
    v_add_f32 v228, v228, v106
    v_add_f32 v229, v229, v107
    v_add_f32 v228, v228, v108
    v_add_f32 v229, v229, v109
    v_add_f32 v228, v228, v110
    v_mfma_f32_16x16x32_bf16 v[132:135], v[36:39], v[48:51], 0
    v_add_f32 v229, v229, v111
    v_add_f32 v228, v228, v120
    v_add_f32 v229, v229, v121
    v_add_f32 v228, v228, v122
    v_add_f32 v229, v229, v123
    v_add_f32 v228, v228, v124
    v_add_f32 v229, v229, v125
    v_add_f32 v228, v228, v126
    v_add_f32 v229, v229, v127
    ds_read_b64_tr_b16 v[48:49], v16 offset:7200
    ds_read_b64_tr_b16 v[50:51], v16 offset:8096
    s_waitcnt lgkmcnt(6)
    v_mfma_f32_16x16x32_bf16 v[144:147], v[32:35], v[52:55], 0
    v_add_f32 v228, v228, v136
    v_add_f32 v229, v229, v137
    v_add_f32 v228, v228, v138
    v_add_f32 v229, v229, v139
    v_add_f32 v228, v228, v140
    v_add_f32 v229, v229, v141
    v_add_f32 v228, v228, v142
    v_add_f32 v229, v229, v143
    v_mfma_f32_16x16x32_bf16 v[148:151], v[36:39], v[52:55], 0
    v_add_f32 v228, v228, v152
    v_add_f32 v229, v229, v153
    v_add_f32 v228, v228, v154
    v_add_f32 v229, v229, v155
    v_add_f32 v228, v228, v156
    v_add_f32 v229, v229, v157
    v_add_f32 v228, v228, v158
    v_add_f32 v229, v229, v159
    v_add_f32 v228, v228, v168
    ds_read_b64_tr_b16 v[52:53], v16 offset:7232
    ds_read_b64_tr_b16 v[54:55], v16 offset:8128
    s_waitcnt lgkmcnt(6)
    v_mfma_f32_16x16x32_bf16 v[160:163], v[32:35], v[56:59], 0
    v_add_f32 v229, v229, v169
    v_add_f32 v228, v228, v170
    v_add_f32 v229, v229, v171
    v_add_f32 v228, v228, v172
    v_add_f32 v229, v229, v173
    v_add_f32 v228, v228, v174
    v_add_f32 v229, v229, v175
    v_add_f32 v228, v228, v229
    s_nop 1
    v_add_f32_dpp v228, v228, v228 row_ror:8 row_mask:0xf bank_mask:0xf
    v_mfma_f32_16x16x32_bf16 v[164:167], v[36:39], v[56:59], 0
    v_mov_b32 v229, v228
    s_nop 1
    v_permlane16_swap_b32 v228, v229
    v_add_f32 v228, v228, v229
    v_mov_b32 v229, v228
    s_nop 1
    v_permlane32_swap_b32 v228, v229
    v_add_f32 v228, v228, v229
    v_mul_f32 v228, 0x3b124925, v228
    v_mov_b32 v230, 0
    v_mov_b32 v231, 0
    ds_read_b64_tr_b16 v[56:57], v16 offset:7264
    ds_read_b64_tr_b16 v[58:59], v16 offset:8160
    s_waitcnt lgkmcnt(6)
    v_mfma_f32_16x16x32_bf16 v[64:67], v[176:179], v[60:63], v[64:67]
    v_sub_f32 v20, v72, v228
    v_sub_f32 v21, v73, v228
    v_fmac_f32 v230, v20, v20
    v_fmac_f32 v231, v21, v21
    v_sub_f32 v20, v74, v228
    v_sub_f32 v21, v75, v228
    v_fmac_f32 v230, v20, v20
    v_fmac_f32 v231, v21, v21
    v_mfma_f32_16x16x32_bf16 v[68:71], v[180:183], v[60:63], v[68:71]
    v_sub_f32 v20, v76, v228
    v_sub_f32 v21, v77, v228
    v_fmac_f32 v230, v20, v20
    v_fmac_f32 v231, v21, v21
    v_sub_f32 v20, v78, v228
    v_sub_f32 v21, v79, v228
    v_fmac_f32 v230, v20, v20
    v_fmac_f32 v231, v21, v21
    v_sub_f32 v20, v88, v228
    ds_read_b64_tr_b16 v[60:61], v16 offset:7296
    ds_read_b64_tr_b16 v[62:63], v16 offset:8192
    s_waitcnt lgkmcnt(6)
    v_mfma_f32_16x16x32_bf16 v[80:83], v[176:179], v[48:51], v[80:83]
    v_sub_f32 v21, v89, v228
    v_fmac_f32 v230, v20, v20
    v_fmac_f32 v231, v21, v21
    v_sub_f32 v20, v90, v228
    v_sub_f32 v21, v91, v228
    v_fmac_f32 v230, v20, v20
    v_fmac_f32 v231, v21, v21
    v_sub_f32 v20, v92, v228
    v_sub_f32 v21, v93, v228
    v_mfma_f32_16x16x32_bf16 v[84:87], v[180:183], v[48:51], v[84:87]
    v_fmac_f32 v230, v20, v20
    v_fmac_f32 v231, v21, v21
    v_sub_f32 v20, v94, v228
    v_sub_f32 v21, v95, v228
    v_fmac_f32 v230, v20, v20
    v_fmac_f32 v231, v21, v21
    v_sub_f32 v20, v104, v228
    v_sub_f32 v21, v105, v228
    ds_read_b64_tr_b16 v[48:49], v16 offset:7328
    ds_read_b64_tr_b16 v[50:51], v16 offset:8224
    s_waitcnt lgkmcnt(6)
    v_mfma_f32_16x16x32_bf16 v[96:99], v[176:179], v[52:55], v[96:99]
    v_fmac_f32 v230, v20, v20
    v_fmac_f32 v231, v21, v21
    v_sub_f32 v20, v106, v228
    v_sub_f32 v21, v107, v228
    v_fmac_f32 v230, v20, v20
    v_fmac_f32 v231, v21, v21
    v_sub_f32 v20, v108, v228
    v_sub_f32 v21, v109, v228
    v_fmac_f32 v230, v20, v20
    v_mfma_f32_16x16x32_bf16 v[100:103], v[180:183], v[52:55], v[100:103]
    v_fmac_f32 v231, v21, v21
    v_sub_f32 v20, v110, v228
    v_sub_f32 v21, v111, v228
    v_fmac_f32 v230, v20, v20
    v_fmac_f32 v231, v21, v21
    v_sub_f32 v20, v120, v228
    v_sub_f32 v21, v121, v228
    v_fmac_f32 v230, v20, v20
    v_fmac_f32 v231, v21, v21
    ds_read_b64_tr_b16 v[52:53], v16 offset:7360
    ds_read_b64_tr_b16 v[54:55], v16 offset:8256
    s_waitcnt lgkmcnt(6)
    v_mfma_f32_16x16x32_bf16 v[112:115], v[176:179], v[56:59], v[112:115]
    v_sub_f32 v20, v122, v228
    v_sub_f32 v21, v123, v228
    v_fmac_f32 v230, v20, v20
    v_fmac_f32 v231, v21, v21
    v_sub_f32 v20, v124, v228
    v_sub_f32 v21, v125, v228
    v_fmac_f32 v230, v20, v20
    v_fmac_f32 v231, v21, v21
    v_sub_f32 v20, v126, v228
    v_mfma_f32_16x16x32_bf16 v[116:119], v[180:183], v[56:59], v[116:119]
    v_sub_f32 v21, v127, v228
    v_fmac_f32 v230, v20, v20
    v_fmac_f32 v231, v21, v21
    v_sub_f32 v20, v136, v228
    v_sub_f32 v21, v137, v228
    v_fmac_f32 v230, v20, v20
    v_fmac_f32 v231, v21, v21
    v_sub_f32 v20, v138, v228
    s_waitcnt lgkmcnt(4)
    v_mfma_f32_16x16x32_bf16 v[128:131], v[176:179], v[60:63], v[128:131]
    v_sub_f32 v21, v139, v228
    v_fmac_f32 v230, v20, v20
    v_fmac_f32 v231, v21, v21
    v_sub_f32 v20, v140, v228
    v_sub_f32 v21, v141, v228
    v_fmac_f32 v230, v20, v20
    v_fmac_f32 v231, v21, v21
    v_sub_f32 v20, v142, v228
    v_sub_f32 v21, v143, v228
    v_mfma_f32_16x16x32_bf16 v[132:135], v[180:183], v[60:63], v[132:135]
    v_fmac_f32 v230, v20, v20
    v_fmac_f32 v231, v21, v21
    v_sub_f32 v20, v152, v228
    v_sub_f32 v21, v153, v228
    v_fmac_f32 v230, v20, v20
    v_fmac_f32 v231, v21, v21
    v_sub_f32 v20, v154, v228
    v_sub_f32 v21, v155, v228
    v_fmac_f32 v230, v20, v20
    s_waitcnt lgkmcnt(2)
    v_mfma_f32_16x16x32_bf16 v[144:147], v[176:179], v[48:51], v[144:147]
    v_fmac_f32 v231, v21, v21
    v_sub_f32 v20, v156, v228
    v_sub_f32 v21, v157, v228
    v_fmac_f32 v230, v20, v20
    v_fmac_f32 v231, v21, v21
    v_sub_f32 v20, v158, v228
    v_sub_f32 v21, v159, v228
    v_fmac_f32 v230, v20, v20
    v_mfma_f32_16x16x32_bf16 v[148:151], v[180:183], v[48:51], v[148:151]
    v_fmac_f32 v231, v21, v21
    v_sub_f32 v20, v168, v228
    v_sub_f32 v21, v169, v228
    v_fmac_f32 v230, v20, v20
    v_fmac_f32 v231, v21, v21
    v_sub_f32 v20, v170, v228
    v_sub_f32 v21, v171, v228
    v_fmac_f32 v230, v20, v20
    v_fmac_f32 v231, v21, v21
    s_waitcnt lgkmcnt(0)
    v_mfma_f32_16x16x32_bf16 v[160:163], v[176:179], v[52:55], v[160:163]
    v_sub_f32 v20, v172, v228
    v_sub_f32 v21, v173, v228
    v_fmac_f32 v230, v20, v20
    v_fmac_f32 v231, v21, v21
    v_sub_f32 v20, v174, v228
    v_sub_f32 v21, v175, v228
    v_fmac_f32 v230, v20, v20
    v_fmac_f32 v231, v21, v21
    v_add_f32 v230, v230, v231
    v_mfma_f32_16x16x32_bf16 v[164:167], v[180:183], v[52:55], v[164:167]
    s_nop 0
    v_add_f32_dpp v230, v230, v230 row_ror:8 row_mask:0xf bank_mask:0xf
    v_mov_b32 v229, v230
    s_nop 1
    v_permlane16_swap_b32 v230, v229
    v_add_f32 v230, v230, v229
    v_mov_b32 v229, v230
    s_nop 1
    v_permlane32_swap_b32 v230, v229
    v_add_f32 v230, v230, v229
    v_mul_f32 v230, 0x3b124925, v230
    v_cvt_pk_bf16_f32 v228, v228, v228
    s_waitcnt vmcnt(8)
    s_barrier
    buffer_atomic_add v1, v2, s[48:51], 0 offen sc0 sc1
    ds_read_b128 v[32:35], v12 offset:4096
    ds_read_b128 v[36:39], v12 offset:6144
    ds_read_b64_tr_b16 v[48:49], v16 offset:14336
    ds_read_b64_tr_b16 v[50:51], v16 offset:15232
    ds_read_b64_tr_b16 v[52:53], v16 offset:14368
    ds_read_b64_tr_b16 v[54:55], v16 offset:15264
    ds_read_b64_tr_b16 v[56:57], v16 offset:14400
    ds_read_b64_tr_b16 v[58:59], v16 offset:15296
    ds_read_b128 v[176:179], v13 offset:4096
    ds_read_b128 v[180:183], v13 offset:6144
    ds_read_b64_tr_b16 v[60:61], v16 offset:14432
    ds_read_b64_tr_b16 v[62:63], v16 offset:15328
    s_waitcnt lgkmcnt(8)
    v_mfma_f32_16x16x32_bf16 v[64:67], v[32:35], v[48:51], v[64:67]
    s_add_u32 m0, s56, 43008
    s_nop 0
    buffer_load_dwordx4 v8, s[44:47], s52 offen lds
    s_add_u32 s52, s52, s39
    v_lshlrev_b32 v228, 16, v228
    v_cvt_pk_bf16_f32 v230, v230, v230
    v_lshlrev_b32 v230, 16, v230
    v_add_f32 v230, 0x3727c5ac, v230
    v_cvt_pk_bf16_f32 v230, v230, v230
    v_lshlrev_b32 v230, 16, v230
    v_sqrt_f32 v230, v230
    s_nop 0
    v_cvt_pk_bf16_f32 v230, v230, v230
    v_mfma_f32_16x16x32_bf16 v[68:71], v[36:39], v[48:51], v[68:71]
    s_add_u32 m0, s57, 43008
    s_nop 0
    buffer_load_dwordx4 v9, s[44:47], s53 offen lds
    s_add_u32 s53, s53, s39
    v_lshlrev_b32 v230, 16, v230
    v_rcp_f32 v230, v230
    v_sub_f32 v20, v72, v228
    v_sub_f32 v21, v73, v228
    v_cvt_pk_bf16_f32 v20, v20, v21
    v_and_b32 v21, s92, v20
    v_lshlrev_b32 v20, 16, v20
    v_mul_f32 v20, v20, v230
    v_mul_f32 v21, v21, v230
    ds_read_b64_tr_b16 v[48:49], v16 offset:14464
    ds_read_b64_tr_b16 v[50:51], v16 offset:15360
    s_waitcnt lgkmcnt(8)
    v_mfma_f32_16x16x32_bf16 v[80:83], v[32:35], v[52:55], v[80:83]
    s_add_u32 m0, s58, 43008
    s_nop 0
    buffer_load_dwordx4 v10, s[44:47], s54 offen lds
    s_add_u32 s54, s54, s39
    v_cvt_pk_bf16_f32 v200, v20, v21
    v_sub_f32 v20, v74, v228
    v_sub_f32 v21, v75, v228
    v_cvt_pk_bf16_f32 v20, v20, v21
    v_and_b32 v21, s92, v20
    v_lshlrev_b32 v20, 16, v20
    v_mul_f32 v20, v20, v230
    v_mul_f32 v21, v21, v230
    v_cvt_pk_bf16_f32 v201, v20, v21
    v_mfma_f32_16x16x32_bf16 v[84:87], v[36:39], v[52:55], v[84:87]
    s_add_u32 m0, s59, 43008
    s_nop 0
    buffer_load_dwordx4 v11, s[44:47], s55 offen lds
    s_add_u32 s55, s55, s39
    v_sub_f32 v20, v76, v228
    v_sub_f32 v21, v77, v228
    v_cvt_pk_bf16_f32 v20, v20, v21
    v_and_b32 v21, s92, v20
    v_lshlrev_b32 v20, 16, v20
    v_mul_f32 v20, v20, v230
    v_mul_f32 v21, v21, v230
    v_cvt_pk_bf16_f32 v202, v20, v21
    ds_read_b64_tr_b16 v[52:53], v16 offset:14496
    ds_read_b64_tr_b16 v[54:55], v16 offset:15392
    s_waitcnt lgkmcnt(8)
    v_mfma_f32_16x16x32_bf16 v[96:99], v[32:35], v[56:59], v[96:99]
    s_add_u32 m0, s35, 0
    s_add_u32 s30, s38, 384
    buffer_load_dwordx4 v5, s[40:43], s30 offen lds
    v_sub_f32 v20, v78, v228
    v_sub_f32 v21, v79, v228
    v_cvt_pk_bf16_f32 v20, v20, v21
    v_and_b32 v21, s92, v20
    v_lshlrev_b32 v20, 16, v20
    v_mul_f32 v20, v20, v230
    v_mul_f32 v21, v21, v230
    v_cvt_pk_bf16_f32 v203, v20, v21
    v_sub_f32 v20, v88, v228
    v_mfma_f32_16x16x32_bf16 v[100:103], v[36:39], v[56:59], v[100:103]
    s_add_u32 m0, s35, 1024
    s_nop 0
    buffer_load_dwordx4 v6, s[40:43], s30 offen lds
    v_sub_f32 v21, v89, v228
    v_cvt_pk_bf16_f32 v20, v20, v21
    v_and_b32 v21, s92, v20
    v_lshlrev_b32 v20, 16, v20
    v_mul_f32 v20, v20, v230
    v_mul_f32 v21, v21, v230
    v_cvt_pk_bf16_f32 v204, v20, v21
    v_sub_f32 v20, v90, v228
    v_sub_f32 v21, v91, v228
    ds_read_b64_tr_b16 v[56:57], v16 offset:14528
    ds_read_b64_tr_b16 v[58:59], v16 offset:15424
    s_waitcnt lgkmcnt(6)
    v_mfma_f32_16x16x32_bf16 v[112:115], v[32:35], v[60:63], v[112:115]
    s_add_u32 m0, s35, 2048
    s_add_u32 s30, s38, 33152
    buffer_load_dwordx4 v5, s[40:43], s30 offen lds
    v_cvt_pk_bf16_f32 v20, v20, v21
    v_and_b32 v21, s92, v20
    v_lshlrev_b32 v20, 16, v20
    v_mul_f32 v20, v20, v230
    v_mul_f32 v21, v21, v230
    v_cvt_pk_bf16_f32 v205, v20, v21
    v_sub_f32 v20, v92, v228
    v_sub_f32 v21, v93, v228
    v_cvt_pk_bf16_f32 v20, v20, v21
    v_mfma_f32_16x16x32_bf16 v[116:119], v[36:39], v[60:63], v[116:119]
    s_add_u32 m0, s35, 3072
    s_nop 0
    buffer_load_dwordx4 v6, s[40:43], s30 offen lds
    v_and_b32 v21, s92, v20
    v_lshlrev_b32 v20, 16, v20
    v_mul_f32 v20, v20, v230
    v_mul_f32 v21, v21, v230
    v_cvt_pk_bf16_f32 v206, v20, v21
    v_sub_f32 v20, v94, v228
    v_sub_f32 v21, v95, v228
    v_cvt_pk_bf16_f32 v20, v20, v21
    ds_read_b64_tr_b16 v[60:61], v16 offset:21504
    ds_read_b64_tr_b16 v[62:63], v16 offset:22400
    s_waitcnt lgkmcnt(6)
    v_mfma_f32_16x16x32_bf16 v[128:131], v[32:35], v[48:51], v[128:131]
    v_and_b32 v21, s92, v20
    v_lshlrev_b32 v20, 16, v20
    v_mul_f32 v20, v20, v230
    v_mul_f32 v21, v21, v230
    v_cvt_pk_bf16_f32 v207, v20, v21
    v_sub_f32 v20, v104, v228
    v_sub_f32 v21, v105, v228
    v_cvt_pk_bf16_f32 v20, v20, v21
    v_and_b32 v21, s92, v20
    v_mfma_f32_16x16x32_bf16 v[132:135], v[36:39], v[48:51], v[132:135]
    v_lshlrev_b32 v20, 16, v20
    v_mul_f32 v20, v20, v230
    v_mul_f32 v21, v21, v230
    v_cvt_pk_bf16_f32 v208, v20, v21
    v_sub_f32 v20, v106, v228
    v_sub_f32 v21, v107, v228
    v_cvt_pk_bf16_f32 v20, v20, v21
    v_and_b32 v21, s92, v20
    v_lshlrev_b32 v20, 16, v20
    ds_read_b64_tr_b16 v[48:49], v16 offset:21536
    ds_read_b64_tr_b16 v[50:51], v16 offset:22432
    s_waitcnt lgkmcnt(6)
    v_mfma_f32_16x16x32_bf16 v[144:147], v[32:35], v[52:55], v[144:147]
    v_mul_f32 v20, v20, v230
    v_mul_f32 v21, v21, v230
    v_cvt_pk_bf16_f32 v209, v20, v21
    v_sub_f32 v20, v108, v228
    v_sub_f32 v21, v109, v228
    v_cvt_pk_bf16_f32 v20, v20, v21
    v_and_b32 v21, s92, v20
    v_lshlrev_b32 v20, 16, v20
    v_mfma_f32_16x16x32_bf16 v[148:151], v[36:39], v[52:55], v[148:151]
    v_mul_f32 v20, v20, v230
    v_mul_f32 v21, v21, v230
    v_cvt_pk_bf16_f32 v210, v20, v21
    v_sub_f32 v20, v110, v228
    v_sub_f32 v21, v111, v228
    v_cvt_pk_bf16_f32 v20, v20, v21
    v_and_b32 v21, s92, v20
    v_lshlrev_b32 v20, 16, v20
    v_mul_f32 v20, v20, v230
    ds_read_b64_tr_b16 v[52:53], v16 offset:21568
    ds_read_b64_tr_b16 v[54:55], v16 offset:22464
    s_waitcnt lgkmcnt(6)
    v_mfma_f32_16x16x32_bf16 v[160:163], v[32:35], v[56:59], v[160:163]
    v_mul_f32 v21, v21, v230
    v_cvt_pk_bf16_f32 v211, v20, v21
    v_sub_f32 v20, v120, v228
    v_sub_f32 v21, v121, v228
    v_cvt_pk_bf16_f32 v20, v20, v21
    v_and_b32 v21, s92, v20
    v_lshlrev_b32 v20, 16, v20
    v_mul_f32 v20, v20, v230
    v_mul_f32 v21, v21, v230
    v_mfma_f32_16x16x32_bf16 v[164:167], v[36:39], v[56:59], v[164:167]
    v_cvt_pk_bf16_f32 v212, v20, v21
    v_sub_f32 v20, v122, v228
    v_sub_f32 v21, v123, v228
    v_cvt_pk_bf16_f32 v20, v20, v21
    v_and_b32 v21, s92, v20
    v_lshlrev_b32 v20, 16, v20
    v_mul_f32 v20, v20, v230
    v_mul_f32 v21, v21, v230
    v_cvt_pk_bf16_f32 v213, v20, v21
    ds_read_b64_tr_b16 v[56:57], v16 offset:21600
    ds_read_b64_tr_b16 v[58:59], v16 offset:22496
    s_waitcnt lgkmcnt(6)
    v_mfma_f32_16x16x32_bf16 v[64:67], v[176:179], v[60:63], v[64:67]
    v_sub_f32 v20, v124, v228
    v_sub_f32 v21, v125, v228
    v_cvt_pk_bf16_f32 v20, v20, v21
    v_and_b32 v21, s92, v20
    v_lshlrev_b32 v20, 16, v20
    v_mul_f32 v20, v20, v230
    v_mul_f32 v21, v21, v230
    v_cvt_pk_bf16_f32 v214, v20, v21
    v_mfma_f32_16x16x32_bf16 v[68:71], v[180:183], v[60:63], v[68:71]
    v_sub_f32 v20, v126, v228
    v_sub_f32 v21, v127, v228
    v_cvt_pk_bf16_f32 v20, v20, v21
    v_and_b32 v21, s92, v20
    v_lshlrev_b32 v20, 16, v20
    v_mul_f32 v20, v20, v230
    v_mul_f32 v21, v21, v230
    v_cvt_pk_bf16_f32 v215, v20, v21
    v_sub_f32 v20, v136, v228
    ds_read_b64_tr_b16 v[60:61], v16 offset:21632
    ds_read_b64_tr_b16 v[62:63], v16 offset:22528
    s_waitcnt lgkmcnt(6)
    v_mfma_f32_16x16x32_bf16 v[80:83], v[176:179], v[48:51], v[80:83]
    v_sub_f32 v21, v137, v228
    v_cvt_pk_bf16_f32 v20, v20, v21
    v_and_b32 v21, s92, v20
    v_lshlrev_b32 v20, 16, v20
    v_mul_f32 v20, v20, v230
    v_mul_f32 v21, v21, v230
    v_cvt_pk_bf16_f32 v216, v20, v21
    v_sub_f32 v20, v138, v228
    v_sub_f32 v21, v139, v228
    v_mfma_f32_16x16x32_bf16 v[84:87], v[180:183], v[48:51], v[84:87]
    v_cvt_pk_bf16_f32 v20, v20, v21
    v_and_b32 v21, s92, v20
    v_lshlrev_b32 v20, 16, v20
    v_mul_f32 v20, v20, v230
    v_mul_f32 v21, v21, v230
    v_cvt_pk_bf16_f32 v217, v20, v21
    v_sub_f32 v20, v140, v228
    v_sub_f32 v21, v141, v228
    ds_read_b64_tr_b16 v[48:49], v16 offset:21664
    ds_read_b64_tr_b16 v[50:51], v16 offset:22560
    s_waitcnt lgkmcnt(6)
    v_mfma_f32_16x16x32_bf16 v[96:99], v[176:179], v[52:55], v[96:99]
    v_cvt_pk_bf16_f32 v20, v20, v21
    v_and_b32 v21, s92, v20
    v_lshlrev_b32 v20, 16, v20
    v_mul_f32 v20, v20, v230
    v_mul_f32 v21, v21, v230
    v_cvt_pk_bf16_f32 v218, v20, v21
    v_sub_f32 v20, v142, v228
    v_sub_f32 v21, v143, v228
    v_cvt_pk_bf16_f32 v20, v20, v21
    v_mfma_f32_16x16x32_bf16 v[100:103], v[180:183], v[52:55], v[100:103]
    v_and_b32 v21, s92, v20
    v_lshlrev_b32 v20, 16, v20
    v_mul_f32 v20, v20, v230
    v_mul_f32 v21, v21, v230
    v_cvt_pk_bf16_f32 v219, v20, v21
    v_sub_f32 v20, v152, v228
    v_sub_f32 v21, v153, v228
    v_cvt_pk_bf16_f32 v20, v20, v21
    v_and_b32 v21, s92, v20
    ds_read_b64_tr_b16 v[52:53], v16 offset:21696
    ds_read_b64_tr_b16 v[54:55], v16 offset:22592
    s_waitcnt lgkmcnt(6)
    v_mfma_f32_16x16x32_bf16 v[112:115], v[176:179], v[56:59], v[112:115]
    v_lshlrev_b32 v20, 16, v20
    v_mul_f32 v20, v20, v230
    v_mul_f32 v21, v21, v230
    v_cvt_pk_bf16_f32 v220, v20, v21
    v_sub_f32 v20, v154, v228
    v_sub_f32 v21, v155, v228
    v_cvt_pk_bf16_f32 v20, v20, v21
    v_and_b32 v21, s92, v20
    v_lshlrev_b32 v20, 16, v20
    v_mfma_f32_16x16x32_bf16 v[116:119], v[180:183], v[56:59], v[116:119]
    v_mul_f32 v20, v20, v230
    v_mul_f32 v21, v21, v230
    v_cvt_pk_bf16_f32 v221, v20, v21
    v_sub_f32 v20, v156, v228
    v_sub_f32 v21, v157, v228
    v_cvt_pk_bf16_f32 v20, v20, v21
    v_and_b32 v21, s92, v20
    v_lshlrev_b32 v20, 16, v20
    s_waitcnt lgkmcnt(4)
    v_mfma_f32_16x16x32_bf16 v[128:131], v[176:179], v[60:63], v[128:131]
    v_mul_f32 v20, v20, v230
    v_mul_f32 v21, v21, v230
    v_cvt_pk_bf16_f32 v222, v20, v21
    v_sub_f32 v20, v158, v228
    v_sub_f32 v21, v159, v228
    v_cvt_pk_bf16_f32 v20, v20, v21
    v_and_b32 v21, s92, v20
    v_lshlrev_b32 v20, 16, v20
    v_mul_f32 v20, v20, v230
    v_mfma_f32_16x16x32_bf16 v[132:135], v[180:183], v[60:63], v[132:135]
    v_mul_f32 v21, v21, v230
    v_cvt_pk_bf16_f32 v223, v20, v21
    v_sub_f32 v20, v168, v228
    v_sub_f32 v21, v169, v228
    v_cvt_pk_bf16_f32 v20, v20, v21
    v_and_b32 v21, s92, v20
    v_lshlrev_b32 v20, 16, v20
    v_mul_f32 v20, v20, v230
    v_mul_f32 v21, v21, v230
    s_waitcnt lgkmcnt(2)
    v_mfma_f32_16x16x32_bf16 v[144:147], v[176:179], v[48:51], v[144:147]
    v_cvt_pk_bf16_f32 v224, v20, v21
    v_sub_f32 v20, v170, v228
    v_sub_f32 v21, v171, v228
    v_cvt_pk_bf16_f32 v20, v20, v21
    v_and_b32 v21, s92, v20
    v_lshlrev_b32 v20, 16, v20
    v_mul_f32 v20, v20, v230
    v_mul_f32 v21, v21, v230
    v_mfma_f32_16x16x32_bf16 v[148:151], v[180:183], v[48:51], v[148:151]
    v_cvt_pk_bf16_f32 v225, v20, v21
    v_sub_f32 v20, v172, v228
    v_sub_f32 v21, v173, v228
    v_cvt_pk_bf16_f32 v20, v20, v21
    v_and_b32 v21, s92, v20
    v_lshlrev_b32 v20, 16, v20
    v_mul_f32 v20, v20, v230
    v_mul_f32 v21, v21, v230
    v_cvt_pk_bf16_f32 v226, v20, v21
    s_waitcnt lgkmcnt(0)
    v_mfma_f32_16x16x32_bf16 v[160:163], v[176:179], v[52:55], v[160:163]
    v_sub_f32 v20, v174, v228
    v_sub_f32 v21, v175, v228
    v_cvt_pk_bf16_f32 v20, v20, v21
    v_and_b32 v21, s92, v20
    v_lshlrev_b32 v20, 16, v20
    v_mul_f32 v20, v20, v230
    v_mul_f32 v21, v21, v230
    v_cvt_pk_bf16_f32 v227, v20, v21
    v_and_b32 v228, 1, v19
    v_mfma_f32_16x16x32_bf16 v[164:167], v[180:183], v[52:55], v[164:167]
    v_cmp_eq_u32 s[100:101], 1, v228
    s_lshr_b32 s93, s2, 2
    s_mul_i32 s93, s93, 28672
    s_and_b32 s92, s2, 3
    s_lshl_b32 s92, s92, 7
    s_add_u32 s93, s93, s92
    v_lshlrev_b32 v228, 9, v19
    v_lshl_add_u32 v228, v18, 4, v228
    v_add_u32 v228, s93, v228
    s_waitcnt vmcnt(9)
    s_barrier
    ds_read_b128 v[32:35], v12 offset:8192
    ds_read_b128 v[36:39], v12 offset:10240
    ds_read_b64_tr_b16 v[48:49], v16 offset:28672
    ds_read_b64_tr_b16 v[50:51], v16 offset:29568
    ds_read_b64_tr_b16 v[52:53], v16 offset:28704
    ds_read_b64_tr_b16 v[54:55], v16 offset:29600
    ds_read_b64_tr_b16 v[56:57], v16 offset:28736
    ds_read_b64_tr_b16 v[58:59], v16 offset:29632
    ds_read_b128 v[176:179], v13 offset:8192
    ds_read_b128 v[180:183], v13 offset:10240
    ds_read_b64_tr_b16 v[60:61], v16 offset:28768
    ds_read_b64_tr_b16 v[62:63], v16 offset:29664
    s_waitcnt lgkmcnt(8)
    v_mfma_f32_16x16x32_bf16 v[64:67], v[32:35], v[48:51], v[64:67]
    s_mov_b32 s33, 16056320
    buffer_store_dwordx4 v[200:203], v228, s[4:7], s33 offen sc1
    v_cndmask_b32 v24, v201, v200, s[100:101]
    v_mfma_f32_16x16x32_bf16 v[68:71], v[36:39], v[48:51], v[68:71]
    v_cndmask_b32 v25, v203, v202, s[100:101]
    v_mov_b32_dpp v24, v24 row_ror:8 row_mask:0xf bank_mask:0xf
    s_nop 0
    v_mov_b32_dpp v25, v25 row_ror:8 row_mask:0xf bank_mask:0xf
    ds_read_b64_tr_b16 v[48:49], v16 offset:28800
    ds_read_b64_tr_b16 v[50:51], v16 offset:29696
    s_waitcnt lgkmcnt(8)
    v_mfma_f32_16x16x32_bf16 v[80:83], v[32:35], v[52:55], v[80:83]
    v_cndmask_b32 v20, v200, v24, s[100:101]
    v_cndmask_b32 v21, v202, v25, s[100:101]
    v_cndmask_b32 v22, v24, v201, s[100:101]
    v_mfma_f32_16x16x32_bf16 v[84:87], v[36:39], v[52:55], v[84:87]
    v_cndmask_b32 v23, v25, v203, s[100:101]
    s_mov_b32 s34, 17891328
    buffer_store_dwordx4 v[20:23], v228, s[4:7], s34 offen sc1
    ds_read_b64_tr_b16 v[52:53], v16 offset:28832
    ds_read_b64_tr_b16 v[54:55], v16 offset:29728
    s_waitcnt lgkmcnt(8)
    v_mfma_f32_16x16x32_bf16 v[96:99], v[32:35], v[56:59], v[96:99]
    s_mov_b32 s33, 16060416
    buffer_store_dwordx4 v[204:207], v228, s[4:7], s33 offen sc1
    v_cndmask_b32 v30, v205, v204, s[100:101]
    v_mfma_f32_16x16x32_bf16 v[100:103], v[36:39], v[56:59], v[100:103]
    v_cndmask_b32 v31, v207, v206, s[100:101]
    v_mov_b32_dpp v30, v30 row_ror:8 row_mask:0xf bank_mask:0xf
    s_nop 0
    v_mov_b32_dpp v31, v31 row_ror:8 row_mask:0xf bank_mask:0xf
    ds_read_b64_tr_b16 v[56:57], v16 offset:28864
    ds_read_b64_tr_b16 v[58:59], v16 offset:29760
    s_waitcnt lgkmcnt(6)
    v_mfma_f32_16x16x32_bf16 v[112:115], v[32:35], v[60:63], v[112:115]
    v_cndmask_b32 v26, v204, v30, s[100:101]
    v_cndmask_b32 v27, v206, v31, s[100:101]
    v_cndmask_b32 v28, v30, v205, s[100:101]
    v_mfma_f32_16x16x32_bf16 v[116:119], v[36:39], v[60:63], v[116:119]
    v_cndmask_b32 v29, v31, v207, s[100:101]
    s_mov_b32 s34, 17895424
    buffer_store_dwordx4 v[26:29], v228, s[4:7], s34 offen sc1
    ds_read_b64_tr_b16 v[60:61], v16 offset:35840
    ds_read_b64_tr_b16 v[62:63], v16 offset:36736
    s_waitcnt lgkmcnt(6)
    v_mfma_f32_16x16x32_bf16 v[128:131], v[32:35], v[48:51], v[128:131]
    s_mov_b32 s33, 16064512
    buffer_store_dwordx4 v[208:211], v228, s[4:7], s33 offen sc1
    v_cndmask_b32 v24, v209, v208, s[100:101]
    v_mfma_f32_16x16x32_bf16 v[132:135], v[36:39], v[48:51], v[132:135]
    v_cndmask_b32 v25, v211, v210, s[100:101]
    v_mov_b32_dpp v24, v24 row_ror:8 row_mask:0xf bank_mask:0xf
    s_nop 0
    v_mov_b32_dpp v25, v25 row_ror:8 row_mask:0xf bank_mask:0xf
    ds_read_b64_tr_b16 v[48:49], v16 offset:35872
    ds_read_b64_tr_b16 v[50:51], v16 offset:36768
    s_waitcnt lgkmcnt(6)
    v_mfma_f32_16x16x32_bf16 v[144:147], v[32:35], v[52:55], v[144:147]
    v_cndmask_b32 v20, v208, v24, s[100:101]
    v_cndmask_b32 v21, v210, v25, s[100:101]
    v_cndmask_b32 v22, v24, v209, s[100:101]
    v_mfma_f32_16x16x32_bf16 v[148:151], v[36:39], v[52:55], v[148:151]
    v_cndmask_b32 v23, v25, v211, s[100:101]
    s_mov_b32 s34, 17899520
    buffer_store_dwordx4 v[20:23], v228, s[4:7], s34 offen sc1
    ds_read_b64_tr_b16 v[52:53], v16 offset:35904
    ds_read_b64_tr_b16 v[54:55], v16 offset:36800
    s_waitcnt lgkmcnt(6)
    v_mfma_f32_16x16x32_bf16 v[160:163], v[32:35], v[56:59], v[160:163]
    s_mov_b32 s33, 16068608
    buffer_store_dwordx4 v[212:215], v228, s[4:7], s33 offen sc1
    v_cndmask_b32 v30, v213, v212, s[100:101]
    v_mfma_f32_16x16x32_bf16 v[164:167], v[36:39], v[56:59], v[164:167]
    v_cndmask_b32 v31, v215, v214, s[100:101]
    v_mov_b32_dpp v30, v30 row_ror:8 row_mask:0xf bank_mask:0xf
    s_nop 0
    v_mov_b32_dpp v31, v31 row_ror:8 row_mask:0xf bank_mask:0xf
    ds_read_b64_tr_b16 v[56:57], v16 offset:35936
    ds_read_b64_tr_b16 v[58:59], v16 offset:36832
    s_waitcnt lgkmcnt(6)
    v_mfma_f32_16x16x32_bf16 v[64:67], v[176:179], v[60:63], v[64:67]
    v_cndmask_b32 v26, v212, v30, s[100:101]
    v_cndmask_b32 v27, v214, v31, s[100:101]
    v_cndmask_b32 v28, v30, v213, s[100:101]
    v_mfma_f32_16x16x32_bf16 v[68:71], v[180:183], v[60:63], v[68:71]
    v_cndmask_b32 v29, v31, v215, s[100:101]
    s_mov_b32 s34, 17903616
    buffer_store_dwordx4 v[26:29], v228, s[4:7], s34 offen sc1
    ds_read_b64_tr_b16 v[60:61], v16 offset:35968
    ds_read_b64_tr_b16 v[62:63], v16 offset:36864
    s_waitcnt lgkmcnt(6)
    v_mfma_f32_16x16x32_bf16 v[80:83], v[176:179], v[48:51], v[80:83]
    s_mov_b32 s33, 16072704
    buffer_store_dwordx4 v[216:219], v228, s[4:7], s33 offen sc1
    v_cndmask_b32 v24, v217, v216, s[100:101]
    v_mfma_f32_16x16x32_bf16 v[84:87], v[180:183], v[48:51], v[84:87]
    v_cndmask_b32 v25, v219, v218, s[100:101]
    v_mov_b32_dpp v24, v24 row_ror:8 row_mask:0xf bank_mask:0xf
    s_nop 0
    v_mov_b32_dpp v25, v25 row_ror:8 row_mask:0xf bank_mask:0xf
    ds_read_b64_tr_b16 v[48:49], v16 offset:36000
    ds_read_b64_tr_b16 v[50:51], v16 offset:36896
    s_waitcnt lgkmcnt(6)
    v_mfma_f32_16x16x32_bf16 v[96:99], v[176:179], v[52:55], v[96:99]
    v_cndmask_b32 v20, v216, v24, s[100:101]
    v_cndmask_b32 v21, v218, v25, s[100:101]
    v_cndmask_b32 v22, v24, v217, s[100:101]
    v_mfma_f32_16x16x32_bf16 v[100:103], v[180:183], v[52:55], v[100:103]
    v_cndmask_b32 v23, v25, v219, s[100:101]
    s_mov_b32 s34, 17907712
    buffer_store_dwordx4 v[20:23], v228, s[4:7], s34 offen sc1
    ds_read_b64_tr_b16 v[52:53], v16 offset:36032
    ds_read_b64_tr_b16 v[54:55], v16 offset:36928
    s_waitcnt lgkmcnt(6)
    v_mfma_f32_16x16x32_bf16 v[112:115], v[176:179], v[56:59], v[112:115]
    s_mov_b32 s33, 16076800
    buffer_store_dwordx4 v[220:223], v228, s[4:7], s33 offen sc1
    v_cndmask_b32 v30, v221, v220, s[100:101]
    v_mfma_f32_16x16x32_bf16 v[116:119], v[180:183], v[56:59], v[116:119]
    v_cndmask_b32 v31, v223, v222, s[100:101]
    v_mov_b32_dpp v30, v30 row_ror:8 row_mask:0xf bank_mask:0xf
    s_nop 0
    v_mov_b32_dpp v31, v31 row_ror:8 row_mask:0xf bank_mask:0xf
    s_waitcnt lgkmcnt(4)
    v_mfma_f32_16x16x32_bf16 v[128:131], v[176:179], v[60:63], v[128:131]
    v_cndmask_b32 v26, v220, v30, s[100:101]
    v_cndmask_b32 v27, v222, v31, s[100:101]
    v_cndmask_b32 v28, v30, v221, s[100:101]
    v_mfma_f32_16x16x32_bf16 v[132:135], v[180:183], v[60:63], v[132:135]
    v_cndmask_b32 v29, v31, v223, s[100:101]
    s_mov_b32 s34, 17911808
    buffer_store_dwordx4 v[26:29], v228, s[4:7], s34 offen sc1
    s_waitcnt lgkmcnt(2)
    v_mfma_f32_16x16x32_bf16 v[144:147], v[176:179], v[48:51], v[144:147]
    s_mov_b32 s33, 16080896
    buffer_store_dwordx4 v[224:227], v228, s[4:7], s33 offen sc1
    v_cndmask_b32 v24, v225, v224, s[100:101]
    v_mfma_f32_16x16x32_bf16 v[148:151], v[180:183], v[48:51], v[148:151]
    v_cndmask_b32 v25, v227, v226, s[100:101]
    v_mov_b32_dpp v24, v24 row_ror:8 row_mask:0xf bank_mask:0xf
    s_nop 0
    v_mov_b32_dpp v25, v25 row_ror:8 row_mask:0xf bank_mask:0xf
    s_waitcnt lgkmcnt(0)
    v_mfma_f32_16x16x32_bf16 v[160:163], v[176:179], v[52:55], v[160:163]
    v_cndmask_b32 v20, v224, v24, s[100:101]
    v_cndmask_b32 v21, v226, v25, s[100:101]
    v_cndmask_b32 v22, v24, v225, s[100:101]
    v_mfma_f32_16x16x32_bf16 v[164:167], v[180:183], v[52:55], v[164:167]
    v_cndmask_b32 v23, v25, v227, s[100:101]
    s_mov_b32 s34, 17915904
    buffer_store_dwordx4 v[20:23], v228, s[4:7], s34 offen sc1
    s_waitcnt vmcnt(14)
    s_barrier
    ds_read_b128 v[32:35], v12 offset:0
    ds_read_b128 v[36:39], v12 offset:2048
    ds_read_b64_tr_b16 v[48:49], v16 offset:43008
    ds_read_b64_tr_b16 v[50:51], v16 offset:43904
    ds_read_b64_tr_b16 v[52:53], v16 offset:43040
    ds_read_b64_tr_b16 v[54:55], v16 offset:43936
    ds_read_b64_tr_b16 v[56:57], v16 offset:43072
    ds_read_b64_tr_b16 v[58:59], v16 offset:43968
    ds_read_b128 v[176:179], v13 offset:0
    ds_read_b128 v[180:183], v13 offset:2048
    ds_read_b64_tr_b16 v[60:61], v16 offset:43104
    ds_read_b64_tr_b16 v[62:63], v16 offset:44000
    s_waitcnt lgkmcnt(8)
    v_mfma_f32_16x16x32_bf16 v[64:67], v[32:35], v[48:51], v[64:67]
    v_mfma_f32_16x16x32_bf16 v[68:71], v[36:39], v[48:51], v[68:71]
    ds_read_b64_tr_b16 v[48:49], v16 offset:43136
    ds_read_b64_tr_b16 v[50:51], v16 offset:44032
    s_waitcnt lgkmcnt(8)
    v_mfma_f32_16x16x32_bf16 v[80:83], v[32:35], v[52:55], v[80:83]
    v_mfma_f32_16x16x32_bf16 v[84:87], v[36:39], v[52:55], v[84:87]
    ds_read_b64_tr_b16 v[52:53], v16 offset:43168
    ds_read_b64_tr_b16 v[54:55], v16 offset:44064
    s_waitcnt lgkmcnt(8)
    v_mfma_f32_16x16x32_bf16 v[96:99], v[32:35], v[56:59], v[96:99]
    v_mfma_f32_16x16x32_bf16 v[100:103], v[36:39], v[56:59], v[100:103]
    ds_read_b64_tr_b16 v[56:57], v16 offset:43200
    ds_read_b64_tr_b16 v[58:59], v16 offset:44096
    s_waitcnt lgkmcnt(6)
    v_mfma_f32_16x16x32_bf16 v[112:115], v[32:35], v[60:63], v[112:115]
    v_mfma_f32_16x16x32_bf16 v[116:119], v[36:39], v[60:63], v[116:119]
    ds_read_b64_tr_b16 v[60:61], v16 offset:50176
    ds_read_b64_tr_b16 v[62:63], v16 offset:51072
    s_waitcnt lgkmcnt(6)
    v_mfma_f32_16x16x32_bf16 v[128:131], v[32:35], v[48:51], v[128:131]
    v_mfma_f32_16x16x32_bf16 v[132:135], v[36:39], v[48:51], v[132:135]
    ds_read_b64_tr_b16 v[48:49], v16 offset:50208
    ds_read_b64_tr_b16 v[50:51], v16 offset:51104
    s_waitcnt lgkmcnt(6)
    v_mfma_f32_16x16x32_bf16 v[144:147], v[32:35], v[52:55], v[144:147]
    v_mfma_f32_16x16x32_bf16 v[148:151], v[36:39], v[52:55], v[148:151]
    ds_read_b64_tr_b16 v[52:53], v16 offset:50240
    ds_read_b64_tr_b16 v[54:55], v16 offset:51136
    s_waitcnt lgkmcnt(6)
    v_mfma_f32_16x16x32_bf16 v[160:163], v[32:35], v[56:59], v[160:163]
    v_mfma_f32_16x16x32_bf16 v[164:167], v[36:39], v[56:59], v[164:167]
    ds_read_b64_tr_b16 v[56:57], v16 offset:50272
    ds_read_b64_tr_b16 v[58:59], v16 offset:51168
    s_waitcnt lgkmcnt(6)
    v_mfma_f32_16x16x32_bf16 v[64:67], v[176:179], v[60:63], v[64:67]
    v_mfma_f32_16x16x32_bf16 v[68:71], v[180:183], v[60:63], v[68:71]
    ds_read_b64_tr_b16 v[60:61], v16 offset:50304
    ds_read_b64_tr_b16 v[62:63], v16 offset:51200
    s_waitcnt lgkmcnt(6)
    v_mfma_f32_16x16x32_bf16 v[80:83], v[176:179], v[48:51], v[80:83]
    v_mfma_f32_16x16x32_bf16 v[84:87], v[180:183], v[48:51], v[84:87]
    ds_read_b64_tr_b16 v[48:49], v16 offset:50336
    ds_read_b64_tr_b16 v[50:51], v16 offset:51232
    s_waitcnt lgkmcnt(6)
    v_mfma_f32_16x16x32_bf16 v[96:99], v[176:179], v[52:55], v[96:99]
    v_mfma_f32_16x16x32_bf16 v[100:103], v[180:183], v[52:55], v[100:103]
    ds_read_b64_tr_b16 v[52:53], v16 offset:50368
    ds_read_b64_tr_b16 v[54:55], v16 offset:51264
    s_waitcnt lgkmcnt(6)
    v_mfma_f32_16x16x32_bf16 v[112:115], v[176:179], v[56:59], v[112:115]
    v_mfma_f32_16x16x32_bf16 v[116:119], v[180:183], v[56:59], v[116:119]
    s_waitcnt lgkmcnt(4)
    v_mfma_f32_16x16x32_bf16 v[128:131], v[176:179], v[60:63], v[128:131]
    v_mfma_f32_16x16x32_bf16 v[132:135], v[180:183], v[60:63], v[132:135]
    s_waitcnt lgkmcnt(2)
    v_mfma_f32_16x16x32_bf16 v[144:147], v[176:179], v[48:51], v[144:147]
    v_mfma_f32_16x16x32_bf16 v[148:151], v[180:183], v[48:51], v[148:151]
    s_waitcnt lgkmcnt(0)
    v_mfma_f32_16x16x32_bf16 v[160:163], v[176:179], v[52:55], v[160:163]
    v_mfma_f32_16x16x32_bf16 v[164:167], v[180:183], v[52:55], v[164:167]
p0_e3:
    s_cmp_eq_u32 s29, 0
    s_cbranch_scc0 p0_e4
    s_nop 5
    v_mul_f32 v64, 0x3db8aa3b, v64
    v_mul_f32 v65, 0x3db8aa3b, v65
    v_mul_f32 v66, 0x3db8aa3b, v66
    v_mul_f32 v67, 0x3db8aa3b, v67
    v_mul_f32 v68, 0x3db8aa3b, v68
    v_mul_f32 v69, 0x3db8aa3b, v69
    v_mul_f32 v70, 0x3db8aa3b, v70
    v_mul_f32 v71, 0x3db8aa3b, v71
    v_mul_f32 v80, 0x3db8aa3b, v80
    v_mul_f32 v81, 0x3db8aa3b, v81
    v_mul_f32 v82, 0x3db8aa3b, v82
    v_mul_f32 v83, 0x3db8aa3b, v83
    v_mul_f32 v84, 0x3db8aa3b, v84
    v_mul_f32 v85, 0x3db8aa3b, v85
    v_mul_f32 v86, 0x3db8aa3b, v86
    v_mul_f32 v87, 0x3db8aa3b, v87
    v_mul_f32 v96, 0x3db8aa3b, v96
    v_mul_f32 v97, 0x3db8aa3b, v97
    v_mul_f32 v98, 0x3db8aa3b, v98
    v_mul_f32 v99, 0x3db8aa3b, v99
    v_mul_f32 v100, 0x3db8aa3b, v100
    v_mul_f32 v101, 0x3db8aa3b, v101
    v_mul_f32 v102, 0x3db8aa3b, v102
    v_mul_f32 v103, 0x3db8aa3b, v103
    v_mul_f32 v112, 0x3db8aa3b, v112
    v_mul_f32 v113, 0x3db8aa3b, v113
    v_mul_f32 v114, 0x3db8aa3b, v114
    v_mul_f32 v115, 0x3db8aa3b, v115
    v_mul_f32 v116, 0x3db8aa3b, v116
    v_mul_f32 v117, 0x3db8aa3b, v117
    v_mul_f32 v118, 0x3db8aa3b, v118
    v_mul_f32 v119, 0x3db8aa3b, v119
    v_mul_f32 v128, 0x3db8aa3b, v128
    v_mul_f32 v129, 0x3db8aa3b, v129
    v_mul_f32 v130, 0x3db8aa3b, v130
    v_mul_f32 v131, 0x3db8aa3b, v131
    v_mul_f32 v132, 0x3db8aa3b, v132
    v_mul_f32 v133, 0x3db8aa3b, v133
    v_mul_f32 v134, 0x3db8aa3b, v134
    v_mul_f32 v135, 0x3db8aa3b, v135
    v_mul_f32 v144, 0x3db8aa3b, v144
    v_mul_f32 v145, 0x3db8aa3b, v145
    v_mul_f32 v146, 0x3db8aa3b, v146
    v_mul_f32 v147, 0x3db8aa3b, v147
    v_mul_f32 v148, 0x3db8aa3b, v148
    v_mul_f32 v149, 0x3db8aa3b, v149
    v_mul_f32 v150, 0x3db8aa3b, v150
    v_mul_f32 v151, 0x3db8aa3b, v151
    v_mul_f32 v160, 0x3db8aa3b, v160
    v_mul_f32 v161, 0x3db8aa3b, v161
    v_mul_f32 v162, 0x3db8aa3b, v162
    v_mul_f32 v163, 0x3db8aa3b, v163
    v_mul_f32 v164, 0x3db8aa3b, v164
    v_mul_f32 v165, 0x3db8aa3b, v165
    v_mul_f32 v166, 0x3db8aa3b, v166
    v_mul_f32 v167, 0x3db8aa3b, v167
p0_e4:
    s_mul_i32 s30, s24, 28
    s_mul_i32 s31, s27, 7
    s_add_u32 s30, s30, s31
    s_mul_i32 s30, s30, 14336
    s_lshl_b32 s31, s37, 10
    s_add_u32 s30, s30, s31
    s_nop 1
    v_cvt_pk_bf16_f32 v64, v64, v65
    v_cvt_pk_bf16_f32 v65, v66, v67
    v_cvt_pk_bf16_f32 v66, v68, v69
    v_cvt_pk_bf16_f32 v67, v70, v71
    buffer_store_dwordx4 v[64:67], v17, s[4:7], s30 offen offset:0 sc1
    s_add_u32 s30, s30, 14336
    v_cvt_pk_bf16_f32 v80, v80, v81
    v_cvt_pk_bf16_f32 v81, v82, v83
    v_cvt_pk_bf16_f32 v82, v84, v85
    v_cvt_pk_bf16_f32 v83, v86, v87
    buffer_store_dwordx4 v[80:83], v17, s[4:7], s30 offen offset:0 sc1
    s_add_u32 s30, s30, 14336
    v_cvt_pk_bf16_f32 v96, v96, v97
    v_cvt_pk_bf16_f32 v97, v98, v99
    v_cvt_pk_bf16_f32 v98, v100, v101
    v_cvt_pk_bf16_f32 v99, v102, v103
    buffer_store_dwordx4 v[96:99], v17, s[4:7], s30 offen offset:0 sc1
    s_add_u32 s30, s30, 14336
    v_cvt_pk_bf16_f32 v112, v112, v113
    v_cvt_pk_bf16_f32 v113, v114, v115
    v_cvt_pk_bf16_f32 v114, v116, v117
    v_cvt_pk_bf16_f32 v115, v118, v119
    buffer_store_dwordx4 v[112:115], v17, s[4:7], s30 offen offset:0 sc1
    s_add_u32 s30, s30, 14336
    v_cvt_pk_bf16_f32 v128, v128, v129
    v_cvt_pk_bf16_f32 v129, v130, v131
    v_cvt_pk_bf16_f32 v130, v132, v133
    v_cvt_pk_bf16_f32 v131, v134, v135
    buffer_store_dwordx4 v[128:131], v17, s[4:7], s30 offen offset:0 sc1
    s_add_u32 s30, s30, 14336
    v_cvt_pk_bf16_f32 v144, v144, v145
    v_cvt_pk_bf16_f32 v145, v146, v147
    v_cvt_pk_bf16_f32 v146, v148, v149
    v_cvt_pk_bf16_f32 v147, v150, v151
    buffer_store_dwordx4 v[144:147], v17, s[4:7], s30 offen offset:0 sc1
    s_add_u32 s30, s30, 14336
    v_cvt_pk_bf16_f32 v160, v160, v161
    v_cvt_pk_bf16_f32 v161, v162, v163
    v_cvt_pk_bf16_f32 v162, v164, v165
    v_cvt_pk_bf16_f32 v163, v166, v167
    buffer_store_dwordx4 v[160:163], v17, s[4:7], s30 offen offset:0 sc1
    s_add_u32 s30, s30, 14336
    s_cmp_eq_u32 s2, 255
    s_cbranch_scc0 p0_done
    s_mov_b32 s40, s66
    s_and_b32 s41, s67, 0xffff
    s_mov_b32 s42, 7168
    s_mov_b32 s43, 0x20000
    v_mul_u32_u24 v7, 896, v18
    v_lshl_add_u32 v7, v19, 4, v7
    buffer_load_dwordx4 v[200:203], v7, s[40:43], 0 offen offset:0
    buffer_load_dwordx4 v[204:207], v7, s[40:43], 0 offen offset:128
    buffer_load_dwordx4 v[208:211], v7, s[40:43], 0 offen offset:256
    buffer_load_dwordx4 v[212:215], v7, s[40:43], 0 offen offset:384
    buffer_load_dwordx4 v[216:219], v7, s[40:43], 0 offen offset:512
    buffer_load_dwordx4 v[220:223], v7, s[40:43], 0 offen offset:640
    buffer_load_dwordx4 v[224:227], v7, s[40:43], 0 offen offset:768
    v_lshlrev_b32 v8, 7, v19
    v_lshl_add_u32 v8, v18, 4, v8
    s_waitcnt vmcnt(0)
    v_min_u32 v200, -2, v200
    v_min_u32 v201, -2, v201
    v_min_u32 v202, -2, v202
    v_min_u32 v203, -2, v203
    v_min_u32 v204, -2, v204
    v_min_u32 v205, -2, v205
    v_min_u32 v206, -2, v206
    v_min_u32 v207, -2, v207
    v_min_u32 v208, -2, v208
    v_min_u32 v209, -2, v209
    v_min_u32 v210, -2, v210
    v_min_u32 v211, -2, v211
    v_min_u32 v212, -2, v212
    v_min_u32 v213, -2, v213
    v_min_u32 v214, -2, v214
    v_min_u32 v215, -2, v215
    v_min_u32 v216, -2, v216
    v_min_u32 v217, -2, v217
    v_min_u32 v218, -2, v218
    v_min_u32 v219, -2, v219
    v_min_u32 v220, -2, v220
    v_min_u32 v221, -2, v221
    v_min_u32 v222, -2, v222
    v_min_u32 v223, -2, v223
    v_min_u32 v224, -2, v224
    v_min_u32 v225, -2, v225
    v_min_u32 v226, -2, v226
    v_min_u32 v227, -2, v227
    s_mov_b32 s33, 65608704
    buffer_store_dwordx4 v[200:203], v8, s[4:7], s33 offen sc1
    v_cndmask_b32 v24, v201, v200, s[100:101]
    v_cndmask_b32 v25, v203, v202, s[100:101]
    s_nop 0
    v_mov_b32_dpp v24, v24 row_ror:8 row_mask:0xf bank_mask:0xf
    v_mov_b32_dpp v25, v25 row_ror:8 row_mask:0xf bank_mask:0xf
    v_cndmask_b32 v20, v200, v24, s[100:101]
    v_cndmask_b32 v21, v202, v25, s[100:101]
    v_cndmask_b32 v22, v24, v201, s[100:101]
    v_cndmask_b32 v23, v25, v203, s[100:101]
    s_mov_b32 s34, 65601536
    buffer_store_dwordx4 v[20:23], v8, s[4:7], s34 offen sc1
    s_mov_b32 s33, 65609728
    buffer_store_dwordx4 v[204:207], v8, s[4:7], s33 offen sc1
    v_cndmask_b32 v30, v205, v204, s[100:101]
    v_cndmask_b32 v31, v207, v206, s[100:101]
    s_nop 0
    v_mov_b32_dpp v30, v30 row_ror:8 row_mask:0xf bank_mask:0xf
    v_mov_b32_dpp v31, v31 row_ror:8 row_mask:0xf bank_mask:0xf
    v_cndmask_b32 v26, v204, v30, s[100:101]
    v_cndmask_b32 v27, v206, v31, s[100:101]
    v_cndmask_b32 v28, v30, v205, s[100:101]
    v_cndmask_b32 v29, v31, v207, s[100:101]
    s_mov_b32 s34, 65602560
    buffer_store_dwordx4 v[26:29], v8, s[4:7], s34 offen sc1
    s_mov_b32 s33, 65610752
    buffer_store_dwordx4 v[208:211], v8, s[4:7], s33 offen sc1
    v_cndmask_b32 v24, v209, v208, s[100:101]
    v_cndmask_b32 v25, v211, v210, s[100:101]
    s_nop 0
    v_mov_b32_dpp v24, v24 row_ror:8 row_mask:0xf bank_mask:0xf
    v_mov_b32_dpp v25, v25 row_ror:8 row_mask:0xf bank_mask:0xf
    v_cndmask_b32 v20, v208, v24, s[100:101]
    v_cndmask_b32 v21, v210, v25, s[100:101]
    v_cndmask_b32 v22, v24, v209, s[100:101]
    v_cndmask_b32 v23, v25, v211, s[100:101]
    s_mov_b32 s34, 65603584
    buffer_store_dwordx4 v[20:23], v8, s[4:7], s34 offen sc1
    s_mov_b32 s33, 65611776
    buffer_store_dwordx4 v[212:215], v8, s[4:7], s33 offen sc1
    v_cndmask_b32 v30, v213, v212, s[100:101]
    v_cndmask_b32 v31, v215, v214, s[100:101]
    s_nop 0
    v_mov_b32_dpp v30, v30 row_ror:8 row_mask:0xf bank_mask:0xf
    v_mov_b32_dpp v31, v31 row_ror:8 row_mask:0xf bank_mask:0xf
    v_cndmask_b32 v26, v212, v30, s[100:101]
    v_cndmask_b32 v27, v214, v31, s[100:101]
    v_cndmask_b32 v28, v30, v213, s[100:101]
    v_cndmask_b32 v29, v31, v215, s[100:101]
    s_mov_b32 s34, 65604608
    buffer_store_dwordx4 v[26:29], v8, s[4:7], s34 offen sc1
    s_mov_b32 s33, 65612800
    buffer_store_dwordx4 v[216:219], v8, s[4:7], s33 offen sc1
    v_cndmask_b32 v24, v217, v216, s[100:101]
    v_cndmask_b32 v25, v219, v218, s[100:101]
    s_nop 0
    v_mov_b32_dpp v24, v24 row_ror:8 row_mask:0xf bank_mask:0xf
    v_mov_b32_dpp v25, v25 row_ror:8 row_mask:0xf bank_mask:0xf
    v_cndmask_b32 v20, v216, v24, s[100:101]
    v_cndmask_b32 v21, v218, v25, s[100:101]
    v_cndmask_b32 v22, v24, v217, s[100:101]
    v_cndmask_b32 v23, v25, v219, s[100:101]
    s_mov_b32 s34, 65605632
    buffer_store_dwordx4 v[20:23], v8, s[4:7], s34 offen sc1
    s_mov_b32 s33, 65613824
    buffer_store_dwordx4 v[220:223], v8, s[4:7], s33 offen sc1
    v_cndmask_b32 v30, v221, v220, s[100:101]
    v_cndmask_b32 v31, v223, v222, s[100:101]
    s_nop 0
    v_mov_b32_dpp v30, v30 row_ror:8 row_mask:0xf bank_mask:0xf
    v_mov_b32_dpp v31, v31 row_ror:8 row_mask:0xf bank_mask:0xf
    v_cndmask_b32 v26, v220, v30, s[100:101]
    v_cndmask_b32 v27, v222, v31, s[100:101]
    v_cndmask_b32 v28, v30, v221, s[100:101]
    v_cndmask_b32 v29, v31, v223, s[100:101]
    s_mov_b32 s34, 65606656
    buffer_store_dwordx4 v[26:29], v8, s[4:7], s34 offen sc1
    s_mov_b32 s33, 65614848
    buffer_store_dwordx4 v[224:227], v8, s[4:7], s33 offen sc1
    v_cndmask_b32 v24, v225, v224, s[100:101]
    v_cndmask_b32 v25, v227, v226, s[100:101]
    s_nop 0
    v_mov_b32_dpp v24, v24 row_ror:8 row_mask:0xf bank_mask:0xf
    v_mov_b32_dpp v25, v25 row_ror:8 row_mask:0xf bank_mask:0xf
    v_cndmask_b32 v20, v224, v24, s[100:101]
    v_cndmask_b32 v21, v226, v25, s[100:101]
    v_cndmask_b32 v22, v24, v225, s[100:101]
    v_cndmask_b32 v23, v25, v227, s[100:101]
    s_mov_b32 s34, 65607680
    buffer_store_dwordx4 v[20:23], v8, s[4:7], s34 offen sc1
p0_done:
    s_cmp_eq_u32 s16, 0
    s_cbranch_scc0 role_wait
    s_waitcnt vmcnt(14)
    v_readfirstlane_b32 s28, v1
    s_lshl_b32 s17, s26, 5
    s_add_u32 s17, s17, s28
    s_mov_b32 s27, s28
    s_cmp_lt_u32 s28, 32
    s_cbranch_scc1 role_cnt
    v_mov_b32 v1, 1
    v_mov_b32 v2, 16
    s_mov_b64 exec, 1
    buffer_atomic_add v1, v2, s[48:51], 0 offen sc0 sc1
    s_waitcnt vmcnt(0)
    v_readfirstlane_b32 s28, v1
    s_mov_b64 exec, -1
role_cnt:
    v_and_b32 v2, 7, v0
    v_lshlrev_b32 v2, 5, v2
    buffer_load_dword v1, v2, s[48:51], 0 offen sc1
    s_waitcnt vmcnt(0)
    v_readlane_b32 s30, v1, 0
    v_readlane_b32 s31, v1, 1
    v_readlane_b32 s32, v1, 2
    v_readlane_b32 s33, v1, 3
    v_readlane_b32 s34, v1, 4
    v_readlane_b32 s35, v1, 5
    v_readlane_b32 s36, v1, 6
    v_readlane_b32 s37, v1, 7
    s_add_u32 s38, s30, s31
    s_add_u32 s38, s38, s32
    s_add_u32 s38, s38, s33
    s_add_u32 s38, s38, s34
    s_add_u32 s38, s38, s35
    s_add_u32 s38, s38, s36
    s_add_u32 s38, s38, s37
    s_cmp_ge_u32 s38, 256
    s_cbranch_scc1 role_pick
    s_sub_u32 s18, s18, 1
    s_cbranch_scc1 main_end
    s_sleep 2
    s_branch role_cnt
role_pick:
    s_cmp_lt_u32 s27, 32
    s_cbranch_scc1 role_have
    s_min_u32 s29, s30, 32
    s_add_u32 s17, s29, 0
    s_add_u32 s17, s17, s28
    s_sub_u32 s29, 32, s29
    s_cmp_lt_u32 s28, s29
    s_cbranch_scc1 role_have
    s_sub_u32 s28, s28, s29
    s_min_u32 s29, s31, 32
    s_add_u32 s17, s29, 32
    s_add_u32 s17, s17, s28
    s_sub_u32 s29, 32, s29
    s_cmp_lt_u32 s28, s29
    s_cbranch_scc1 role_have
    s_sub_u32 s28, s28, s29
    s_min_u32 s29, s32, 32
    s_add_u32 s17, s29, 64
    s_add_u32 s17, s17, s28
    s_sub_u32 s29, 32, s29
    s_cmp_lt_u32 s28, s29
    s_cbranch_scc1 role_have
    s_sub_u32 s28, s28, s29
    s_min_u32 s29, s33, 32
    s_add_u32 s17, s29, 96
    s_add_u32 s17, s17, s28
    s_sub_u32 s29, 32, s29
    s_cmp_lt_u32 s28, s29
    s_cbranch_scc1 role_have
    s_sub_u32 s28, s28, s29
    s_min_u32 s29, s34, 32
    s_add_u32 s17, s29, 128
    s_add_u32 s17, s17, s28
    s_sub_u32 s29, 32, s29
    s_cmp_lt_u32 s28, s29
    s_cbranch_scc1 role_have
    s_sub_u32 s28, s28, s29
    s_min_u32 s29, s35, 32
    s_add_u32 s17, s29, 160
    s_add_u32 s17, s17, s28
    s_sub_u32 s29, 32, s29
    s_cmp_lt_u32 s28, s29
    s_cbranch_scc1 role_have
    s_sub_u32 s28, s28, s29
    s_min_u32 s29, s36, 32
    s_add_u32 s17, s29, 192
    s_add_u32 s17, s17, s28
    s_sub_u32 s29, 32, s29
    s_cmp_lt_u32 s28, s29
    s_cbranch_scc1 role_have
    s_sub_u32 s28, s28, s29
    s_min_u32 s29, s37, 32
    s_add_u32 s17, s29, 224
    s_add_u32 s17, s17, s28
    s_sub_u32 s29, 32, s29
    s_cmp_lt_u32 s28, s29
    s_cbranch_scc1 role_have
    s_sub_u32 s28, s28, s29
role_have:
    s_cmp_ge_u32 s30, 32
    s_cselect_b32 s19, 256, 0
    s_or_b32 s17, s17, s19
    v_mov_b32 v2, s17
    v_mov_b32 v1, 143360
    ds_write_b32 v1, v2
role_wait:
    s_waitcnt vmcnt(0) lgkmcnt(0)
    s_barrier
    v_mov_b32 v1, 143360
    ds_read_b32 v2, v1
    s_lshl_b32 s30, s24, 7
    s_lshl_b32 s31, s25, 2
    s_add_u32 s30, s30, s31
    s_add_u32 s30, s30, 69828608
    s_cmp_eq_u32 s16, 0
    s_cselect_b32 s30, s30, 0x7ff00000
    v_mov_b32 v5, 1
    v_mov_b32 v6, 0
    s_mov_b64 exec, 1
    buffer_store_dword v5, v6, s[4:7], s30 offen sc1
    s_mov_b64 exec, -1
    s_waitcnt lgkmcnt(0)
    v_readfirstlane_b32 s17, v2
    s_lshr_b32 s19, s17, 8
    s_and_b32 s17, s17, 255
role_go:
    s_lshr_b32 s26, s17, 5
    s_and_b32 s27, s17, 31
    s_cmp_lt_u32 s17, 16
    s_cbranch_scc1 role_A
    s_cmp_lt_u32 s17, 30
    s_cbranch_scc1 role_B
    s_cmp_eq_u32 s17, 30
    s_cbranch_scc1 role_R
    s_cmp_eq_u32 s17, 31
    s_cbranch_scc1 role_L
    s_cmp_lt_u32 s17, 96
    s_cbranch_scc1 role_V
    s_cmp_lt_u32 s17, 160
    s_cbranch_scc1 role_P
    s_cmp_lt_u32 s17, 176
    s_cbranch_scc1 role_H
    s_cmp_lt_u32 s17, 192
    s_cbranch_scc1 role_F
    s_sub_u32 s20, s17, 192
    s_lshl_b32 s20, s20, 2
    s_add_u32 s20, s20, s16
    s_mul_i32 s35, s16, 14336
    s_mul_i32 s21, s20, 2341
    s_lshr_b32 s21, s21, 16
    s_mul_i32 s22, s21, 28
    s_sub_u32 s22, s20, s22
    s_lshr_b32 s23, s22, 1
    s_and_b32 s22, s22, 1
    s_cmp_lt_u32 s21, 4
    s_cselect_b32 s30, s80, s82
    s_cselect_b32 s31, s81, s83
    s_movk_i32 s36, 896
    s_cselect_b32 s36, 3584, s36
    s_lshl_b32 s37, s23, 5
    s_mul_i32 s37, s37, s36
    s_mul_i32 s33, s22, 448
    s_add_u32 s37, s37, s33
    s_and_b32 s33, s21, 3
    s_cmp_lt_u32 s21, 4
    s_movk_i32 s34, 896
    s_cselect_b32 s34, s34, 401408
    s_mul_i32 s33, s33, s34
    s_add_u32 s37, s37, s33
    s_mov_b32 s60, s30
    s_and_b32 s61, s31, 0xffff
    s_mov_b32 s62, 1605632
    s_mov_b32 s63, 0x20000
    s_cmp_lt_u32 s20, 224
    s_cselect_b32 s62, s62, 0
    v_add_u32 v20, 0, v0
    v_mul_u32_u24 v21, 2341, v20
    v_lshrrev_b32 v21, 16, v21
    v_mul_u32_u24 v22, 28, v21
    v_sub_u32 v20, v20, v22
    v_mul_u32_u24 v21, s36, v21
    v_lshl_add_u32 v20, v20, 4, v21
    s_add_u32 m0, s35, 0
    s_nop 0
    buffer_load_dwordx4 v20, s[60:63], s37 offen lds
    v_add_u32 v20, 64, v0
    v_mul_u32_u24 v21, 2341, v20
    v_lshrrev_b32 v21, 16, v21
    v_mul_u32_u24 v22, 28, v21
    v_sub_u32 v20, v20, v22
    v_mul_u32_u24 v21, s36, v21
    v_lshl_add_u32 v20, v20, 4, v21
    s_add_u32 m0, s35, 1024
    s_nop 0
    buffer_load_dwordx4 v20, s[60:63], s37 offen lds
    v_add_u32 v20, 128, v0
    v_mul_u32_u24 v21, 2341, v20
    v_lshrrev_b32 v21, 16, v21
    v_mul_u32_u24 v22, 28, v21
    v_sub_u32 v20, v20, v22
    v_mul_u32_u24 v21, s36, v21
    v_lshl_add_u32 v20, v20, 4, v21
    s_add_u32 m0, s35, 2048
    s_nop 0
    buffer_load_dwordx4 v20, s[60:63], s37 offen lds
    v_add_u32 v20, 192, v0
    v_mul_u32_u24 v21, 2341, v20
    v_lshrrev_b32 v21, 16, v21
    v_mul_u32_u24 v22, 28, v21
    v_sub_u32 v20, v20, v22
    v_mul_u32_u24 v21, s36, v21
    v_lshl_add_u32 v20, v20, 4, v21
    s_add_u32 m0, s35, 3072
    s_nop 0
    buffer_load_dwordx4 v20, s[60:63], s37 offen lds
    v_add_u32 v20, 256, v0
    v_mul_u32_u24 v21, 2341, v20
    v_lshrrev_b32 v21, 16, v21
    v_mul_u32_u24 v22, 28, v21
    v_sub_u32 v20, v20, v22
    v_mul_u32_u24 v21, s36, v21
    v_lshl_add_u32 v20, v20, 4, v21
    s_add_u32 m0, s35, 4096
    s_nop 0
    buffer_load_dwordx4 v20, s[60:63], s37 offen lds
    v_add_u32 v20, 320, v0
    v_mul_u32_u24 v21, 2341, v20
    v_lshrrev_b32 v21, 16, v21
    v_mul_u32_u24 v22, 28, v21
    v_sub_u32 v20, v20, v22
    v_mul_u32_u24 v21, s36, v21
    v_lshl_add_u32 v20, v20, 4, v21
    s_add_u32 m0, s35, 5120
    s_nop 0
    buffer_load_dwordx4 v20, s[60:63], s37 offen lds
    v_add_u32 v20, 384, v0
    v_mul_u32_u24 v21, 2341, v20
    v_lshrrev_b32 v21, 16, v21
    v_mul_u32_u24 v22, 28, v21
    v_sub_u32 v20, v20, v22
    v_mul_u32_u24 v21, s36, v21
    v_lshl_add_u32 v20, v20, 4, v21
    s_add_u32 m0, s35, 6144
    s_nop 0
    buffer_load_dwordx4 v20, s[60:63], s37 offen lds
    v_add_u32 v20, 448, v0
    v_mul_u32_u24 v21, 2341, v20
    v_lshrrev_b32 v21, 16, v21
    v_mul_u32_u24 v22, 28, v21
    v_sub_u32 v20, v20, v22
    v_mul_u32_u24 v21, s36, v21
    v_lshl_add_u32 v20, v20, 4, v21
    s_add_u32 m0, s35, 7168
    s_nop 0
    buffer_load_dwordx4 v20, s[60:63], s37 offen lds
    v_add_u32 v20, 512, v0
    v_mul_u32_u24 v21, 2341, v20
    v_lshrrev_b32 v21, 16, v21
    v_mul_u32_u24 v22, 28, v21
    v_sub_u32 v20, v20, v22
    v_mul_u32_u24 v21, s36, v21
    v_lshl_add_u32 v20, v20, 4, v21
    s_add_u32 m0, s35, 8192
    s_nop 0
    buffer_load_dwordx4 v20, s[60:63], s37 offen lds
    v_add_u32 v20, 576, v0
    v_mul_u32_u24 v21, 2341, v20
    v_lshrrev_b32 v21, 16, v21
    v_mul_u32_u24 v22, 28, v21
    v_sub_u32 v20, v20, v22
    v_mul_u32_u24 v21, s36, v21
    v_lshl_add_u32 v20, v20, 4, v21
    s_add_u32 m0, s35, 9216
    s_nop 0
    buffer_load_dwordx4 v20, s[60:63], s37 offen lds
    v_add_u32 v20, 640, v0
    v_mul_u32_u24 v21, 2341, v20
    v_lshrrev_b32 v21, 16, v21
    v_mul_u32_u24 v22, 28, v21
    v_sub_u32 v20, v20, v22
    v_mul_u32_u24 v21, s36, v21
    v_lshl_add_u32 v20, v20, 4, v21
    s_add_u32 m0, s35, 10240
    s_nop 0
    buffer_load_dwordx4 v20, s[60:63], s37 offen lds
    v_add_u32 v20, 704, v0
    v_mul_u32_u24 v21, 2341, v20
    v_lshrrev_b32 v21, 16, v21
    v_mul_u32_u24 v22, 28, v21
    v_sub_u32 v20, v20, v22
    v_mul_u32_u24 v21, s36, v21
    v_lshl_add_u32 v20, v20, 4, v21
    s_add_u32 m0, s35, 11264
    s_nop 0
    buffer_load_dwordx4 v20, s[60:63], s37 offen lds
    v_add_u32 v20, 768, v0
    v_mul_u32_u24 v21, 2341, v20
    v_lshrrev_b32 v21, 16, v21
    v_mul_u32_u24 v22, 28, v21
    v_sub_u32 v20, v20, v22
    v_mul_u32_u24 v21, s36, v21
    v_lshl_add_u32 v20, v20, 4, v21
    s_add_u32 m0, s35, 12288
    s_nop 0
    buffer_load_dwordx4 v20, s[60:63], s37 offen lds
    v_add_u32 v20, 832, v0
    v_mul_u32_u24 v21, 2341, v20
    v_lshrrev_b32 v21, 16, v21
    v_mul_u32_u24 v22, 28, v21
    v_sub_u32 v20, v20, v22
    v_mul_u32_u24 v21, s36, v21
    v_lshl_add_u32 v20, v20, 4, v21
    s_add_u32 m0, s35, 13312
    s_nop 0
    buffer_load_dwordx4 v20, s[60:63], s37 offen lds
    v_mov_b32 v24, -1
    v_mov_b32 v25, -1
    v_mov_b32 v26, -1
    v_mov_b32 v27, -1
    s_mul_i32 s30, s20, 10240
    s_add_u32 s30, s30, 67174400
    buffer_store_dwordx4 v[24:27], v17, s[4:7], s30 offen offset:0 sc1
    buffer_store_dwordx4 v[24:27], v17, s[4:7], s30 offen offset:1024 sc1
    buffer_store_dwordx4 v[24:27], v17, s[4:7], s30 offen offset:2048 sc1
    buffer_store_dwordx4 v[24:27], v17, s[4:7], s30 offen offset:3072 sc1
    s_add_u32 s30, s30, 4096
    buffer_store_dwordx4 v[24:27], v17, s[4:7], s30 offen offset:0 sc1
    buffer_store_dwordx4 v[24:27], v17, s[4:7], s30 offen offset:1024 sc1
    buffer_store_dwordx4 v[24:27], v17, s[4:7], s30 offen offset:2048 sc1
    buffer_store_dwordx4 v[24:27], v17, s[4:7], s30 offen offset:3072 sc1
    s_add_u32 s30, s30, 4096
    buffer_store_dwordx4 v[24:27], v17, s[4:7], s30 offen offset:0 sc1
    buffer_store_dwordx4 v[24:27], v17, s[4:7], s30 offen offset:1024 sc1
    s_mul_i32 s30, s20, 2048
    s_add_u32 s30, s30, 65142784
    s_cmp_lt_u32 s20, 224
    s_cbranch_scc0 h_done
    buffer_store_dwordx4 v[24:27], v17, s[4:7], s30 offen offset:0 sc1
    buffer_store_dwordx4 v[24:27], v17, s[4:7], s30 offen offset:1024 sc1
    v_lshrrev_b32 v5, 2, v4
    v_and_b32 v6, 3, v4
    s_cmp_lt_u32 s21, 4
    s_cselect_b32 s53, 8, 4
    s_cselect_b32 s55, 4, 16
    s_mul_i32 s55, s55, 448
    v_mul_u32_u24 v7, s53, v3
    v_add_u32 v7, v7, v5
    v_mul_u32_u24 v7, 448, v7
    v_lshl_add_u32 v7, v6, 3, v7
    v_add_u32 v7, s35, v7
    v_add_u32 v8, s55, v7
    s_add_u32 s38, s21, 32
    s_mul_i32 s38, s38, 28
    s_mul_i32 s39, s22, 14
    s_add_u32 s38, s38, s39
    s_mul_i32 s38, s38, 14336
    s_lshl_b32 s39, s23, 10
    s_add_u32 s38, s38, s39
    s_waitcnt vmcnt(12)
    ds_read_b64_tr_b16 v[64:65], v7 offset:0
    ds_read_b64_tr_b16 v[66:67], v8 offset:0
    ds_read_b64_tr_b16 v[68:69], v7 offset:32
    ds_read_b64_tr_b16 v[70:71], v8 offset:32
    ds_read_b64_tr_b16 v[72:73], v7 offset:64
    ds_read_b64_tr_b16 v[74:75], v8 offset:64
    ds_read_b64_tr_b16 v[76:77], v7 offset:96
    ds_read_b64_tr_b16 v[78:79], v8 offset:96
    ds_read_b64_tr_b16 v[80:81], v7 offset:128
    ds_read_b64_tr_b16 v[82:83], v8 offset:128
    ds_read_b64_tr_b16 v[84:85], v7 offset:160
    ds_read_b64_tr_b16 v[86:87], v8 offset:160
    ds_read_b64_tr_b16 v[88:89], v7 offset:192
    ds_read_b64_tr_b16 v[90:91], v8 offset:192
    s_waitcnt lgkmcnt(12)
    buffer_store_dwordx4 v[64:67], v17, s[4:7], s38 offen sc1
    s_add_u32 s38, s38, 14336
    ds_read_b64_tr_b16 v[92:93], v7 offset:224
    ds_read_b64_tr_b16 v[94:95], v8 offset:224
    s_waitcnt lgkmcnt(12)
    buffer_store_dwordx4 v[68:71], v17, s[4:7], s38 offen sc1
    s_add_u32 s38, s38, 14336
    ds_read_b64_tr_b16 v[96:97], v7 offset:256
    ds_read_b64_tr_b16 v[98:99], v8 offset:256
    s_waitcnt lgkmcnt(12)
    buffer_store_dwordx4 v[72:75], v17, s[4:7], s38 offen sc1
    s_add_u32 s38, s38, 14336
    ds_read_b64_tr_b16 v[100:101], v7 offset:288
    ds_read_b64_tr_b16 v[102:103], v8 offset:288
    s_waitcnt lgkmcnt(12)
    buffer_store_dwordx4 v[76:79], v17, s[4:7], s38 offen sc1
    s_add_u32 s38, s38, 14336
    ds_read_b64_tr_b16 v[104:105], v7 offset:320
    ds_read_b64_tr_b16 v[106:107], v8 offset:320
    s_waitcnt lgkmcnt(12)
    buffer_store_dwordx4 v[80:83], v17, s[4:7], s38 offen sc1
    s_add_u32 s38, s38, 14336
    ds_read_b64_tr_b16 v[108:109], v7 offset:352
    ds_read_b64_tr_b16 v[110:111], v8 offset:352
    s_waitcnt lgkmcnt(12)
    buffer_store_dwordx4 v[84:87], v17, s[4:7], s38 offen sc1
    s_add_u32 s38, s38, 14336
    ds_read_b64_tr_b16 v[112:113], v7 offset:384
    ds_read_b64_tr_b16 v[114:115], v8 offset:384
    s_waitcnt lgkmcnt(12)
    buffer_store_dwordx4 v[88:91], v17, s[4:7], s38 offen sc1
    s_add_u32 s38, s38, 14336
    ds_read_b64_tr_b16 v[116:117], v7 offset:416
    ds_read_b64_tr_b16 v[118:119], v8 offset:416
    s_waitcnt lgkmcnt(12)
    buffer_store_dwordx4 v[92:95], v17, s[4:7], s38 offen sc1
    s_add_u32 s38, s38, 14336
    s_waitcnt lgkmcnt(10)
    buffer_store_dwordx4 v[96:99], v17, s[4:7], s38 offen sc1
    s_add_u32 s38, s38, 14336
    s_waitcnt lgkmcnt(8)
    buffer_store_dwordx4 v[100:103], v17, s[4:7], s38 offen sc1
    s_add_u32 s38, s38, 14336
    s_waitcnt lgkmcnt(6)
    buffer_store_dwordx4 v[104:107], v17, s[4:7], s38 offen sc1
    s_add_u32 s38, s38, 14336
    s_waitcnt lgkmcnt(4)
    buffer_store_dwordx4 v[108:111], v17, s[4:7], s38 offen sc1
    s_add_u32 s38, s38, 14336
    s_waitcnt lgkmcnt(2)
    buffer_store_dwordx4 v[112:115], v17, s[4:7], s38 offen sc1
    s_add_u32 s38, s38, 14336
    s_waitcnt lgkmcnt(0)
    buffer_store_dwordx4 v[116:119], v17, s[4:7], s38 offen sc1
    s_add_u32 s38, s38, 14336
h_done:
    s_lshl_b32 s30, s17, 2
    s_add_u32 s30, s30, 69831936
    s_waitcnt vmcnt(0)
    s_barrier
    s_cmp_eq_u32 s16, 0
    s_cbranch_scc0 noflag_1
    v_mov_b32 v5, 1
    v_mov_b32 v6, 0
    s_mov_b64 exec, 1
    buffer_store_dword v5, v6, s[4:7], s30 offen sc1
    s_mov_b64 exec, -1
noflag_1:
    s_cmp_lt_u32 s27, 28
    s_cbranch_scc1 role_O
    s_cmp_eq_u32 s17, 255
    s_cbranch_scc0 main_end
    v_and_b32 v12, 1, v0
    v_lshlrev_b32 v12, 4, v12
    v_lshrrev_b32 v16, 1, v0
    v_lshl_add_u32 v16, v16, 7, v12
    v_add_u32 v16, 69828608, v16
    s_cmp_eq_u32 s16, 0
    s_cbranch_scc0 wad_3
wa_2:
    buffer_load_dwordx4 v[12:15], v16, s[4:7], 0 offen sc1
    s_waitcnt vmcnt(0)
    v_min3_u32 v12, v12, v13, v14
    v_min_u32 v12, v12, v15
    v_cmp_eq_u32 vcc, 0, v12
    s_cbranch_vccz wad_3
    s_sub_u32 s18, s18, 1
    s_cbranch_scc1 main_end2
    s_sleep 4
    s_branch wa_2
wad_3:
    s_waitcnt vmcnt(0)
    s_barrier
    v_lshlrev_b32 v13, 2, v0
    v_add_u32 v13, 69832704, v13
    s_cmp_eq_u32 s16, 0
    s_cbranch_scc0 wad_5
wa_4:
    buffer_load_dword v12, v13, s[4:7], 0 offen sc1
    s_waitcnt vmcnt(0)
    v_cmp_eq_u32 vcc, 0, v12
    s_cbranch_vccz wad_5
    s_sub_u32 s18, s18, 1
    s_cbranch_scc1 main_end2
    s_sleep 4
    s_branch wa_4
wad_5:
    s_waitcnt vmcnt(0)
    s_barrier
    v_lshlrev_b32 v13, 7, v0
    v_mov_b32 v12, 1
    s_mov_b32 s30, 69833728
    s_cmp_eq_u32 s16, 0
    s_cselect_b32 s30, s30, 0x7ff00000
    s_mov_b64 exec, 0xff
    buffer_store_dword v12, v13, s[4:7], s30 offen sc1
    s_mov_b64 exec, -1
main_end:
    s_endpgm
role_A:
    s_lshr_b32 s28, s16, 1
    s_mul_i32 s28, s28, 7
    s_and_b32 s29, s16, 1
    s_cmp_eq_u32 s29, 0
    s_cselect_b32 s30, 0, 5
    s_add_u32 s30, s30, s28
    s_sub_u32 s31, s30, 14
    s_cselect_b32 s40, s30, s31
    s_cmp_eq_u32 s29, 0
    s_cselect_b32 s30, 1, 6
    s_add_u32 s30, s30, s28
    s_sub_u32 s31, s30, 14
    s_cselect_b32 s41, s30, s31
    s_cmp_eq_u32 s29, 0
    s_cselect_b32 s30, 2, 4
    s_add_u32 s30, s30, s28
    s_sub_u32 s31, s30, 14
    s_cselect_b32 s42, s30, s31
    s_cmp_eq_u32 s29, 0
    s_cselect_b32 s30, 3, 3
    s_add_u32 s30, s30, s28
    s_sub_u32 s31, s30, 14
    s_cselect_b32 s43, s30, s31
    s_cmp_eq_u32 s29, 0
    s_cselect_b32 s30, 4, 7
    s_add_u32 s30, s30, s28
    s_sub_u32 s31, s30, 14
    s_cselect_b32 s44, s30, s31
    s_cmp_eq_u32 s29, 0
    s_cselect_b32 s30, 5, 8
    s_add_u32 s30, s30, s28
    s_sub_u32 s31, s30, 14
    s_cselect_b32 s45, s30, s31
    s_cmp_eq_u32 s29, 0
    s_cselect_b32 s30, 6, 9
    s_add_u32 s30, s30, s28
    s_sub_u32 s31, s30, 14
    s_cselect_b32 s46, s30, s31
    s_cmp_eq_u32 s29, 0
    s_cselect_b32 s30, 7, 10
    s_add_u32 s30, s30, s28
    s_sub_u32 s31, s30, 14
    s_cselect_b32 s47, s30, s31
    s_cmp_eq_u32 s29, 0
    s_cselect_b32 s30, 8, 11
    s_add_u32 s30, s30, s28
    s_sub_u32 s31, s30, 14
    s_cselect_b32 s48, s30, s31
    s_cmp_eq_u32 s29, 0
    s_cselect_b32 s30, 9, 12
    s_add_u32 s30, s30, s28
    s_sub_u32 s31, s30, 14
    s_cselect_b32 s49, s30, s31
    s_cmp_eq_u32 s29, 0
    s_cselect_b32 s30, 10, 13
    s_add_u32 s30, s30, s28
    s_sub_u32 s31, s30, 14
    s_cselect_b32 s50, s30, s31
    s_cmp_eq_u32 s29, 0
    s_cselect_b32 s30, 11, 14
    s_add_u32 s30, s30, s28
    s_sub_u32 s31, s30, 14
    s_cselect_b32 s51, s30, s31
    s_cmp_eq_u32 s29, 0
    s_cselect_b32 s30, 12, 15
    s_add_u32 s30, s30, s28
    s_sub_u32 s31, s30, 14
    s_cselect_b32 s52, s30, s31
    s_cmp_eq_u32 s29, 0
    s_cselect_b32 s30, 13, 16
    s_add_u32 s30, s30, s28
    s_sub_u32 s31, s30, 14
    s_cselect_b32 s53, s30, s31
    v_lshrrev_b32 v81, 4, v0
    v_and_b32 v82, 15, v0
    v_and_b32 v83, 4, v82
    v_lshlrev_b32 v83, 1, v83
    v_and_b32 v84, 2, v82
    v_lshl_add_u32 v83, v84, 1, v83
    v_lshrrev_b32 v84, 3, v82
    v_lshl_add_u32 v83, v84, 1, v83
    v_and_b32 v84, 1, v82
    v_add_u32 v83, v83, v84
    v_and_b32 v84, 1, v81
    v_lshlrev_b32 v85, 8, v84
    v_lshl_add_u32 v83, v83, 4, v85
    v_cmp_eq_u32 s[56:57], 1, v84
    v_cmp_lt_u32 s[58:59], 31, v0
    s_mul_i32 s20, s17, 401408
    s_lshl_b32 s30, s40, 1
    s_add_u32 s30, s30, 0
    s_mul_i32 s30, s30, 14336
    s_add_u32 s64, s30, s20
    s_lshl_b32 s30, s40, 1
    s_add_u32 s30, s30, 1
    s_mul_i32 s30, s30, 14336
    s_add_u32 s65, s30, s20
    s_lshl_b32 s30, s41, 1
    s_add_u32 s30, s30, 0
    s_mul_i32 s30, s30, 14336
    s_add_u32 s66, s30, s20
    s_lshl_b32 s30, s41, 1
    s_add_u32 s30, s30, 1
    s_mul_i32 s30, s30, 14336
    s_add_u32 s67, s30, s20
    s_lshl_b32 s30, s42, 1
    s_add_u32 s30, s30, 0
    s_mul_i32 s30, s30, 14336
    s_add_u32 s68, s30, s20
    s_lshl_b32 s30, s42, 1
    s_add_u32 s30, s30, 1
    s_mul_i32 s30, s30, 14336
    s_add_u32 s69, s30, s20
    s_lshl_b32 s30, s43, 1
    s_add_u32 s30, s30, s29
    s_mul_i32 s30, s30, 14336
    s_add_u32 s70, s30, s20
    s_lshl_b32 s35, s16, 13
    v_and_b32 v9, 7, v0
    v_bfe_u32 v10, v0, 3, 0
    v_add_u32 v10, s17, v10
    v_lshlrev_b32 v10, 7, v10
    v_lshl_add_u32 v9, v9, 2, v10
    v_add_u32 v9, 69828608, v9
    s_cmp_eq_u32 s16, 0
    s_cbranch_scc0 wad_7
wa_6:
    buffer_load_dword v8, v9, s[4:7], 0 offen sc1
    s_waitcnt vmcnt(0)
    v_cmp_eq_u32 vcc, 0, v8
    s_cbranch_vccz wad_7
    s_sub_u32 s18, s18, 1
    s_cbranch_scc1 main_end2
    s_sleep 2
    s_branch wa_6
wad_7:
    s_waitcnt vmcnt(0)
    s_barrier
    v_mov_b32 v8, s40
    v_mov_b32 v86, s41
    v_cndmask_b32 v8, v8, v86, s[58:59]
    v_lshl_add_u32 v8, v8, 10, v83
    s_add_u32 m0, s35, 0
    s_nop 0
    buffer_load_dwordx4 v8, s[4:7], s64 offen offset:0 lds
    s_add_u32 m0, s35, 512
    s_nop 0
    buffer_load_dwordx4 v8, s[4:7], s64 offen offset:512 lds
    s_add_u32 m0, s35, 2048
    s_nop 0
    buffer_load_dwordx4 v8, s[4:7], s65 offen offset:0 lds
    s_add_u32 m0, s35, 2560
    s_nop 0
    buffer_load_dwordx4 v8, s[4:7], s65 offen offset:512 lds
    s_add_u32 m0, s35, 4096
    s_nop 0
    buffer_load_dwordx4 v8, s[4:7], s66 offen offset:0 lds
    s_add_u32 m0, s35, 4608
    s_nop 0
    buffer_load_dwordx4 v8, s[4:7], s66 offen offset:512 lds
    s_add_u32 m0, s35, 6144
    s_nop 0
    buffer_load_dwordx4 v8, s[4:7], s67 offen offset:0 lds
    s_add_u32 m0, s35, 6656
    s_nop 0
    buffer_load_dwordx4 v8, s[4:7], s67 offen offset:512 lds
    buffer_load_dwordx4 a[0:3], v8, s[4:7], s68 offen offset:0
    buffer_load_dwordx4 a[4:7], v8, s[4:7], s68 offen offset:512
    buffer_load_dwordx4 a[8:11], v8, s[4:7], s69 offen offset:0
    buffer_load_dwordx4 a[12:15], v8, s[4:7], s69 offen offset:512
    buffer_load_dwordx4 a[16:19], v8, s[4:7], s70 offen offset:0
    buffer_load_dwordx4 a[20:23], v8, s[4:7], s70 offen offset:512
    v_mov_b32 v9, s42
    v_mov_b32 v86, s43
    v_cndmask_b32 v9, v9, v86, s[58:59]
    v_lshl_add_u32 v9, v9, 10, v83
    buffer_load_dwordx4 a[24:27], v9, s[4:7], s64 offen offset:0
    buffer_load_dwordx4 a[28:31], v9, s[4:7], s64 offen offset:512
    buffer_load_dwordx4 a[32:35], v9, s[4:7], s65 offen offset:0
    buffer_load_dwordx4 a[36:39], v9, s[4:7], s65 offen offset:512
    buffer_load_dwordx4 a[40:43], v9, s[4:7], s66 offen offset:0
    buffer_load_dwordx4 a[44:47], v9, s[4:7], s66 offen offset:512
    buffer_load_dwordx4 a[48:51], v9, s[4:7], s67 offen offset:0
    buffer_load_dwordx4 a[52:55], v9, s[4:7], s67 offen offset:512
    buffer_load_dwordx4 a[56:59], v9, s[4:7], s68 offen offset:0
    buffer_load_dwordx4 a[60:63], v9, s[4:7], s68 offen offset:512
    buffer_load_dwordx4 a[64:67], v9, s[4:7], s69 offen offset:0
    buffer_load_dwordx4 a[68:71], v9, s[4:7], s69 offen offset:512
    buffer_load_dwordx4 a[72:75], v9, s[4:7], s70 offen offset:0
    buffer_load_dwordx4 a[76:79], v9, s[4:7], s70 offen offset:512
    v_mov_b32 v10, s44
    v_mov_b32 v86, s45
    v_cndmask_b32 v10, v10, v86, s[58:59]
    v_lshl_add_u32 v10, v10, 10, v83
    buffer_load_dwordx4 a[80:83], v10, s[4:7], s64 offen offset:0
    buffer_load_dwordx4 a[84:87], v10, s[4:7], s64 offen offset:512
    buffer_load_dwordx4 a[88:91], v10, s[4:7], s65 offen offset:0
    buffer_load_dwordx4 a[92:95], v10, s[4:7], s65 offen offset:512
    buffer_load_dwordx4 a[96:99], v10, s[4:7], s66 offen offset:0
    buffer_load_dwordx4 a[100:103], v10, s[4:7], s66 offen offset:512
    buffer_load_dwordx4 a[104:107], v10, s[4:7], s67 offen offset:0
    buffer_load_dwordx4 a[108:111], v10, s[4:7], s67 offen offset:512
    buffer_load_dwordx4 a[112:115], v10, s[4:7], s68 offen offset:0
    buffer_load_dwordx4 a[116:119], v10, s[4:7], s68 offen offset:512
    buffer_load_dwordx4 a[120:123], v10, s[4:7], s69 offen offset:0
    buffer_load_dwordx4 a[124:127], v10, s[4:7], s69 offen offset:512
    buffer_load_dwordx4 a[128:131], v10, s[4:7], s70 offen offset:0
    buffer_load_dwordx4 a[132:135], v10, s[4:7], s70 offen offset:512
    v_mov_b32 v11, s46
    v_mov_b32 v86, s47
    v_cndmask_b32 v11, v11, v86, s[58:59]
    v_lshl_add_u32 v11, v11, 10, v83
    buffer_load_dwordx4 a[136:139], v11, s[4:7], s64 offen offset:0
    buffer_load_dwordx4 a[140:143], v11, s[4:7], s64 offen offset:512
    buffer_load_dwordx4 a[144:147], v11, s[4:7], s65 offen offset:0
    buffer_load_dwordx4 a[148:151], v11, s[4:7], s65 offen offset:512
    buffer_load_dwordx4 a[152:155], v11, s[4:7], s66 offen offset:0
    buffer_load_dwordx4 a[156:159], v11, s[4:7], s66 offen offset:512
    buffer_load_dwordx4 a[160:163], v11, s[4:7], s67 offen offset:0
    buffer_load_dwordx4 a[164:167], v11, s[4:7], s67 offen offset:512
    buffer_load_dwordx4 a[168:171], v11, s[4:7], s68 offen offset:0
    buffer_load_dwordx4 a[172:175], v11, s[4:7], s68 offen offset:512
    buffer_load_dwordx4 a[176:179], v11, s[4:7], s69 offen offset:0
    buffer_load_dwordx4 a[180:183], v11, s[4:7], s69 offen offset:512
    buffer_load_dwordx4 a[184:187], v11, s[4:7], s70 offen offset:0
    buffer_load_dwordx4 a[188:191], v11, s[4:7], s70 offen offset:512
    v_mov_b32 v12, s48
    v_mov_b32 v86, s49
    v_cndmask_b32 v12, v12, v86, s[58:59]
    v_lshl_add_u32 v12, v12, 10, v83
    buffer_load_dwordx4 a[192:195], v12, s[4:7], s64 offen offset:0
    buffer_load_dwordx4 a[196:199], v12, s[4:7], s64 offen offset:512
    buffer_load_dwordx4 a[200:203], v12, s[4:7], s65 offen offset:0
    buffer_load_dwordx4 a[204:207], v12, s[4:7], s65 offen offset:512
    buffer_load_dwordx4 a[208:211], v12, s[4:7], s66 offen offset:0
    buffer_load_dwordx4 a[212:215], v12, s[4:7], s66 offen offset:512
    buffer_load_dwordx4 a[216:219], v12, s[4:7], s67 offen offset:0
    buffer_load_dwordx4 a[220:223], v12, s[4:7], s67 offen offset:512
    buffer_load_dwordx4 a[224:227], v12, s[4:7], s68 offen offset:0
    buffer_load_dwordx4 a[228:231], v12, s[4:7], s68 offen offset:512
    buffer_load_dwordx4 a[232:235], v12, s[4:7], s69 offen offset:0
    buffer_load_dwordx4 a[236:239], v12, s[4:7], s69 offen offset:512
    buffer_load_dwordx4 a[240:243], v12, s[4:7], s70 offen offset:0
    buffer_load_dwordx4 a[244:247], v12, s[4:7], s70 offen offset:512
    v_mov_b32 v13, s50
    v_mov_b32 v86, s51
    v_cndmask_b32 v13, v13, v86, s[58:59]
    v_lshl_add_u32 v13, v13, 10, v83
    buffer_load_dwordx4 a[248:251], v13, s[4:7], s64 offen offset:0
    buffer_load_dwordx4 a[252:255], v13, s[4:7], s64 offen offset:512
    buffer_load_dwordx4 v[152:155], v13, s[4:7], s65 offen offset:0
    buffer_load_dwordx4 v[156:159], v13, s[4:7], s65 offen offset:512
    buffer_load_dwordx4 v[160:163], v13, s[4:7], s66 offen offset:0
    buffer_load_dwordx4 v[164:167], v13, s[4:7], s66 offen offset:512
    buffer_load_dwordx4 v[168:171], v13, s[4:7], s67 offen offset:0
    buffer_load_dwordx4 v[172:175], v13, s[4:7], s67 offen offset:512
    buffer_load_dwordx4 v[176:179], v13, s[4:7], s68 offen offset:0
    buffer_load_dwordx4 v[180:183], v13, s[4:7], s68 offen offset:512
    buffer_load_dwordx4 v[184:187], v13, s[4:7], s69 offen offset:0
    buffer_load_dwordx4 v[188:191], v13, s[4:7], s69 offen offset:512
    buffer_load_dwordx4 v[192:195], v13, s[4:7], s70 offen offset:0
    buffer_load_dwordx4 v[196:199], v13, s[4:7], s70 offen offset:512
    v_mov_b32 v14, s52
    v_mov_b32 v86, s53
    v_cndmask_b32 v14, v14, v86, s[58:59]
    v_lshl_add_u32 v14, v14, 10, v83
    buffer_load_dwordx4 v[200:203], v14, s[4:7], s64 offen offset:0
    buffer_load_dwordx4 v[204:207], v14, s[4:7], s64 offen offset:512
    buffer_load_dwordx4 v[208:211], v14, s[4:7], s65 offen offset:0
    buffer_load_dwordx4 v[212:215], v14, s[4:7], s65 offen offset:512
    buffer_load_dwordx4 v[216:219], v14, s[4:7], s66 offen offset:0
    buffer_load_dwordx4 v[220:223], v14, s[4:7], s66 offen offset:512
    buffer_load_dwordx4 v[224:227], v14, s[4:7], s67 offen offset:0
    buffer_load_dwordx4 v[228:231], v14, s[4:7], s67 offen offset:512
    buffer_load_dwordx4 v[232:235], v14, s[4:7], s68 offen offset:0
    buffer_load_dwordx4 v[236:239], v14, s[4:7], s68 offen offset:512
    buffer_load_dwordx4 v[240:243], v14, s[4:7], s69 offen offset:0
    buffer_load_dwordx4 v[244:247], v14, s[4:7], s69 offen offset:512
    buffer_load_dwordx4 v[248:251], v14, s[4:7], s70 offen offset:0
    buffer_load_dwordx4 v[252:255], v14, s[4:7], s70 offen offset:512
    v_lshrrev_b32 v84, 1, v81
    v_lshlrev_b32 v85, 4, v82
    v_lshl_add_u32 v83, v84, 8, v85
    v_lshl_add_u32 v85, v84, 10, v85
    v_mov_b32 v1, s40
    v_mov_b32 v86, s41
    v_cndmask_b32 v86, v1, v86, s[56:57]
    v_lshl_add_u32 v1, v86, 9, v83
    v_lshl_add_u32 v72, v86, 11, v85
    v_mov_b32 v2, s42
    v_mov_b32 v86, s43
    v_cndmask_b32 v86, v2, v86, s[56:57]
    v_lshl_add_u32 v2, v86, 9, v83
    v_lshl_add_u32 v73, v86, 11, v85
    v_mov_b32 v3, s44
    v_mov_b32 v86, s45
    v_cndmask_b32 v86, v3, v86, s[56:57]
    v_lshl_add_u32 v3, v86, 9, v83
    v_mov_b32 v4, s46
    v_mov_b32 v86, s47
    v_cndmask_b32 v86, v4, v86, s[56:57]
    v_lshl_add_u32 v4, v86, 9, v83
    v_mov_b32 v5, s48
    v_mov_b32 v86, s49
    v_cndmask_b32 v86, v5, v86, s[56:57]
    v_lshl_add_u32 v5, v86, 9, v83
    v_mov_b32 v6, s50
    v_mov_b32 v86, s51
    v_cndmask_b32 v86, v6, v86, s[56:57]
    v_lshl_add_u32 v6, v86, 9, v83
    v_mov_b32 v7, s52
    v_mov_b32 v86, s53
    v_cndmask_b32 v86, v7, v86, s[56:57]
    v_lshl_add_u32 v7, v86, 9, v83
    v_mov_b32 v114, 0x4444
    v_mov_b32 v118, 0xeeee
    v_cmp_gt_u32 vcc, 8, v82
    s_nop 1
    v_cndmask_b32 v114, v118, v114, vcc
    v_and_b32 v15, 1, v82
    v_lshrrev_b32 v83, 2, v82
    v_lshl_add_u32 v15, v83, 1, v15
    v_bfe_u32 v83, v82, 1, 1
    v_lshl_add_u32 v15, v83, 3, v15
    v_mov_b32 v115, 0x4444
    v_mov_b32 v118, 0xeeee
    v_cmp_gt_u32 vcc, 8, v15
    s_nop 1
    v_cndmask_b32 v115, v118, v115, vcc
    v_lshrrev_b32 v83, 2, v15
    v_xor_b32 v83, v83, v81
    v_and_b32 v83, 1, v83
    v_and_b32 v84, 1, v15
    v_lshlrev_b32 v84, 4, v84
    v_mov_b32 v85, 0x3f80
    v_lshlrev_b32 v84, v84, v85
    v_cmp_eq_u32 vcc, 0, v83
    s_nop 1
    v_cndmask_b32 v84, 0, v84, vcc
    v_lshrrev_b32 v83, 3, v15
    v_bfe_u32 v85, v15, 1, 1
    v_lshl_add_u32 v83, v83, 1, v85
    v_cmp_eq_u32 vcc, 0, v83
    s_nop 1
    v_cndmask_b32 v108, 0, v84, vcc
    v_cmp_eq_u32 vcc, 1, v83
    s_nop 1
    v_cndmask_b32 v109, 0, v84, vcc
    v_cmp_eq_u32 vcc, 2, v83
    s_nop 1
    v_cndmask_b32 v110, 0, v84, vcc
    v_cmp_eq_u32 vcc, 3, v83
    s_nop 1
    v_cndmask_b32 v111, 0, v84, vcc
    s_cmp_eq_u32 s29, 0
    s_cselect_b64 vcc, -1, 0
    v_cndmask_b32 v112, v110, v108, vcc
    v_cndmask_b32 v113, v111, v109, vcc
    v_mul_u32_u24 v83, 416, v81
    s_mul_i32 s30, s16, 1664
    s_add_u32 s30, s30, 40960
    v_lshl_add_u32 v83, v82, 2, v83
    v_add_u32 v74, s30, v83
    v_and_b32 v83, 7, v0
    v_mul_u32_u24 v83, 208, v83
    v_add_u32 v83, s30, v83
    v_mov_b32 v24, 0xf149f2ca
    v_mov_b32 v25, v24
    ds_write_b64 v83, v[24:25] offset:192
    v_and_b32 v83, 31, v0
    v_lshrrev_b32 v84, 5, v0
    s_lshl_b32 s30, s16, 1
    v_add_u32 v84, s30, v84
    v_and_b32 v85, 1, v83
    v_lshlrev_b32 v85, 4, v85
    v_and_b32 v86, 8, v83
    v_add_u32 v85, v85, v86
    v_and_b32 v86, 2, v83
    v_lshl_add_u32 v85, v86, 1, v85
    v_bfe_u32 v86, v83, 2, 1
    v_lshl_add_u32 v85, v86, 1, v85
    v_lshlrev_b32 v86, 1, v83
    v_cmp_gt_u32 vcc, 16, v83
    s_nop 1
    v_cndmask_b32 v85, v86, v85, vcc
    v_cmp_gt_u32 s[60:61], 20, v83
    s_nop 1
    v_cndmask_b32 v85, 48, v85, s[60:61]
    v_mul_u32_u24 v86, 208, v84
    v_lshl_add_u32 v85, v85, 2, v86
    v_add_u32 v75, 40960, v85
    v_add_u32 v76, 3328, v75
    v_lshrrev_b32 v85, 3, v83
    v_lshlrev_b32 v85, 8, v85
    v_bfe_u32 v86, v83, 2, 1
    v_lshl_add_u32 v85, v86, 5, v85
    s_and_b32 s30, s17, 1
    s_lshl_b32 s31, s30, 9
    s_lshl_b32 s30, s30, 5
    s_add_u32 s30, s30, 1024
    v_add_u32 v85, s31, v85
    v_mov_b32 v86, s30
    v_cmp_gt_u32 vcc, 16, v83
    s_nop 1
    v_cndmask_b32 v85, v86, v85, vcc
    s_lshl_b32 s30, s16, 6
    v_lshrrev_b32 v86, 5, v0
    v_lshl_add_u32 v86, v86, 4, s30
    v_add_u32 v85, v85, v86
    v_and_b32 v86, 3, v83
    v_lshl_add_u32 v85, v86, 2, v85
    v_bfrev_b32 v86, 1
    v_cndmask_b32 v77, v86, v85, s[60:61]
    s_lshr_b32 s25, s17, 2
    s_lshl_b32 s25, s25, 7
    s_and_b32 s30, s17, 3
    s_lshl_b32 s30, s30, 2
    s_add_u32 s25, s25, s30
    s_add_u32 s25, s25, 69844992
    v_or_b32 v85, s16, v0
    v_cmp_eq_u32 vcc, 0, v85
    s_nop 1
    v_cndmask_b32 v79, v86, v85, vcc
    s_mul_i32 s30, s16, 7168
    v_lshl_add_u32 v85, v0, 7, s30
    v_cmp_gt_u32 vcc, 56, v0
    s_nop 1
    v_cndmask_b32 v76, v86, v85, vcc
    s_add_u32 s26, s17, 16
    s_mul_i32 s26, s26, 28672
    s_add_u32 s26, s26, 19726336
    v_lshlrev_b32 v78, 4, v0
    v_add_u32 v78, s35, v78
    s_mov_b32 s21, 0
    s_mov_b32 s22, 65601536
    s_mov_b32 s23, 17891328
    s_lshr_b32 s24, s17, 1
    s_mul_i32 s24, s24, 1280
    s_add_u32 s24, s24, 66519040
    v_and_b32 v24, 1, v0
    v_lshlrev_b32 v24, 4, v24
    v_lshrrev_b32 v28, 1, v0
    v_lshl_add_u32 v28, v28, 7, v24
    v_add_u32 v28, 69828608, v28
    s_cmp_eq_u32 s16, 0
    s_cbranch_scc0 wad_9
wa_8:
    buffer_load_dwordx4 v[24:27], v28, s[4:7], 0 offen sc1
    s_waitcnt vmcnt(0)
    v_min3_u32 v24, v24, v25, v26
    v_min_u32 v24, v24, v27
    v_cmp_eq_u32 vcc, 0, v24
    s_cbranch_vccz wad_9
    s_sub_u32 s18, s18, 1
    s_cbranch_scc1 main_end2
    s_sleep 1
    s_branch wa_8
wad_9:
    s_waitcnt vmcnt(0)
    s_barrier
    s_lshl_b32 s35, s16, 13
.p2align 6
A_loop:
    v_mov_b32 v96, 0
    v_mov_b32 v97, 0
    v_mov_b32 v98, 0
    v_mov_b32 v99, 0
    v_mov_b32 v100, 0
    v_mov_b32 v101, 0
    v_mov_b32 v102, 0
    v_mov_b32 v103, 0
    v_mov_b32 v104, 0
    v_mov_b32 v105, 0
    v_mov_b32 v106, 0
    v_mov_b32 v107, 0
    v_mov_b32 v44, 0
    s_add_u32 m0, s35, 49152
    s_nop 0
    buffer_load_dwordx4 v72, s[4:7], s23 offen offset:0 lds
    s_add_u32 m0, s35, 49664
    s_nop 0
    buffer_load_dwordx4 v72, s[4:7], s23 offen offset:512 lds
    s_add_u32 m0, s35, 50944
    s_nop 0
    buffer_load_dwordx4 v72, s[4:7], s23 offen offset:256 lds
    s_add_u32 m0, s35, 51456
    s_nop 0
    buffer_load_dwordx4 v72, s[4:7], s23 offen offset:768 lds
    s_add_u32 m0, s35, 53248
    s_nop 0
    buffer_load_dwordx4 v73, s[4:7], s23 offen offset:0 lds
    s_add_u32 m0, s35, 53760
    s_nop 0
    buffer_load_dwordx4 v73, s[4:7], s23 offen offset:512 lds
    s_add_u32 m0, s35, 55040
    s_nop 0
    buffer_load_dwordx4 v73, s[4:7], s23 offen offset:256 lds
    s_add_u32 m0, s35, 55552
    s_nop 0
    buffer_load_dwordx4 v73, s[4:7], s23 offen offset:768 lds
    ds_read_b128 v[120:123], v78 offset:0
    ds_read_b128 v[124:127], v78 offset:1024
    ds_read_b128 v[128:131], v78 offset:2048
    ds_read_b128 v[132:135], v78 offset:3072
    ds_read_b128 v[136:139], v78 offset:4096
    ds_read_b128 v[140:143], v78 offset:5120
    ds_read_b128 v[144:147], v78 offset:6144
    ds_read_b128 v[148:151], v78 offset:7168
    s_waitcnt vmcnt(0) lgkmcnt(0)
    buffer_load_dwordx4 v[8:11], v1, s[4:7], s22 offen offset:0 sc1
    buffer_load_dwordx4 v[16:19], v2, s[4:7], s22 offen offset:0 sc1
    v_mov_b32 v45, 0
    v_mov_b32 v46, 0
    v_mov_b32 v47, 0
    v_mov_b32 v48, 0
    v_mov_b32 v49, 0
    v_mov_b32 v50, 0
    v_mov_b32 v51, 0
    v_mov_b32 v52, 0
    v_mov_b32 v53, 0
    v_mov_b32 v54, 0
    v_mov_b32 v55, 0
    v_mov_b32 v56, 0
    v_mov_b32 v57, 0
    v_mov_b32 v58, 0
    v_mov_b32 v59, 0
    v_mov_b32 v60, 0
    v_mov_b32 v61, 0
    v_mov_b32 v62, 0
    v_mov_b32 v63, 0
    v_mov_b32 v64, 0
    v_mov_b32 v65, 0
    v_mov_b32 v66, 0
    v_mov_b32 v67, 0
    v_mov_b32 v68, 0
    v_mov_b32 v69, 0
    v_mov_b32 v70, 0
    v_mov_b32 v71, 0
A_poll:
    buffer_load_dwordx4 v[8:11], v1, s[4:7], s22 offen offset:0 sc1
    buffer_load_dwordx4 v[16:19], v2, s[4:7], s22 offen offset:0 sc1
    s_sub_u32 s18, s18, 1
    s_cbranch_scc1 main_end2
    s_waitcnt vmcnt(3)
    v_max3_u32 v83, v8, v9, v10
    v_max_u32 v83, v83, v11
    ds_write_b128 v1, v[8:11] offset:32768
    s_waitcnt vmcnt(2)
    v_max3_u32 v83, v83, v16, v17
    v_max3_u32 v83, v83, v18, v19
    v_cmp_eq_u32 vcc, -1, v83
    ds_write_b128 v2, v[16:19] offset:32768
    s_cbranch_vccnz A_poll
    v_smfmac_f32_16x16x64_bf16 v[44:47], v[8:11], v[120:127], v114
    s_mov_b32 m0, 81920
    s_nop 0
    buffer_load_dword v76, s[4:7], s26 offen sc1 lds
    s_add_u32 s26, s26, 458752
    v_smfmac_f32_16x16x64_bf16 v[48:51], v[8:11], v[128:135], v114
    v_smfmac_f32_16x16x64_bf16 v[52:55], v[8:11], v[136:143], v114
    v_smfmac_f32_16x16x64_bf16 v[56:59], v[8:11], v[144:151], v114
    v_smfmac_f32_16x16x64_bf16 v[60:63], v[8:11], a[0:7], v114
    v_smfmac_f32_16x16x64_bf16 v[64:67], v[8:11], a[8:15], v114
    v_smfmac_f32_16x16x64_bf16 v[68:71], v[8:11], a[16:23], v114
    s_waitcnt lgkmcnt(0)
    s_barrier
    v_smfmac_f32_16x16x64_bf16 v[44:47], v[16:19], a[24:31], v114
    ds_read_b128 v[24:27], v3 offset:32768
    v_smfmac_f32_16x16x64_bf16 v[48:51], v[16:19], a[32:39], v114
    ds_read_b128 v[28:31], v4 offset:32768
    v_smfmac_f32_16x16x64_bf16 v[52:55], v[16:19], a[40:47], v114
    ds_read_b128 v[32:35], v5 offset:32768
    v_smfmac_f32_16x16x64_bf16 v[56:59], v[16:19], a[48:55], v114
    ds_read_b128 v[36:39], v6 offset:32768
    v_smfmac_f32_16x16x64_bf16 v[60:63], v[16:19], a[56:63], v114
    ds_read_b128 v[40:43], v7 offset:32768
    v_smfmac_f32_16x16x64_bf16 v[64:67], v[16:19], a[64:71], v114
    v_smfmac_f32_16x16x64_bf16 v[68:71], v[16:19], a[72:79], v114
    s_waitcnt lgkmcnt(4)
    v_smfmac_f32_16x16x64_bf16 v[44:47], v[24:27], a[80:87], v114
    v_smfmac_f32_16x16x64_bf16 v[48:51], v[24:27], a[88:95], v114
    v_smfmac_f32_16x16x64_bf16 v[52:55], v[24:27], a[96:103], v114
    v_smfmac_f32_16x16x64_bf16 v[56:59], v[24:27], a[104:111], v114
    s_waitcnt lgkmcnt(0)
    v_smfmac_f32_16x16x64_bf16 v[44:47], v[28:31], a[136:143], v114
    ds_read_b128 v[120:123], v78 offset:49152
    v_smfmac_f32_16x16x64_bf16 v[48:51], v[28:31], a[144:151], v114
    ds_read_b128 v[124:127], v78 offset:50176
    v_smfmac_f32_16x16x64_bf16 v[52:55], v[28:31], a[152:159], v114
    ds_read_b128 v[128:131], v78 offset:51200
    v_smfmac_f32_16x16x64_bf16 v[56:59], v[28:31], a[160:167], v114
    ds_read_b128 v[132:135], v78 offset:52224
    v_smfmac_f32_16x16x64_bf16 v[44:47], v[32:35], a[192:199], v114
    ds_read_b128 v[136:139], v78 offset:53248
    v_smfmac_f32_16x16x64_bf16 v[48:51], v[32:35], a[200:207], v114
    ds_read_b128 v[140:143], v78 offset:54272
    v_smfmac_f32_16x16x64_bf16 v[52:55], v[32:35], a[208:215], v114
    ds_read_b128 v[144:147], v78 offset:55296
    v_smfmac_f32_16x16x64_bf16 v[56:59], v[32:35], a[216:223], v114
    ds_read_b128 v[148:151], v78 offset:56320
    v_smfmac_f32_16x16x64_bf16 v[44:47], v[36:39], a[248:255], v114
    v_mov_b32_dpp v12, v8 row_ror:8 row_mask:0xf bank_mask:0xf
    v_smfmac_f32_16x16x64_bf16 v[48:51], v[36:39], v[152:159], v114
    v_mov_b32_dpp v13, v9 row_ror:8 row_mask:0xf bank_mask:0xf
    v_smfmac_f32_16x16x64_bf16 v[52:55], v[36:39], v[160:167], v114
    v_mov_b32_dpp v14, v10 row_ror:8 row_mask:0xf bank_mask:0xf
    v_smfmac_f32_16x16x64_bf16 v[56:59], v[36:39], v[168:175], v114
    v_mov_b32_dpp v15, v11 row_ror:8 row_mask:0xf bank_mask:0xf
    v_smfmac_f32_16x16x64_bf16 v[44:47], v[40:43], v[200:207], v114
    v_mov_b32_dpp v20, v16 row_ror:8 row_mask:0xf bank_mask:0xf
    v_smfmac_f32_16x16x64_bf16 v[48:51], v[40:43], v[208:215], v114
    v_mov_b32_dpp v21, v17 row_ror:8 row_mask:0xf bank_mask:0xf
    v_smfmac_f32_16x16x64_bf16 v[52:55], v[40:43], v[216:223], v114
    v_mov_b32_dpp v22, v18 row_ror:8 row_mask:0xf bank_mask:0xf
    v_smfmac_f32_16x16x64_bf16 v[56:59], v[40:43], v[224:231], v114
    v_mov_b32_dpp v23, v19 row_ror:8 row_mask:0xf bank_mask:0xf
    v_smfmac_f32_16x16x64_bf16 v[60:63], v[24:27], a[112:119], v114
    v_smfmac_f32_16x16x64_bf16 v[64:67], v[24:27], a[120:127], v114
    v_smfmac_f32_16x16x64_bf16 v[60:63], v[28:31], a[168:175], v114
    v_smfmac_f32_16x16x64_bf16 v[64:67], v[28:31], a[176:183], v114
    v_smfmac_f32_16x16x64_bf16 v[60:63], v[32:35], a[224:231], v114
    v_cvt_pk_bf16_f32 v80, v44, v45
    v_cvt_pk_bf16_f32 v81, v46, v47
    v_smfmac_f32_16x16x64_bf16 v[64:67], v[32:35], a[232:239], v114
    v_cvt_pk_bf16_f32 v82, v48, v49
    v_cvt_pk_bf16_f32 v83, v50, v51
    v_smfmac_f32_16x16x64_bf16 v[60:63], v[36:39], v[176:183], v114
    v_cvt_pk_bf16_f32 v84, v52, v53
    v_cvt_pk_bf16_f32 v85, v54, v55
    v_smfmac_f32_16x16x64_bf16 v[64:67], v[36:39], v[184:191], v114
    v_cvt_pk_bf16_f32 v86, v56, v57
    v_cvt_pk_bf16_f32 v87, v58, v59
    v_mfma_f32_16x16x32_bf16 v[44:47], v[80:83], v[108:111], 0
    v_smfmac_f32_16x16x64_bf16 v[60:63], v[40:43], v[232:239], v114
    v_smfmac_f32_16x16x64_bf16 v[64:67], v[40:43], v[240:247], v114
    v_mfma_f32_16x16x32_bf16 v[48:51], v[84:87], v[108:111], 0
    v_smfmac_f32_16x16x64_bf16 v[68:71], v[24:27], a[128:135], v114
    v_smfmac_f32_16x16x64_bf16 v[68:71], v[28:31], a[184:191], v114
    v_smfmac_f32_16x16x64_bf16 v[68:71], v[32:35], a[240:247], v114
    v_smfmac_f32_16x16x64_bf16 v[68:71], v[36:39], v[192:199], v114
    v_smfmac_f32_16x16x64_bf16 v[68:71], v[40:43], v[248:255], v114
    v_cvt_pk_bf16_f32 v88, v44, v45
    v_cvt_pk_bf16_f32 v89, v46, v47
    v_cvt_pk_bf16_f32 v116, v60, v61
    v_cvt_pk_bf16_f32 v117, v62, v63
    v_cvt_pk_bf16_f32 v118, v64, v65
    v_cvt_pk_bf16_f32 v119, v66, v67
    v_cvt_pk_bf16_f32 v90, v48, v49
    v_cvt_pk_bf16_f32 v91, v50, v51
    v_mfma_f32_16x16x32_bf16 v[52:55], v[116:119], v[108:111], 0
    v_cvt_pk_bf16_f32 v80, v68, v69
    v_cvt_pk_bf16_f32 v81, v70, v71
    s_waitcnt lgkmcnt(0)
    v_smfmac_f32_16x16x64_bf16 v[104:107], v[88:91], v[8:15], v115
    v_mfma_f32_16x16x16_bf16 v[56:59], v[80:81], v[112:113], 0
    v_smfmac_f32_16x16x64_bf16 v[96:99], v[88:91], v[120:127], v115
    v_smfmac_f32_16x16x64_bf16 v[100:103], v[88:91], v[128:135], v115
    s_nop 0
    v_cvt_pk_bf16_f32 v92, v52, v53
    v_cvt_pk_bf16_f32 v93, v54, v55
    s_nop 2
    v_cvt_pk_bf16_f32 v94, v56, v57
    v_cvt_pk_bf16_f32 v95, v58, v59
    s_nop 1
    v_smfmac_f32_16x16x64_bf16 v[104:107], v[92:95], v[16:23], v115
    v_smfmac_f32_16x16x64_bf16 v[96:99], v[92:95], v[136:143], v115
    v_smfmac_f32_16x16x64_bf16 v[100:103], v[92:95], v[144:151], v115
    s_nop 5
    v_pk_add_f32 v[104:105], v[104:105], v[106:107]
    ds_write2_b32 v74, v104, v105 offset0:32 offset1:84
    v_pk_add_f32 v[96:97], v[96:97], v[98:99]
    ds_write2_b32 v74, v96, v97 offset0:0 offset1:52
    v_pk_add_f32 v[100:101], v[100:101], v[102:103]
    ds_write2_b32 v74, v100, v101 offset0:16 offset1:68
    s_cmp_eq_u32 s19, 0
    s_waitcnt lgkmcnt(0)
    s_barrier
    ds_read_b64 v[24:25], v75 offset:0
    ds_read_b64 v[26:27], v75 offset:1664
    ds_read_b64 v[28:29], v75 offset:3328
    ds_read_b64 v[30:31], v75 offset:4992
    buffer_store_dword v114, v79, s[4:7], s25 offen
    s_waitcnt lgkmcnt(2)
    v_pk_add_f32 v[24:25], v[24:25], v[26:27]
    s_waitcnt lgkmcnt(0)
    v_pk_add_f32 v[28:29], v[28:29], v[30:31]
    v_pk_add_f32 v[24:25], v[24:25], v[28:29]
    v_max_f32 v26, v24, v25
    s_nop 1
    v_max_f32_dpp v26, v26, v26 row_ror:8 row_mask:0xf bank_mask:0xf
    s_nop 1
    v_max_f32_dpp v26, v26, v26 row_ror:4 row_mask:0xf bank_mask:0xf
    s_nop 1
    v_max_f32_dpp v26, v26, v26 row_ror:2 row_mask:0xf bank_mask:0xf
    s_nop 1
    v_max_f32_dpp v26, v26, v26 row_ror:1 row_mask:0xf bank_mask:0xf
    v_mov_b32 v27, v26
    s_nop 1
    v_permlane16_swap_b32 v26, v27
    v_max_f32 v26, v26, v27
    v_sub_f32 v24, v24, v26
    v_sub_f32 v25, v25, v26
    v_exp_f32 v24, v24
    v_exp_f32 v25, v25
    s_nop 0
    v_add_f32 v26, v24, v25
    s_nop 1
    v_add_f32_dpp v26, v26, v26 row_ror:8 row_mask:0xf bank_mask:0xf
    s_nop 1
    v_add_f32_dpp v26, v26, v26 row_ror:4 row_mask:0xf bank_mask:0xf
    s_nop 1
    v_add_f32_dpp v26, v26, v26 row_ror:2 row_mask:0xf bank_mask:0xf
    s_nop 1
    v_add_f32_dpp v26, v26, v26 row_ror:1 row_mask:0xf bank_mask:0xf
    v_mov_b32 v27, v26
    s_nop 1
    v_permlane16_swap_b32 v26, v27
    v_add_f32 v26, v26, v27
    v_rcp_f32 v26, v26
    s_nop 0
    v_mul_f32 v24, v24, v26
    v_mul_f32 v25, v25, v26
    v_cvt_pk_bf16_f32 v24, v24, v25
    v_min_u32 v24, -2, v24
    s_cbranch_scc1 A_far
    buffer_store_dword v24, v77, s[4:7], s24 offen
A_back:
    s_add_u32 s21, s21, 1
    s_add_u32 s22, s22, 14336
    s_add_u32 s23, s23, 28672
    s_add_u32 s24, s24, 10240
    s_add_u32 s25, s25, 512
    s_add_u32 s36, s36, 512
    s_mov_b32 s27, s19
    s_cmp_lt_u32 s21, 63
    s_cbranch_scc1 A_loop
    s_endpgm
A_far:
    buffer_store_dword v24, v77, s[4:7], s24 offen sc1
    s_branch A_back
role_B:
    s_sub_u32 s20, s17, 16
    v_lshrrev_b32 v131, 4, v0
    v_and_b32 v132, 15, v0
    s_lshl_b32 s30, s16, 1
    s_add_u32 s30, s30, 0
    s_sub_u32 s31, s30, 7
    s_cselect_b32 s40, s30, s31
    s_lshl_b32 s30, s16, 1
    s_add_u32 s30, s30, 1
    s_sub_u32 s31, s30, 7
    s_cselect_b32 s41, s30, s31
    s_lshl_b32 s30, s16, 1
    s_add_u32 s30, s30, 2
    s_sub_u32 s31, s30, 7
    s_cselect_b32 s42, s30, s31
    s_lshl_b32 s30, s16, 1
    s_add_u32 s30, s30, 3
    s_sub_u32 s31, s30, 7
    s_cselect_b32 s43, s30, s31
    s_lshl_b32 s30, s16, 1
    s_add_u32 s30, s30, 4
    s_sub_u32 s31, s30, 7
    s_cselect_b32 s44, s30, s31
    s_lshl_b32 s30, s16, 1
    s_add_u32 s30, s30, 5
    s_sub_u32 s31, s30, 7
    s_cselect_b32 s45, s30, s31
    s_lshl_b32 s30, s16, 1
    s_add_u32 s30, s30, 6
    s_sub_u32 s31, s30, 7
    s_cselect_b32 s46, s30, s31
    v_lshrrev_b32 v133, 1, v131
    v_and_b32 v134, 1, v131
    v_lshlrev_b32 v135, 4, v132
    v_lshl_add_u32 v136, v133, 10, v135
    v_lshl_add_u32 v136, v134, 8, v136
    s_lshl_b32 s30, s16, 2
    s_add_u32 s30, s30, 16
    s_mul_i32 s30, s30, 401408
    s_mul_i32 s31, s20, 28672
    s_add_u32 s30, s30, s31
    s_add_u32 s64, s30, 0
    s_add_u32 s65, s30, 14336
    s_add_u32 s66, s30, 401408
    s_add_u32 s67, s30, 415744
    s_add_u32 s68, s30, 802816
    s_add_u32 s69, s30, 817152
    s_add_u32 s70, s30, 1204224
    s_add_u32 s71, s30, 1218560
    s_mul_i32 s35, s16, 28672
    s_lshl_b32 s30, s16, 2
    s_add_u32 s30, s30, 16
    v_and_b32 v8, 1, v0
    v_lshlrev_b32 v8, 4, v8
    v_lshrrev_b32 v12, 1, v0
    v_lshl_add_u32 v12, v12, 7, v8
    v_add_u32 v12, 69828608, v12
    s_cmp_eq_u32 s16, 0
    s_cbranch_scc0 wad_11
wa_10:
    buffer_load_dwordx4 v[8:11], v12, s[4:7], 0 offen sc1
    s_waitcnt vmcnt(0)
    v_min3_u32 v8, v8, v9, v10
    v_min_u32 v8, v8, v11
    v_cmp_eq_u32 vcc, 0, v8
    s_cbranch_vccz wad_11
    s_sub_u32 s18, s18, 1
    s_cbranch_scc1 main_end2
    s_sleep 2
    s_branch wa_10
wad_11:
    s_waitcnt vmcnt(0)
    s_barrier
    s_lshl_b32 s31, s40, 11
    s_add_u32 s33, s31, s64
    buffer_load_dwordx4 a[0:3], v136, s[4:7], s33 offen offset:0
    buffer_load_dwordx4 a[4:7], v136, s[4:7], s33 offen offset:512
    s_add_u32 s33, s31, s65
    buffer_load_dwordx4 a[8:11], v136, s[4:7], s33 offen offset:0
    buffer_load_dwordx4 a[12:15], v136, s[4:7], s33 offen offset:512
    s_add_u32 s33, s31, s66
    buffer_load_dwordx4 a[16:19], v136, s[4:7], s33 offen offset:0
    buffer_load_dwordx4 a[20:23], v136, s[4:7], s33 offen offset:512
    s_add_u32 s33, s31, s67
    buffer_load_dwordx4 a[24:27], v136, s[4:7], s33 offen offset:0
    buffer_load_dwordx4 a[28:31], v136, s[4:7], s33 offen offset:512
    s_add_u32 s33, s31, s68
    buffer_load_dwordx4 a[32:35], v136, s[4:7], s33 offen offset:0
    buffer_load_dwordx4 a[36:39], v136, s[4:7], s33 offen offset:512
    s_add_u32 s33, s31, s69
    buffer_load_dwordx4 a[40:43], v136, s[4:7], s33 offen offset:0
    buffer_load_dwordx4 a[44:47], v136, s[4:7], s33 offen offset:512
    s_add_u32 s33, s31, s70
    s_add_u32 m0, s35, 0
    s_nop 0
    buffer_load_dwordx4 v136, s[4:7], s33 offen offset:0 lds
    s_add_u32 m0, s35, 512
    s_nop 0
    buffer_load_dwordx4 v136, s[4:7], s33 offen offset:512 lds
    s_add_u32 s33, s31, s71
    s_add_u32 m0, s35, 2048
    s_nop 0
    buffer_load_dwordx4 v136, s[4:7], s33 offen offset:0 lds
    s_add_u32 m0, s35, 2560
    s_nop 0
    buffer_load_dwordx4 v136, s[4:7], s33 offen offset:512 lds
    s_lshl_b32 s31, s41, 11
    s_add_u32 s33, s31, s64
    buffer_load_dwordx4 a[48:51], v136, s[4:7], s33 offen offset:0
    buffer_load_dwordx4 a[52:55], v136, s[4:7], s33 offen offset:512
    s_add_u32 s33, s31, s65
    buffer_load_dwordx4 a[56:59], v136, s[4:7], s33 offen offset:0
    buffer_load_dwordx4 a[60:63], v136, s[4:7], s33 offen offset:512
    s_add_u32 s33, s31, s66
    buffer_load_dwordx4 a[64:67], v136, s[4:7], s33 offen offset:0
    buffer_load_dwordx4 a[68:71], v136, s[4:7], s33 offen offset:512
    s_add_u32 s33, s31, s67
    buffer_load_dwordx4 a[72:75], v136, s[4:7], s33 offen offset:0
    buffer_load_dwordx4 a[76:79], v136, s[4:7], s33 offen offset:512
    s_add_u32 s33, s31, s68
    buffer_load_dwordx4 a[80:83], v136, s[4:7], s33 offen offset:0
    buffer_load_dwordx4 a[84:87], v136, s[4:7], s33 offen offset:512
    s_add_u32 s33, s31, s69
    buffer_load_dwordx4 a[88:91], v136, s[4:7], s33 offen offset:0
    buffer_load_dwordx4 a[92:95], v136, s[4:7], s33 offen offset:512
    s_add_u32 s33, s31, s70
    s_add_u32 m0, s35, 4096
    s_nop 0
    buffer_load_dwordx4 v136, s[4:7], s33 offen offset:0 lds
    s_add_u32 m0, s35, 4608
    s_nop 0
    buffer_load_dwordx4 v136, s[4:7], s33 offen offset:512 lds
    s_add_u32 s33, s31, s71
    s_add_u32 m0, s35, 6144
    s_nop 0
    buffer_load_dwordx4 v136, s[4:7], s33 offen offset:0 lds
    s_add_u32 m0, s35, 6656
    s_nop 0
    buffer_load_dwordx4 v136, s[4:7], s33 offen offset:512 lds
    s_lshl_b32 s31, s42, 11
    s_add_u32 s33, s31, s64
    buffer_load_dwordx4 a[96:99], v136, s[4:7], s33 offen offset:0
    buffer_load_dwordx4 a[100:103], v136, s[4:7], s33 offen offset:512
    s_add_u32 s33, s31, s65
    buffer_load_dwordx4 a[104:107], v136, s[4:7], s33 offen offset:0
    buffer_load_dwordx4 a[108:111], v136, s[4:7], s33 offen offset:512
    s_add_u32 s33, s31, s66
    buffer_load_dwordx4 a[112:115], v136, s[4:7], s33 offen offset:0
    buffer_load_dwordx4 a[116:119], v136, s[4:7], s33 offen offset:512
    s_add_u32 s33, s31, s67
    buffer_load_dwordx4 a[120:123], v136, s[4:7], s33 offen offset:0
    buffer_load_dwordx4 a[124:127], v136, s[4:7], s33 offen offset:512
    s_add_u32 s33, s31, s68
    buffer_load_dwordx4 a[128:131], v136, s[4:7], s33 offen offset:0
    buffer_load_dwordx4 a[132:135], v136, s[4:7], s33 offen offset:512
    s_add_u32 s33, s31, s69
    buffer_load_dwordx4 a[136:139], v136, s[4:7], s33 offen offset:0
    buffer_load_dwordx4 a[140:143], v136, s[4:7], s33 offen offset:512
    s_add_u32 s33, s31, s70
    s_add_u32 m0, s35, 8192
    s_nop 0
    buffer_load_dwordx4 v136, s[4:7], s33 offen offset:0 lds
    s_add_u32 m0, s35, 8704
    s_nop 0
    buffer_load_dwordx4 v136, s[4:7], s33 offen offset:512 lds
    s_add_u32 s33, s31, s71
    s_add_u32 m0, s35, 10240
    s_nop 0
    buffer_load_dwordx4 v136, s[4:7], s33 offen offset:0 lds
    s_add_u32 m0, s35, 10752
    s_nop 0
    buffer_load_dwordx4 v136, s[4:7], s33 offen offset:512 lds
    s_lshl_b32 s31, s43, 11
    s_add_u32 s33, s31, s64
    buffer_load_dwordx4 a[144:147], v136, s[4:7], s33 offen offset:0
    buffer_load_dwordx4 a[148:151], v136, s[4:7], s33 offen offset:512
    s_add_u32 s33, s31, s65
    buffer_load_dwordx4 a[152:155], v136, s[4:7], s33 offen offset:0
    buffer_load_dwordx4 a[156:159], v136, s[4:7], s33 offen offset:512
    s_add_u32 s33, s31, s66
    buffer_load_dwordx4 a[160:163], v136, s[4:7], s33 offen offset:0
    buffer_load_dwordx4 a[164:167], v136, s[4:7], s33 offen offset:512
    s_add_u32 s33, s31, s67
    buffer_load_dwordx4 a[168:171], v136, s[4:7], s33 offen offset:0
    buffer_load_dwordx4 a[172:175], v136, s[4:7], s33 offen offset:512
    s_add_u32 s33, s31, s68
    buffer_load_dwordx4 a[176:179], v136, s[4:7], s33 offen offset:0
    buffer_load_dwordx4 a[180:183], v136, s[4:7], s33 offen offset:512
    s_add_u32 s33, s31, s69
    buffer_load_dwordx4 a[184:187], v136, s[4:7], s33 offen offset:0
    buffer_load_dwordx4 a[188:191], v136, s[4:7], s33 offen offset:512
    s_add_u32 s33, s31, s70
    s_add_u32 m0, s35, 12288
    s_nop 0
    buffer_load_dwordx4 v136, s[4:7], s33 offen offset:0 lds
    s_add_u32 m0, s35, 12800
    s_nop 0
    buffer_load_dwordx4 v136, s[4:7], s33 offen offset:512 lds
    s_add_u32 s33, s31, s71
    s_add_u32 m0, s35, 14336
    s_nop 0
    buffer_load_dwordx4 v136, s[4:7], s33 offen offset:0 lds
    s_add_u32 m0, s35, 14848
    s_nop 0
    buffer_load_dwordx4 v136, s[4:7], s33 offen offset:512 lds
    s_lshl_b32 s31, s44, 11
    s_add_u32 s33, s31, s64
    buffer_load_dwordx4 a[192:195], v136, s[4:7], s33 offen offset:0
    buffer_load_dwordx4 a[196:199], v136, s[4:7], s33 offen offset:512
    s_add_u32 s33, s31, s65
    buffer_load_dwordx4 a[200:203], v136, s[4:7], s33 offen offset:0
    buffer_load_dwordx4 a[204:207], v136, s[4:7], s33 offen offset:512
    s_add_u32 s33, s31, s66
    buffer_load_dwordx4 a[208:211], v136, s[4:7], s33 offen offset:0
    buffer_load_dwordx4 a[212:215], v136, s[4:7], s33 offen offset:512
    s_add_u32 s33, s31, s67
    buffer_load_dwordx4 a[216:219], v136, s[4:7], s33 offen offset:0
    buffer_load_dwordx4 a[220:223], v136, s[4:7], s33 offen offset:512
    s_add_u32 s33, s31, s68
    buffer_load_dwordx4 a[224:227], v136, s[4:7], s33 offen offset:0
    buffer_load_dwordx4 a[228:231], v136, s[4:7], s33 offen offset:512
    s_add_u32 s33, s31, s69
    buffer_load_dwordx4 a[232:235], v136, s[4:7], s33 offen offset:0
    buffer_load_dwordx4 a[236:239], v136, s[4:7], s33 offen offset:512
    s_add_u32 s33, s31, s70
    s_add_u32 m0, s35, 16384
    s_nop 0
    buffer_load_dwordx4 v136, s[4:7], s33 offen offset:0 lds
    s_add_u32 m0, s35, 16896
    s_nop 0
    buffer_load_dwordx4 v136, s[4:7], s33 offen offset:512 lds
    s_add_u32 s33, s31, s71
    s_add_u32 m0, s35, 18432
    s_nop 0
    buffer_load_dwordx4 v136, s[4:7], s33 offen offset:0 lds
    s_add_u32 m0, s35, 18944
    s_nop 0
    buffer_load_dwordx4 v136, s[4:7], s33 offen offset:512 lds
    s_lshl_b32 s31, s45, 11
    s_add_u32 s33, s31, s64
    buffer_load_dwordx4 a[240:243], v136, s[4:7], s33 offen offset:0
    buffer_load_dwordx4 a[244:247], v136, s[4:7], s33 offen offset:512
    s_add_u32 s33, s31, s65
    buffer_load_dwordx4 a[248:251], v136, s[4:7], s33 offen offset:0
    buffer_load_dwordx4 a[252:255], v136, s[4:7], s33 offen offset:512
    s_add_u32 s33, s31, s66
    buffer_load_dwordx4 v[160:163], v136, s[4:7], s33 offen offset:0
    buffer_load_dwordx4 v[164:167], v136, s[4:7], s33 offen offset:512
    s_add_u32 s33, s31, s67
    buffer_load_dwordx4 v[168:171], v136, s[4:7], s33 offen offset:0
    buffer_load_dwordx4 v[172:175], v136, s[4:7], s33 offen offset:512
    s_add_u32 s33, s31, s68
    buffer_load_dwordx4 v[176:179], v136, s[4:7], s33 offen offset:0
    buffer_load_dwordx4 v[180:183], v136, s[4:7], s33 offen offset:512
    s_add_u32 s33, s31, s69
    buffer_load_dwordx4 v[184:187], v136, s[4:7], s33 offen offset:0
    buffer_load_dwordx4 v[188:191], v136, s[4:7], s33 offen offset:512
    s_add_u32 s33, s31, s70
    s_add_u32 m0, s35, 20480
    s_nop 0
    buffer_load_dwordx4 v136, s[4:7], s33 offen offset:0 lds
    s_add_u32 m0, s35, 20992
    s_nop 0
    buffer_load_dwordx4 v136, s[4:7], s33 offen offset:512 lds
    s_add_u32 s33, s31, s71
    s_add_u32 m0, s35, 22528
    s_nop 0
    buffer_load_dwordx4 v136, s[4:7], s33 offen offset:0 lds
    s_add_u32 m0, s35, 23040
    s_nop 0
    buffer_load_dwordx4 v136, s[4:7], s33 offen offset:512 lds
    s_lshl_b32 s31, s46, 11
    s_add_u32 s33, s31, s64
    buffer_load_dwordx4 v[192:195], v136, s[4:7], s33 offen offset:0
    buffer_load_dwordx4 v[196:199], v136, s[4:7], s33 offen offset:512
    s_add_u32 s33, s31, s65
    buffer_load_dwordx4 v[200:203], v136, s[4:7], s33 offen offset:0
    buffer_load_dwordx4 v[204:207], v136, s[4:7], s33 offen offset:512
    s_add_u32 s33, s31, s66
    buffer_load_dwordx4 v[208:211], v136, s[4:7], s33 offen offset:0
    buffer_load_dwordx4 v[212:215], v136, s[4:7], s33 offen offset:512
    s_add_u32 s33, s31, s67
    buffer_load_dwordx4 v[216:219], v136, s[4:7], s33 offen offset:0
    buffer_load_dwordx4 v[220:223], v136, s[4:7], s33 offen offset:512
    s_add_u32 s33, s31, s68
    buffer_load_dwordx4 v[224:227], v136, s[4:7], s33 offen offset:0
    buffer_load_dwordx4 v[228:231], v136, s[4:7], s33 offen offset:512
    s_add_u32 s33, s31, s69
    buffer_load_dwordx4 v[232:235], v136, s[4:7], s33 offen offset:0
    buffer_load_dwordx4 v[236:239], v136, s[4:7], s33 offen offset:512
    s_add_u32 s33, s31, s70
    s_add_u32 m0, s35, 24576
    s_nop 0
    buffer_load_dwordx4 v136, s[4:7], s33 offen offset:0 lds
    s_add_u32 m0, s35, 25088
    s_nop 0
    buffer_load_dwordx4 v136, s[4:7], s33 offen offset:512 lds
    s_add_u32 s33, s31, s71
    s_add_u32 m0, s35, 26624
    s_nop 0
    buffer_load_dwordx4 v136, s[4:7], s33 offen offset:0 lds
    s_add_u32 m0, s35, 27136
    s_nop 0
    buffer_load_dwordx4 v136, s[4:7], s33 offen offset:512 lds
    v_lshl_add_u32 v135, v133, 8, v135
    v_lshl_add_u32 v135, v134, 9, v135
    s_lshl_b32 s31, s40, 10
    v_add_u32 v1, s31, v135
    v_add_u32 v138, 114688, v1
    s_lshl_b32 s31, s41, 10
    v_add_u32 v2, s31, v135
    v_add_u32 v139, 114688, v2
    s_lshl_b32 s31, s42, 10
    s_add_u32 s31, s31, 114688
    v_add_u32 v3, s31, v135
    s_lshl_b32 s31, s43, 10
    s_add_u32 s31, s31, 114688
    v_add_u32 v4, s31, v135
    s_lshl_b32 s31, s44, 10
    s_add_u32 s31, s31, 114688
    v_add_u32 v5, s31, v135
    s_lshl_b32 s31, s45, 10
    s_add_u32 s31, s31, 114688
    v_add_u32 v6, s31, v135
    s_lshl_b32 s31, s46, 10
    s_add_u32 s31, s31, 114688
    v_add_u32 v7, s31, v135
    v_and_b32 v135, 7, v132
    v_lshrrev_b32 v136, 3, v132
    s_mul_i32 s30, s16, 2560
    v_lshl_add_u32 v122, v132, 4, s30
    v_mul_u32_u24 v123, 1280, v133
    v_add_u32 v123, v123, v122
    v_lshl_add_u32 v122, v131, 8, v122
    v_lshlrev_b32 v121, 4, v0
    v_add_u32 v129, s35, v121
    s_lshl_b32 s30, s16, 10
    s_mul_i32 s30, s30, 1
    s_add_u32 s30, s30, 121856
    v_lshlrev_b32 v124, 2, v132
    v_lshl_add_u32 v124, v131, 8, v124
    v_lshl_add_u32 v124, v134, 6, v124
    v_xor_b32 v126, 64, v124
    v_add_u32 v124, s30, v124
    v_add_u32 v126, s30, v126
    s_lshl_b32 s30, s16, 1
    v_add_u32 v134, s30, v134
    s_and_b32 s30, s16, 1
    s_lshl_b32 s30, s30, 6
    v_lshlrev_b32 v125, 3, v132
    v_xor_b32 v125, s30, v125
    v_lshl_add_u32 v125, v134, 7, v125
    v_add_u32 v125, 121856, v125
    s_lshl_b32 s30, s20, 9
    v_lshl_add_u32 v134, v134, 4, s30
    v_lshl_add_u32 v127, v136, 8, v134
    v_and_b32 v133, 1, v132
    v_lshl_add_u32 v127, v133, 7, v127
    v_lshrrev_b32 v133, 1, v135
    v_lshl_add_u32 v127, v133, 2, v127
    v_lshrrev_b32 v133, 2, v132
    v_lshl_add_u32 v128, v133, 7, v134
    v_and_b32 v133, 3, v132
    v_lshl_add_u32 v128, v133, 2, v128
    v_add_u32 v128, 7168, v128
    v_bfrev_b32 v133, 1
    v_cmp_gt_u32 vcc, 32, v0
    s_nop 1
    v_cndmask_b32 v127, v133, v127, vcc
    v_cndmask_b32 v128, v133, v128, vcc
    v_lshlrev_b32 v130, 6, v0
    v_mov_b32 v120, 0x4444
    v_mov_b32 v118, 0xeeee
    v_cmp_gt_u32 vcc, 8, v132
    s_nop 1
    v_cndmask_b32 v120, v118, v120, vcc
    v_and_b32 v133, 1, v132
    v_lshrrev_b32 v134, 2, v132
    v_lshl_add_u32 v133, v134, 1, v133
    v_bfe_u32 v134, v132, 1, 1
    v_lshl_add_u32 v133, v134, 3, v133
    v_mov_b32 v140, 0x4444
    v_mov_b32 v118, 0xeeee
    v_cmp_gt_u32 vcc, 8, v133
    s_nop 1
    v_cndmask_b32 v140, v118, v140, vcc
    s_lshl_b32 s25, s16, 7
    s_add_u32 s25, s25, 69844992
    v_mov_b32 v141, 0
    s_lshl_b32 s30, s20, 2
    s_add_u32 s30, s30, 64
    v_mov_b32 v134, s30
    v_bfrev_b32 v135, 1
    v_cmp_eq_u32 vcc, 0, v0
    s_nop 1
    v_cndmask_b32 v131, v135, v134, vcc
    s_mov_b32 s21, 0
    s_mov_b32 s22, 65601536
    s_mov_b32 s24, 66519040
    s_lshl_b32 s30, s16, 2
    s_mul_i32 s30, s30, 28672
    s_lshl_b32 s31, s20, 11
    s_add_u32 s30, s30, s31
    s_add_u32 s23, s30, 19726336
    s_lshl_b32 s30, s16, 4
    s_add_u32 s27, s30, 69812224
    s_mov_b64 s[62:63], 0
    s_waitcnt vmcnt(62)
    buffer_load_dwordx4 v[134:137], v130, s[4:7], s27 offen sc1
.p2align 6
B_loop:
    ds_read_b128 v[144:147], v129 offset:0
    ds_read_b128 v[148:151], v129 offset:1024
    ds_read_b128 v[152:155], v129 offset:2048
    ds_read_b128 v[156:159], v129 offset:3072
    ds_read_b128 v[240:243], v129 offset:4096
    ds_read_b128 v[244:247], v129 offset:5120
    ds_read_b128 v[248:251], v129 offset:6144
    ds_read_b128 v[252:255], v129 offset:7168
    v_mov_b32 v36, 0
    v_mov_b32 v37, 0
    v_mov_b32 v38, 0
    v_mov_b32 v39, 0
    v_mov_b32 v40, 0
    v_mov_b32 v41, 0
    v_mov_b32 v42, 0
    v_mov_b32 v43, 0
    v_mov_b32 v44, 0
    v_mov_b32 v45, 0
    v_mov_b32 v46, 0
    v_mov_b32 v47, 0
    v_mov_b32 v48, 0
    v_mov_b32 v49, 0
    v_mov_b32 v50, 0
    v_mov_b32 v51, 0
    v_mov_b32 v52, 0
    v_mov_b32 v53, 0
    v_mov_b32 v54, 0
    v_mov_b32 v55, 0
    v_mov_b32 v56, 0
    v_mov_b32 v57, 0
    v_mov_b32 v58, 0
    v_mov_b32 v59, 0
    v_mov_b32 v60, 0
    v_mov_b32 v61, 0
    v_mov_b32 v62, 0
    v_mov_b32 v63, 0
    v_mov_b32 v64, 0
    v_mov_b32 v65, 0
    v_mov_b32 v66, 0
    v_mov_b32 v67, 0
    v_mov_b32 v112, 0
    v_mov_b32 v113, 0
    v_mov_b32 v114, 0
    v_mov_b32 v115, 0
    v_mov_b32 v116, 0
    v_mov_b32 v117, 0
    v_mov_b32 v118, 0
    v_mov_b32 v119, 0
B_poll:
    buffer_load_dwordx4 v[8:11], v1, s[4:7], s22 offen offset:0 sc1
    buffer_load_dwordx4 v[12:15], v2, s[4:7], s22 offen offset:0 sc1
    s_sub_u32 s18, s18, 1
    s_cbranch_scc1 main_end2
    s_waitcnt vmcnt(1)
    v_max3_u32 v133, v8, v9, v10
    v_max_u32 v133, v133, v11
    s_waitcnt vmcnt(0)
    v_max3_u32 v133, v133, v12, v13
    v_max3_u32 v133, v133, v14, v15
    v_cmp_eq_u32 vcc, -1, v133
    s_cbranch_vccnz B_poll
    s_waitcnt lgkmcnt(0)
    v_smfmac_f32_16x16x64_bf16 v[48:51], v[8:11], v[144:151], v120
    ds_write_b128 v138, v[8:11]
    v_smfmac_f32_16x16x64_bf16 v[64:67], v[8:11], v[152:159], v120
    ds_write_b128 v139, v[12:15]
    s_bitcmp1_b64 s[62:63], s21
    s_cbranch_scc0 B_vwait
B_vok:
    s_add_u32 s33, s21, 2
    s_bitcmp1_b64 s[62:63], s33
    s_cbranch_scc0 B_ref
B_nref:
    v_smfmac_f32_16x16x64_bf16 v[36:39], v[8:11], a[0:7], v120
    s_add_u32 s33, s23, 0
    buffer_load_dwordx4 v[68:71], v121, s[4:7], s33 offen offset:0 sc1
    v_smfmac_f32_16x16x64_bf16 v[52:55], v[8:11], a[8:15], v120
    v_smfmac_f32_16x16x64_bf16 v[40:43], v[8:11], a[16:23], v120
    s_add_u32 s33, s23, 0
    buffer_load_dwordx4 v[76:79], v121, s[4:7], s33 offen offset:1024 sc1
    v_smfmac_f32_16x16x64_bf16 v[56:59], v[8:11], a[24:31], v120
    v_smfmac_f32_16x16x64_bf16 v[44:47], v[8:11], a[32:39], v120
    s_add_u32 s33, s23, 28672
    buffer_load_dwordx4 v[72:75], v121, s[4:7], s33 offen offset:0 sc1
    v_smfmac_f32_16x16x64_bf16 v[60:63], v[8:11], a[40:47], v120
    s_waitcnt lgkmcnt(0)
    s_barrier
    ds_read_b128 v[16:19], v3
    ds_read_b128 v[144:147], v129 offset:8192
    ds_read_b128 v[148:151], v129 offset:9216
    ds_read_b128 v[152:155], v129 offset:10240
    ds_read_b128 v[156:159], v129 offset:11264
    ds_read_b128 v[20:23], v4
    ds_read_b128 v[24:27], v5
    ds_read_b128 v[28:31], v6
    ds_read_b128 v[32:35], v7
    v_smfmac_f32_16x16x64_bf16 v[48:51], v[12:15], v[240:247], v120
    v_smfmac_f32_16x16x64_bf16 v[64:67], v[12:15], v[248:255], v120
    ds_read_b128 v[240:243], v129 offset:12288
    ds_read_b128 v[244:247], v129 offset:13312
    ds_read_b128 v[248:251], v129 offset:14336
    ds_read_b128 v[252:255], v129 offset:15360
    v_smfmac_f32_16x16x64_bf16 v[36:39], v[12:15], a[48:55], v120
    s_add_u32 s33, s23, 28672
    buffer_load_dwordx4 v[80:83], v121, s[4:7], s33 offen offset:1024 sc1
    v_smfmac_f32_16x16x64_bf16 v[52:55], v[12:15], a[56:63], v120
    v_smfmac_f32_16x16x64_bf16 v[40:43], v[12:15], a[64:71], v120
    s_add_u32 s33, s23, 57344
    buffer_load_dwordx4 v[84:87], v121, s[4:7], s33 offen offset:0 sc1
    v_smfmac_f32_16x16x64_bf16 v[56:59], v[12:15], a[72:79], v120
    v_smfmac_f32_16x16x64_bf16 v[44:47], v[12:15], a[80:87], v120
    s_add_u32 s33, s23, 57344
    buffer_load_dwordx4 v[92:95], v121, s[4:7], s33 offen offset:1024 sc1
    v_smfmac_f32_16x16x64_bf16 v[60:63], v[12:15], a[88:95], v120
    s_waitcnt lgkmcnt(8)
    v_smfmac_f32_16x16x64_bf16 v[48:51], v[16:19], v[144:151], v120
    v_smfmac_f32_16x16x64_bf16 v[64:67], v[16:19], v[152:159], v120
    ds_read_b128 v[144:147], v129 offset:16384
    ds_read_b128 v[148:151], v129 offset:17408
    ds_read_b128 v[152:155], v129 offset:18432
    ds_read_b128 v[156:159], v129 offset:19456
    v_smfmac_f32_16x16x64_bf16 v[36:39], v[16:19], a[96:103], v120
    s_add_u32 s33, s23, 86016
    buffer_load_dwordx4 v[88:91], v121, s[4:7], s33 offen offset:0 sc1
    v_smfmac_f32_16x16x64_bf16 v[52:55], v[16:19], a[104:111], v120
    v_smfmac_f32_16x16x64_bf16 v[40:43], v[16:19], a[112:119], v120
    s_add_u32 s33, s23, 86016
    buffer_load_dwordx4 v[96:99], v121, s[4:7], s33 offen offset:1024 sc1
    v_smfmac_f32_16x16x64_bf16 v[56:59], v[16:19], a[120:127], v120
    v_smfmac_f32_16x16x64_bf16 v[44:47], v[16:19], a[128:135], v120
    v_smfmac_f32_16x16x64_bf16 v[60:63], v[16:19], a[136:143], v120
    s_waitcnt lgkmcnt(4)
    v_smfmac_f32_16x16x64_bf16 v[48:51], v[20:23], v[240:247], v120
    v_smfmac_f32_16x16x64_bf16 v[64:67], v[20:23], v[248:255], v120
    ds_read_b128 v[240:243], v129 offset:20480
    ds_read_b128 v[244:247], v129 offset:21504
    ds_read_b128 v[248:251], v129 offset:22528
    ds_read_b128 v[252:255], v129 offset:23552
    v_smfmac_f32_16x16x64_bf16 v[36:39], v[20:23], a[144:151], v120
    v_smfmac_f32_16x16x64_bf16 v[52:55], v[20:23], a[152:159], v120
    v_smfmac_f32_16x16x64_bf16 v[40:43], v[20:23], a[160:167], v120
    v_smfmac_f32_16x16x64_bf16 v[56:59], v[20:23], a[168:175], v120
    v_smfmac_f32_16x16x64_bf16 v[44:47], v[20:23], a[176:183], v120
    v_smfmac_f32_16x16x64_bf16 v[60:63], v[20:23], a[184:191], v120
    s_waitcnt lgkmcnt(4)
    v_smfmac_f32_16x16x64_bf16 v[48:51], v[24:27], v[144:151], v120
    v_smfmac_f32_16x16x64_bf16 v[64:67], v[24:27], v[152:159], v120
    ds_read_b128 v[144:147], v129 offset:24576
    ds_read_b128 v[148:151], v129 offset:25600
    ds_read_b128 v[152:155], v129 offset:26624
    ds_read_b128 v[156:159], v129 offset:27648
    v_smfmac_f32_16x16x64_bf16 v[36:39], v[24:27], a[192:199], v120
    v_smfmac_f32_16x16x64_bf16 v[52:55], v[24:27], a[200:207], v120
    v_smfmac_f32_16x16x64_bf16 v[40:43], v[24:27], a[208:215], v120
    v_smfmac_f32_16x16x64_bf16 v[56:59], v[24:27], a[216:223], v120
    v_smfmac_f32_16x16x64_bf16 v[44:47], v[24:27], a[224:231], v120
    v_smfmac_f32_16x16x64_bf16 v[60:63], v[24:27], a[232:239], v120
    s_waitcnt lgkmcnt(4)
    v_smfmac_f32_16x16x64_bf16 v[48:51], v[28:31], v[240:247], v120
    v_smfmac_f32_16x16x64_bf16 v[64:67], v[28:31], v[248:255], v120
    v_smfmac_f32_16x16x64_bf16 v[36:39], v[28:31], a[240:247], v120
    v_smfmac_f32_16x16x64_bf16 v[52:55], v[28:31], a[248:255], v120
    v_smfmac_f32_16x16x64_bf16 v[40:43], v[28:31], v[160:167], v120
    v_smfmac_f32_16x16x64_bf16 v[56:59], v[28:31], v[168:175], v120
    v_smfmac_f32_16x16x64_bf16 v[44:47], v[28:31], v[176:183], v120
    v_smfmac_f32_16x16x64_bf16 v[60:63], v[28:31], v[184:191], v120
    s_waitcnt lgkmcnt(0)
    v_smfmac_f32_16x16x64_bf16 v[36:39], v[32:35], v[192:199], v120
    buffer_load_dwordx4 v[8:11], v141, s[4:7], s25 offen sc1
    v_smfmac_f32_16x16x64_bf16 v[52:55], v[32:35], v[200:207], v120
    v_smfmac_f32_16x16x64_bf16 v[40:43], v[32:35], v[208:215], v120
    v_smfmac_f32_16x16x64_bf16 v[56:59], v[32:35], v[216:223], v120
    s_nop 3
    v_cvt_pk_bf16_f32 v36, v36, v37
    v_cvt_pk_bf16_f32 v38, v38, v39
    v_smfmac_f32_16x16x64_bf16 v[44:47], v[32:35], v[224:231], v120
    v_cvt_pk_bf16_f32 v52, v52, v53
    v_cvt_pk_bf16_f32 v54, v54, v55
    s_cmp_eq_u32 s19, 0
    s_cbranch_scc1 B_hinted
B_hint:
    buffer_load_dwordx4 v[8:11], v141, s[4:7], s25 offen sc1
    s_sub_u32 s18, s18, 1
    s_cbranch_scc1 main_end2
    s_waitcnt vmcnt(1)
    v_min3_u32 v12, v8, v9, v10
    v_min_u32 v12, v12, v11
    v_cmp_eq_u32 vcc, 0, v12
    s_cbranch_vccnz B_hint
B_hinted:
    buffer_load_dwordx4 v[100:103], v122, s[4:7], s24 offen offset:0 sc1
    buffer_load_dwordx4 v[104:107], v122, s[4:7], s24 offen offset:1280 sc1
    buffer_load_dwordx4 v[108:111], v123, s[4:7], s24 offen offset:1024 sc1
    v_smfmac_f32_16x16x64_bf16 v[60:63], v[32:35], v[232:239], v120
    v_cvt_pk_bf16_f32 v37, v40, v41
    v_cvt_pk_bf16_f32 v39, v42, v43
    v_smfmac_f32_16x16x64_bf16 v[48:51], v[32:35], v[144:151], v120
    v_cvt_pk_bf16_f32 v53, v56, v57
    v_cvt_pk_bf16_f32 v55, v58, v59
    v_smfmac_f32_16x16x64_bf16 v[64:67], v[32:35], v[152:159], v120
    v_cvt_pk_bf16_f32 v40, v44, v45
    v_cvt_pk_bf16_f32 v42, v46, v47
    v_cvt_pk_bf16_f32 v56, v60, v61
    v_cvt_pk_bf16_f32 v58, v62, v63
    s_nop 0
    v_cvt_pk_bf16_f32 v41, v48, v49
    v_cvt_pk_bf16_f32 v43, v50, v51
    s_nop 0
    v_cvt_pk_bf16_f32 v57, v64, v65
    v_cvt_pk_bf16_f32 v59, v66, v67
B_pollp:
    buffer_load_dwordx4 v[100:103], v122, s[4:7], s24 offen offset:0 sc1
    buffer_load_dwordx4 v[104:107], v122, s[4:7], s24 offen offset:1280 sc1
    buffer_load_dwordx4 v[108:111], v123, s[4:7], s24 offen offset:1024 sc1
    s_sub_u32 s18, s18, 1
    s_cbranch_scc1 main_end2
    s_waitcnt vmcnt(5)
    v_max3_u32 v133, v100, v101, v102
    v_max_u32 v133, v133, v103
    v_smfmac_f32_16x16x64_bf16 v[112:115], v[100:103], v[68:75], v140
    v_smfmac_f32_16x16x64_bf16 v[116:119], v[100:103], v[76:83], v140
    s_waitcnt vmcnt(4)
    v_max3_u32 v133, v133, v104, v105
    v_max3_u32 v133, v133, v106, v107
    v_smfmac_f32_16x16x64_bf16 v[112:115], v[104:107], v[84:91], v140
    v_smfmac_f32_16x16x64_bf16 v[116:119], v[104:107], v[92:99], v140
    s_waitcnt vmcnt(3)
    v_max3_u32 v133, v133, v108, v109
    v_max3_u32 v133, v133, v110, v111
    v_cmp_eq_u32 vcc, -1, v133
    v_smfmac_f32_16x16x64_bf16 v[112:115], v[108:111], v[36:43], v140
    v_smfmac_f32_16x16x64_bf16 v[116:119], v[108:111], v[52:59], v140
    s_cbranch_vccnz B_again
    s_add_u32 s22, s22, 14336
    s_cmp_eq_u32 s19, 0
    s_nop 3
    v_pk_add_f32 v[112:113], v[112:113], v[114:115]
    ds_write2_b32 v124, v112, v113 offset0:0 offset1:32
    v_pk_add_f32 v[116:117], v[116:117], v[118:119]
    ds_write2_b32 v126, v116, v117 offset0:0 offset1:32
    s_waitcnt lgkmcnt(0)
    s_barrier
    ds_read_b64 v[16:17], v125 offset:0
    ds_read_b64 v[18:19], v125 offset:1024
    ds_read_b64 v[20:21], v125 offset:2048
    ds_read_b64 v[22:23], v125 offset:3072
    s_waitcnt lgkmcnt(2)
    v_pk_add_f32 v[16:17], v[16:17], v[18:19]
    s_waitcnt lgkmcnt(0)
    v_pk_add_f32 v[20:21], v[20:21], v[22:23]
    v_pk_add_f32 v[16:17], v[16:17], v[20:21]
    v_cvt_pk_bf16_f32 v16, v16, v17
    v_min_u32 v16, -2, v16
    s_cbranch_scc1 B_far
    buffer_store_dword v16, v127, s[4:7], s22 offen
B_back:
    v_min3_u32 v24, v134, v135, v136
    v_min_u32 v24, v24, v137
    v_cmp_ne_u32 s[62:63], 0, v24
    s_add_u32 s21, s21, 1
    s_add_u32 s23, s23, 458752
    s_add_u32 s24, s24, 10240
    s_add_u32 s25, s25, 512
    s_cmp_lt_u32 s21, 62
    s_cbranch_scc1 B_loop
    s_cmp_eq_u32 s21, 62
    s_cbranch_scc0 B_end
    s_mov_b32 s19, 0
    v_mov_b32 v127, v128
    s_branch B_loop
B_end:
    s_endpgm
B_far:
    buffer_store_dword v16, v127, s[4:7], s22 offen sc1
    s_branch B_back
B_ref:
    buffer_load_dwordx4 v[134:137], v130, s[4:7], s27 offen sc1
    s_branch B_nref
B_again:
    s_nop 7
    v_mov_b32 v112, 0
    v_mov_b32 v113, 0
    v_mov_b32 v114, 0
    v_mov_b32 v115, 0
    v_mov_b32 v116, 0
    v_mov_b32 v117, 0
    v_mov_b32 v118, 0
    v_mov_b32 v119, 0
    s_branch B_pollp
B_vwait:
    s_waitcnt vmcnt(0)
    v_min3_u32 v132, v134, v135, v136
    v_min_u32 v132, v132, v137
    v_cmp_ne_u32 s[62:63], 0, v132
    s_nop 4
    s_bitcmp1_b64 s[62:63], s21
    s_cbranch_scc1 B_vok
    buffer_load_dwordx4 v[134:137], v130, s[4:7], s27 offen sc1
    s_sub_u32 s18, s18, 1
    s_cbranch_scc0 B_vwait
    s_branch main_end2
role_R:
    v_lshlrev_b32 v1, 4, v0
    s_lshl_b32 s20, s16, 11
    v_add_u32 v1, s20, v1
    v_add_u32 v2, 1024, v1
    s_cmp_eq_u32 s16, 3
    s_cselect_b32 s20, 1024, 0
    v_subrev_u32 v2, s20, v2
    v_add_u32 v3, 7168, v1
    v_add_u32 v4, 7168, v2
    v_and_b32 v5, 8, v0
    v_cmp_ne_u32 s[40:41], 0, v5
    s_mov_b32 s21, 1
    s_mov_b32 s22, 65615872
    v_lshlrev_b32 v6, 7, v0
    s_lshl_b32 s20, s16, 2
    s_mul_i32 s20, s20, 28672
    s_add_u32 s23, s20, 21102592
R_loop:
R_poll:
    buffer_load_dwordx4 v[8:11], v1, s[4:7], s22 offen offset:0 sc1
    buffer_load_dwordx4 v[12:15], v2, s[4:7], s22 offen offset:0 sc1
    s_sub_u32 s18, s18, 1
    s_cbranch_scc1 main_end2
    s_waitcnt vmcnt(1)
    v_max3_u32 v5, v8, v9, v10
    v_max_u32 v5, v5, v11
    s_waitcnt vmcnt(0)
    v_max3_u32 v5, v5, v12, v13
    v_max3_u32 v5, v5, v14, v15
    v_cmp_eq_u32 vcc, -1, v5
    s_cbranch_vccnz R_poll
    v_cndmask_b32 v20, v10, v8, s[40:41]
    v_cndmask_b32 v21, v11, v9, s[40:41]
    s_nop 0
    v_mov_b32_dpp v20, v20 row_ror:8 row_mask:0xf bank_mask:0xf
    v_mov_b32_dpp v21, v21 row_ror:8 row_mask:0xf bank_mask:0xf
    v_cndmask_b32 v16, v8, v20, s[40:41]
    v_cndmask_b32 v17, v20, v10, s[40:41]
    v_cndmask_b32 v18, v9, v21, s[40:41]
    v_cndmask_b32 v19, v21, v11, s[40:41]
    buffer_store_dwordx4 v[16:19], v3, s[4:7], s22 offen sc1
    v_cndmask_b32 v28, v14, v12, s[40:41]
    v_cndmask_b32 v29, v15, v13, s[40:41]
    s_nop 0
    v_mov_b32_dpp v28, v28 row_ror:8 row_mask:0xf bank_mask:0xf
    v_mov_b32_dpp v29, v29 row_ror:8 row_mask:0xf bank_mask:0xf
    v_cndmask_b32 v24, v12, v28, s[40:41]
    v_cndmask_b32 v25, v28, v14, s[40:41]
    v_cndmask_b32 v26, v13, v29, s[40:41]
    v_cndmask_b32 v27, v29, v15, s[40:41]
    buffer_store_dwordx4 v[24:27], v4, s[4:7], s22 offen sc1
    s_add_u32 s21, s21, 1
    s_add_u32 s22, s22, 14336
    s_add_u32 s23, s23, 458752
    s_cmp_lt_u32 s21, 63
    s_cbranch_scc1 R_loop
    s_endpgm
role_L:
    s_lshl_b32 s20, s16, 6
    v_add_u32 v1, s20, v0
    v_min_u32 v2, 223, v1
    v_lshlrev_b32 v2, 7, v2
    v_add_u32 v2, 17891328, v2
    v_lshlrev_b32 v3, 7, v1
    v_add_u32 v4, 66511872, v3
    v_add_u32 v3, 65615872, v3
    v_cmp_gt_u32 vcc, 56, v1
    s_nop 1
    v_cndmask_b32 v3, v4, v3, vcc
    v_mov_b32 v4, 10240
    v_mov_b32 v5, 14336
    v_cndmask_b32 v4, v4, v5, vcc
    v_lshlrev_b32 v5, 7, v1
    v_add_u32 v5, 69827584, v5
    v_cmp_gt_u32 vcc, 136, v1
    s_nop 1
    v_cndmask_b32 v3, v5, v3, vcc
    v_mov_b32 v5, 512
    v_cndmask_b32 v4, v5, v4, vcc
    v_bfrev_b32 v5, 1
    v_cmp_gt_u32 vcc, 140, v1
    s_nop 1
    v_cndmask_b32 v3, v5, v3, vcc
    v_cndmask_b32 v4, 0, v4, vcc
    v_lshlrev_b32 v6, 7, v0
    s_lshl_b32 s20, s16, 2
    s_mul_i32 s20, s20, 28672
    s_add_u32 s20, s20, 19726336
    v_add_u32 v6, s20, v6
    v_mov_b32 v7, 0
    s_mov_b32 s21, 0
    s_mov_b32 s22, 65601536
    s_mov_b32 s23, 0
    v_and_b32 v12, 1, v0
    v_lshlrev_b32 v12, 4, v12
    v_lshrrev_b32 v16, 1, v0
    v_lshl_add_u32 v16, v16, 7, v12
    v_add_u32 v16, 69828608, v16
    s_cmp_eq_u32 s16, 0
    s_cbranch_scc0 wad_13
wa_12:
    buffer_load_dwordx4 v[12:15], v16, s[4:7], 0 offen sc1
    s_waitcnt vmcnt(0)
    v_min3_u32 v12, v12, v13, v14
    v_min_u32 v12, v12, v15
    v_cmp_eq_u32 vcc, 0, v12
    s_cbranch_vccz wad_13
    s_sub_u32 s18, s18, 1
    s_cbranch_scc1 main_end2
    s_sleep 16
    s_branch wa_12
wad_13:
    s_waitcnt vmcnt(0)
    s_barrier
L_loop:
    buffer_load_dword v8, v2, s[4:7], 0 offen sc1
    buffer_load_dword v8, v3, s[4:7], 0 offen sc1
    v_add_u32 v2, 28672, v2
    v_add_u32 v3, v4, v3
    s_add_u32 s23, s23, 458752
    s_add_u32 s21, s21, 1
    s_cmp_le_u32 s21, 2
    s_cbranch_scc1 L_loop
    s_cmp_ge_u32 s21, 63
    s_cbranch_scc1 main_end2
    s_add_u32 s22, s22, 14336
L_poll:
    buffer_load_dword v8, v7, s[4:7], s22 offen sc1
    s_sub_u32 s18, s18, 1
    s_cbranch_scc1 main_end2
    s_waitcnt vmcnt(0)
    v_cmp_eq_u32 vcc, -1, v8
    s_cbranch_vccz L_loop
    s_sleep 2
    s_branch L_poll
main_end2:
    s_endpgm
role_V:
    s_sub_u32 s27, s17, 32
    s_lshr_b32 s22, s27, 2
    s_and_b32 s21, s27, 3
    s_add_u32 s20, s22, 16
    s_lshr_b32 s28, s16, 1
    s_mul_i32 s28, s28, 7
    s_and_b32 s29, s16, 1
    s_mul_i32 s30, s21, 4
    s_add_u32 s28, s28, s30
    s_cmp_eq_u32 s29, 0
    s_cselect_b32 s30, 4, 16
    s_add_u32 s30, s30, s28
    s_sub_u32 s31, s30, 14
    s_cselect_b32 s30, s30, s31
    s_sub_u32 s31, s30, 14
    s_cselect_b32 s30, s30, s31
    s_lshl_b32 s40, s30, 11
    s_cmp_eq_u32 s29, 0
    s_cselect_b32 s30, 5, 15
    s_add_u32 s30, s30, s28
    s_sub_u32 s31, s30, 14
    s_cselect_b32 s30, s30, s31
    s_sub_u32 s31, s30, 14
    s_cselect_b32 s30, s30, s31
    s_lshl_b32 s41, s30, 11
    s_cmp_eq_u32 s29, 0
    s_cselect_b32 s30, 6, 14
    s_add_u32 s30, s30, s28
    s_sub_u32 s31, s30, 14
    s_cselect_b32 s30, s30, s31
    s_sub_u32 s31, s30, 14
    s_cselect_b32 s30, s30, s31
    s_lshl_b32 s42, s30, 11
    s_cmp_eq_u32 s29, 0
    s_cselect_b32 s30, 7, 13
    s_add_u32 s30, s30, s28
    s_sub_u32 s31, s30, 14
    s_cselect_b32 s30, s30, s31
    s_sub_u32 s31, s30, 14
    s_cselect_b32 s30, s30, s31
    s_lshl_b32 s43, s30, 11
    s_cmp_eq_u32 s29, 0
    s_cselect_b32 s30, 8, 12
    s_add_u32 s30, s30, s28
    s_sub_u32 s31, s30, 14
    s_cselect_b32 s30, s30, s31
    s_sub_u32 s31, s30, 14
    s_cselect_b32 s30, s30, s31
    s_lshl_b32 s44, s30, 11
    s_cmp_eq_u32 s29, 0
    s_cselect_b32 s30, 9, 11
    s_add_u32 s30, s30, s28
    s_sub_u32 s31, s30, 14
    s_cselect_b32 s30, s30, s31
    s_sub_u32 s31, s30, 14
    s_cselect_b32 s30, s30, s31
    s_lshl_b32 s45, s30, 11
    s_cmp_eq_u32 s29, 0
    s_cselect_b32 s30, 10, 10
    s_add_u32 s30, s30, s28
    s_sub_u32 s31, s30, 14
    s_cselect_b32 s30, s30, s31
    s_sub_u32 s31, s30, 14
    s_cselect_b32 s30, s30, s31
    s_lshl_b32 s46, s30, 11
    s_cmp_eq_u32 s29, 0
    s_cselect_b32 s30, 11, 9
    s_add_u32 s30, s30, s28
    s_sub_u32 s31, s30, 14
    s_cselect_b32 s30, s30, s31
    s_sub_u32 s31, s30, 14
    s_cselect_b32 s30, s30, s31
    s_lshl_b32 s47, s30, 11
    s_cmp_eq_u32 s29, 0
    s_cselect_b32 s30, 12, 8
    s_add_u32 s30, s30, s28
    s_sub_u32 s31, s30, 14
    s_cselect_b32 s30, s30, s31
    s_sub_u32 s31, s30, 14
    s_cselect_b32 s30, s30, s31
    s_lshl_b32 s48, s30, 11
    s_cmp_eq_u32 s29, 0
    s_cselect_b32 s30, 13, 7
    s_add_u32 s30, s30, s28
    s_sub_u32 s31, s30, 14
    s_cselect_b32 s30, s30, s31
    s_sub_u32 s31, s30, 14
    s_cselect_b32 s30, s30, s31
    s_lshl_b32 s49, s30, 11
    s_cmp_eq_u32 s29, 0
    s_cselect_b32 s30, 14, 6
    s_add_u32 s30, s30, s28
    s_sub_u32 s31, s30, 14
    s_cselect_b32 s30, s30, s31
    s_sub_u32 s31, s30, 14
    s_cselect_b32 s30, s30, s31
    s_lshl_b32 s50, s30, 11
    s_cmp_eq_u32 s29, 0
    s_cselect_b32 s30, 15, 5
    s_add_u32 s30, s30, s28
    s_sub_u32 s31, s30, 14
    s_cselect_b32 s30, s30, s31
    s_sub_u32 s31, s30, 14
    s_cselect_b32 s30, s30, s31
    s_lshl_b32 s51, s30, 11
    s_cmp_eq_u32 s29, 0
    s_cselect_b32 s30, 16, 4
    s_add_u32 s30, s30, s28
    s_sub_u32 s31, s30, 14
    s_cselect_b32 s30, s30, s31
    s_sub_u32 s31, s30, 14
    s_cselect_b32 s30, s30, s31
    s_lshl_b32 s52, s30, 11
    s_cmp_eq_u32 s29, 0
    s_cselect_b32 s30, 17, 3
    s_add_u32 s30, s30, s28
    s_sub_u32 s31, s30, 14
    s_cselect_b32 s30, s30, s31
    s_sub_u32 s31, s30, 14
    s_cselect_b32 s30, s30, s31
    s_lshl_b32 s53, s30, 11
    s_mul_i32 s56, s16, 7
    s_add_u32 s56, s56, 0
    s_mul_i32 s57, s16, 7
    s_add_u32 s57, s57, 1
    s_mul_i32 s58, s16, 7
    s_add_u32 s58, s58, 2
    s_mul_i32 s59, s16, 7
    s_add_u32 s59, s59, 3
    s_mul_i32 s60, s16, 7
    s_add_u32 s60, s60, 4
    s_mul_i32 s61, s16, 7
    s_add_u32 s61, s61, 5
    s_mul_i32 s62, s16, 7
    s_add_u32 s62, s62, 6
    v_lshlrev_b32 v1, 4, v0
    v_lshrrev_b32 v3, 4, v0
    v_and_b32 v4, 15, v0
    v_lshlrev_b32 v2, 9, v3
    v_lshl_add_u32 v2, v4, 4, v2
    s_mul_i32 s30, s20, 401408
    s_mul_i32 s64, s56, 14336
    s_add_u32 s64, s64, s30
    s_mul_i32 s65, s57, 14336
    s_add_u32 s65, s65, s30
    s_mul_i32 s66, s58, 14336
    s_add_u32 s66, s66, s30
    s_mul_i32 s67, s59, 14336
    s_add_u32 s67, s67, s30
    s_mul_i32 s68, s60, 14336
    s_add_u32 s68, s68, s30
    s_mul_i32 s69, s61, 14336
    s_add_u32 s69, s69, s30
    s_mul_i32 s70, s62, 14336
    s_add_u32 s70, s70, s30
    v_and_b32 v9, 3, v0
    v_lshl_add_u32 v9, s21, 2, v9
    v_and_b32 v10, 7, v9
    v_lshrrev_b32 v9, 3, v9
    v_lshl_add_u32 v9, v10, 2, v9
    v_lshlrev_b32 v9, 7, v9
    s_lshl_b32 s30, s20, 7
    v_lshl_add_u32 v10, v0, 2, s30
    v_cmp_gt_u32 vcc, 8, v0
    s_nop 1
    v_cndmask_b32 v9, v9, v10, vcc
    v_add_u32 v9, 69828608, v9
    s_cmp_eq_u32 s16, 0
    s_cbranch_scc0 wad_15
wa_14:
    buffer_load_dword v8, v9, s[4:7], 0 offen sc1
    s_waitcnt vmcnt(0)
    v_cmp_eq_u32 vcc, 0, v8
    s_cbranch_vccz wad_15
    s_sub_u32 s18, s18, 1
    s_cbranch_scc1 main_end2
    s_sleep 2
    s_branch wa_14
wad_15:
    s_waitcnt vmcnt(0)
    s_barrier
    s_mul_i32 s23, s21, 28672
    s_add_u32 s23, s23, 16056320
    s_add_u32 s33, s23, s40
    buffer_load_dwordx4 v[8:11], v2, s[4:7], s33 offen offset:0
    buffer_load_dwordx4 v[12:15], v2, s[4:7], s33 offen offset:256
    s_lshr_b32 s31, s40, 1
    s_add_u32 s33, s31, s64
    buffer_load_dwordx4 a[0:3], v1, s[4:7], s33 offen
    s_add_u32 s33, s31, s65
    buffer_load_dwordx4 a[4:7], v1, s[4:7], s33 offen
    s_add_u32 s33, s31, s66
    buffer_load_dwordx4 a[8:11], v1, s[4:7], s33 offen
    s_add_u32 s33, s31, s67
    buffer_load_dwordx4 a[12:15], v1, s[4:7], s33 offen
    s_add_u32 s33, s31, s68
    buffer_load_dwordx4 a[16:19], v1, s[4:7], s33 offen
    s_add_u32 s33, s31, s69
    buffer_load_dwordx4 a[20:23], v1, s[4:7], s33 offen
    s_add_u32 s33, s31, s70
    buffer_load_dwordx4 a[24:27], v1, s[4:7], s33 offen
    s_add_u32 s33, s23, s41
    buffer_load_dwordx4 v[16:19], v2, s[4:7], s33 offen offset:0
    buffer_load_dwordx4 v[20:23], v2, s[4:7], s33 offen offset:256
    s_lshr_b32 s31, s41, 1
    s_add_u32 s33, s31, s64
    buffer_load_dwordx4 a[28:31], v1, s[4:7], s33 offen
    s_add_u32 s33, s31, s65
    buffer_load_dwordx4 a[32:35], v1, s[4:7], s33 offen
    s_add_u32 s33, s31, s66
    buffer_load_dwordx4 a[36:39], v1, s[4:7], s33 offen
    s_add_u32 s33, s31, s67
    buffer_load_dwordx4 a[40:43], v1, s[4:7], s33 offen
    s_add_u32 s33, s31, s68
    buffer_load_dwordx4 a[44:47], v1, s[4:7], s33 offen
    s_add_u32 s33, s31, s69
    buffer_load_dwordx4 a[48:51], v1, s[4:7], s33 offen
    s_add_u32 s33, s31, s70
    buffer_load_dwordx4 a[52:55], v1, s[4:7], s33 offen
    s_add_u32 s33, s23, s42
    buffer_load_dwordx4 v[24:27], v2, s[4:7], s33 offen offset:0
    buffer_load_dwordx4 v[28:31], v2, s[4:7], s33 offen offset:256
    s_lshr_b32 s31, s42, 1
    s_add_u32 s33, s31, s64
    buffer_load_dwordx4 a[56:59], v1, s[4:7], s33 offen
    s_add_u32 s33, s31, s65
    buffer_load_dwordx4 a[60:63], v1, s[4:7], s33 offen
    s_add_u32 s33, s31, s66
    buffer_load_dwordx4 a[64:67], v1, s[4:7], s33 offen
    s_add_u32 s33, s31, s67
    buffer_load_dwordx4 a[68:71], v1, s[4:7], s33 offen
    s_add_u32 s33, s31, s68
    buffer_load_dwordx4 a[72:75], v1, s[4:7], s33 offen
    s_add_u32 s33, s31, s69
    buffer_load_dwordx4 a[76:79], v1, s[4:7], s33 offen
    s_add_u32 s33, s31, s70
    buffer_load_dwordx4 a[80:83], v1, s[4:7], s33 offen
    s_add_u32 s33, s23, s43
    buffer_load_dwordx4 v[32:35], v2, s[4:7], s33 offen offset:0
    buffer_load_dwordx4 v[36:39], v2, s[4:7], s33 offen offset:256
    s_lshr_b32 s31, s43, 1
    s_add_u32 s33, s31, s64
    buffer_load_dwordx4 a[84:87], v1, s[4:7], s33 offen
    s_add_u32 s33, s31, s65
    buffer_load_dwordx4 a[88:91], v1, s[4:7], s33 offen
    s_add_u32 s33, s31, s66
    buffer_load_dwordx4 a[92:95], v1, s[4:7], s33 offen
    s_add_u32 s33, s31, s67
    buffer_load_dwordx4 a[96:99], v1, s[4:7], s33 offen
    s_add_u32 s33, s31, s68
    buffer_load_dwordx4 a[100:103], v1, s[4:7], s33 offen
    s_add_u32 s33, s31, s69
    buffer_load_dwordx4 a[104:107], v1, s[4:7], s33 offen
    s_add_u32 s33, s31, s70
    buffer_load_dwordx4 a[108:111], v1, s[4:7], s33 offen
    s_add_u32 s33, s23, s44
    buffer_load_dwordx4 v[40:43], v2, s[4:7], s33 offen offset:0
    buffer_load_dwordx4 v[44:47], v2, s[4:7], s33 offen offset:256
    s_lshr_b32 s31, s44, 1
    s_add_u32 s33, s31, s64
    buffer_load_dwordx4 a[112:115], v1, s[4:7], s33 offen
    s_add_u32 s33, s31, s65
    buffer_load_dwordx4 a[116:119], v1, s[4:7], s33 offen
    s_add_u32 s33, s31, s66
    buffer_load_dwordx4 a[120:123], v1, s[4:7], s33 offen
    s_add_u32 s33, s31, s67
    buffer_load_dwordx4 a[124:127], v1, s[4:7], s33 offen
    s_add_u32 s33, s31, s68
    buffer_load_dwordx4 a[128:131], v1, s[4:7], s33 offen
    s_add_u32 s33, s31, s69
    buffer_load_dwordx4 a[132:135], v1, s[4:7], s33 offen
    s_add_u32 s33, s31, s70
    buffer_load_dwordx4 a[136:139], v1, s[4:7], s33 offen
    s_add_u32 s33, s23, s45
    buffer_load_dwordx4 v[48:51], v2, s[4:7], s33 offen offset:0
    buffer_load_dwordx4 v[52:55], v2, s[4:7], s33 offen offset:256
    s_lshr_b32 s31, s45, 1
    s_add_u32 s33, s31, s64
    buffer_load_dwordx4 a[140:143], v1, s[4:7], s33 offen
    s_add_u32 s33, s31, s65
    buffer_load_dwordx4 a[144:147], v1, s[4:7], s33 offen
    s_add_u32 s33, s31, s66
    buffer_load_dwordx4 a[148:151], v1, s[4:7], s33 offen
    s_add_u32 s33, s31, s67
    buffer_load_dwordx4 a[152:155], v1, s[4:7], s33 offen
    s_add_u32 s33, s31, s68
    buffer_load_dwordx4 a[156:159], v1, s[4:7], s33 offen
    s_add_u32 s33, s31, s69
    buffer_load_dwordx4 a[160:163], v1, s[4:7], s33 offen
    s_add_u32 s33, s31, s70
    buffer_load_dwordx4 a[164:167], v1, s[4:7], s33 offen
    s_add_u32 s33, s23, s46
    buffer_load_dwordx4 v[56:59], v2, s[4:7], s33 offen offset:0
    buffer_load_dwordx4 v[60:63], v2, s[4:7], s33 offen offset:256
    s_lshr_b32 s31, s46, 1
    s_add_u32 s33, s31, s64
    buffer_load_dwordx4 a[168:171], v1, s[4:7], s33 offen
    s_add_u32 s33, s31, s65
    buffer_load_dwordx4 a[172:175], v1, s[4:7], s33 offen
    s_add_u32 s33, s31, s66
    buffer_load_dwordx4 a[176:179], v1, s[4:7], s33 offen
    s_add_u32 s33, s31, s67
    buffer_load_dwordx4 a[180:183], v1, s[4:7], s33 offen
    s_add_u32 s33, s31, s68
    buffer_load_dwordx4 a[184:187], v1, s[4:7], s33 offen
    s_add_u32 s33, s31, s69
    buffer_load_dwordx4 a[188:191], v1, s[4:7], s33 offen
    s_add_u32 s33, s31, s70
    buffer_load_dwordx4 a[192:195], v1, s[4:7], s33 offen
    s_waitcnt vmcnt(54)
    v_mfma_f32_16x16x32_bf16 v[64:67], v[8:11], a[0:3], 0
    v_mfma_f32_16x16x32_bf16 v[72:75], v[8:11], a[4:7], 0
    v_mfma_f32_16x16x32_bf16 v[80:83], v[8:11], a[8:11], 0
    v_mfma_f32_16x16x32_bf16 v[88:91], v[8:11], a[12:15], 0
    v_mfma_f32_16x16x32_bf16 v[96:99], v[8:11], a[16:19], 0
    v_mfma_f32_16x16x32_bf16 v[104:107], v[8:11], a[20:23], 0
    v_mfma_f32_16x16x32_bf16 v[112:115], v[8:11], a[24:27], 0
    v_mfma_f32_16x16x32_bf16 v[68:71], v[12:15], a[0:3], 0
    v_mfma_f32_16x16x32_bf16 v[76:79], v[12:15], a[4:7], 0
    v_mfma_f32_16x16x32_bf16 v[84:87], v[12:15], a[8:11], 0
    v_mfma_f32_16x16x32_bf16 v[92:95], v[12:15], a[12:15], 0
    v_mfma_f32_16x16x32_bf16 v[100:103], v[12:15], a[16:19], 0
    v_mfma_f32_16x16x32_bf16 v[108:111], v[12:15], a[20:23], 0
    v_mfma_f32_16x16x32_bf16 v[116:119], v[12:15], a[24:27], 0
    s_add_u32 s33, s23, s47
    buffer_load_dwordx4 v[8:11], v2, s[4:7], s33 offen offset:0
    buffer_load_dwordx4 v[12:15], v2, s[4:7], s33 offen offset:256
    s_lshr_b32 s31, s47, 1
    s_add_u32 s33, s31, s64
    buffer_load_dwordx4 a[196:199], v1, s[4:7], s33 offen
    s_add_u32 s33, s31, s65
    buffer_load_dwordx4 a[200:203], v1, s[4:7], s33 offen
    s_add_u32 s33, s31, s66
    buffer_load_dwordx4 a[204:207], v1, s[4:7], s33 offen
    s_add_u32 s33, s31, s67
    buffer_load_dwordx4 a[208:211], v1, s[4:7], s33 offen
    s_add_u32 s33, s31, s68
    buffer_load_dwordx4 a[212:215], v1, s[4:7], s33 offen
    s_add_u32 s33, s31, s69
    buffer_load_dwordx4 a[216:219], v1, s[4:7], s33 offen
    s_add_u32 s33, s31, s70
    buffer_load_dwordx4 a[220:223], v1, s[4:7], s33 offen
    s_waitcnt vmcnt(54)
    v_mfma_f32_16x16x32_bf16 v[64:67], v[16:19], a[28:31], v[64:67]
    v_mfma_f32_16x16x32_bf16 v[72:75], v[16:19], a[32:35], v[72:75]
    v_mfma_f32_16x16x32_bf16 v[80:83], v[16:19], a[36:39], v[80:83]
    v_mfma_f32_16x16x32_bf16 v[88:91], v[16:19], a[40:43], v[88:91]
    v_mfma_f32_16x16x32_bf16 v[96:99], v[16:19], a[44:47], v[96:99]
    v_mfma_f32_16x16x32_bf16 v[104:107], v[16:19], a[48:51], v[104:107]
    v_mfma_f32_16x16x32_bf16 v[112:115], v[16:19], a[52:55], v[112:115]
    v_mfma_f32_16x16x32_bf16 v[68:71], v[20:23], a[28:31], v[68:71]
    v_mfma_f32_16x16x32_bf16 v[76:79], v[20:23], a[32:35], v[76:79]
    v_mfma_f32_16x16x32_bf16 v[84:87], v[20:23], a[36:39], v[84:87]
    v_mfma_f32_16x16x32_bf16 v[92:95], v[20:23], a[40:43], v[92:95]
    v_mfma_f32_16x16x32_bf16 v[100:103], v[20:23], a[44:47], v[100:103]
    v_mfma_f32_16x16x32_bf16 v[108:111], v[20:23], a[48:51], v[108:111]
    v_mfma_f32_16x16x32_bf16 v[116:119], v[20:23], a[52:55], v[116:119]
    s_add_u32 s33, s23, s48
    buffer_load_dwordx4 v[16:19], v2, s[4:7], s33 offen offset:0
    buffer_load_dwordx4 v[20:23], v2, s[4:7], s33 offen offset:256
    s_lshr_b32 s31, s48, 1
    s_add_u32 s33, s31, s64
    buffer_load_dwordx4 a[224:227], v1, s[4:7], s33 offen
    s_add_u32 s33, s31, s65
    buffer_load_dwordx4 a[228:231], v1, s[4:7], s33 offen
    s_add_u32 s33, s31, s66
    buffer_load_dwordx4 a[232:235], v1, s[4:7], s33 offen
    s_add_u32 s33, s31, s67
    buffer_load_dwordx4 a[236:239], v1, s[4:7], s33 offen
    s_add_u32 s33, s31, s68
    buffer_load_dwordx4 a[240:243], v1, s[4:7], s33 offen
    s_add_u32 s33, s31, s69
    buffer_load_dwordx4 a[244:247], v1, s[4:7], s33 offen
    s_add_u32 s33, s31, s70
    buffer_load_dwordx4 a[248:251], v1, s[4:7], s33 offen
    s_waitcnt vmcnt(54)
    v_mfma_f32_16x16x32_bf16 v[64:67], v[24:27], a[56:59], v[64:67]
    v_mfma_f32_16x16x32_bf16 v[72:75], v[24:27], a[60:63], v[72:75]
    v_mfma_f32_16x16x32_bf16 v[80:83], v[24:27], a[64:67], v[80:83]
    v_mfma_f32_16x16x32_bf16 v[88:91], v[24:27], a[68:71], v[88:91]
    v_mfma_f32_16x16x32_bf16 v[96:99], v[24:27], a[72:75], v[96:99]
    v_mfma_f32_16x16x32_bf16 v[104:107], v[24:27], a[76:79], v[104:107]
    v_mfma_f32_16x16x32_bf16 v[112:115], v[24:27], a[80:83], v[112:115]
    v_mfma_f32_16x16x32_bf16 v[68:71], v[28:31], a[56:59], v[68:71]
    v_mfma_f32_16x16x32_bf16 v[76:79], v[28:31], a[60:63], v[76:79]
    v_mfma_f32_16x16x32_bf16 v[84:87], v[28:31], a[64:67], v[84:87]
    v_mfma_f32_16x16x32_bf16 v[92:95], v[28:31], a[68:71], v[92:95]
    v_mfma_f32_16x16x32_bf16 v[100:103], v[28:31], a[72:75], v[100:103]
    v_mfma_f32_16x16x32_bf16 v[108:111], v[28:31], a[76:79], v[108:111]
    v_mfma_f32_16x16x32_bf16 v[116:119], v[28:31], a[80:83], v[116:119]
    s_add_u32 s33, s23, s49
    buffer_load_dwordx4 v[24:27], v2, s[4:7], s33 offen offset:0
    buffer_load_dwordx4 v[28:31], v2, s[4:7], s33 offen offset:256
    s_lshr_b32 s31, s49, 1
    s_add_u32 s33, s31, s64
    buffer_load_dwordx4 a[252:255], v1, s[4:7], s33 offen
    s_add_u32 s33, s31, s65
    buffer_load_dwordx4 v[120:123], v1, s[4:7], s33 offen
    s_add_u32 s33, s31, s66
    buffer_load_dwordx4 v[124:127], v1, s[4:7], s33 offen
    s_add_u32 s33, s31, s67
    buffer_load_dwordx4 v[128:131], v1, s[4:7], s33 offen
    s_add_u32 s33, s31, s68
    buffer_load_dwordx4 v[132:135], v1, s[4:7], s33 offen
    s_add_u32 s33, s31, s69
    buffer_load_dwordx4 v[136:139], v1, s[4:7], s33 offen
    s_add_u32 s33, s31, s70
    buffer_load_dwordx4 v[140:143], v1, s[4:7], s33 offen
    s_waitcnt vmcnt(54)
    v_mfma_f32_16x16x32_bf16 v[64:67], v[32:35], a[84:87], v[64:67]
    v_mfma_f32_16x16x32_bf16 v[72:75], v[32:35], a[88:91], v[72:75]
    v_mfma_f32_16x16x32_bf16 v[80:83], v[32:35], a[92:95], v[80:83]
    v_mfma_f32_16x16x32_bf16 v[88:91], v[32:35], a[96:99], v[88:91]
    v_mfma_f32_16x16x32_bf16 v[96:99], v[32:35], a[100:103], v[96:99]
    v_mfma_f32_16x16x32_bf16 v[104:107], v[32:35], a[104:107], v[104:107]
    v_mfma_f32_16x16x32_bf16 v[112:115], v[32:35], a[108:111], v[112:115]
    v_mfma_f32_16x16x32_bf16 v[68:71], v[36:39], a[84:87], v[68:71]
    v_mfma_f32_16x16x32_bf16 v[76:79], v[36:39], a[88:91], v[76:79]
    v_mfma_f32_16x16x32_bf16 v[84:87], v[36:39], a[92:95], v[84:87]
    v_mfma_f32_16x16x32_bf16 v[92:95], v[36:39], a[96:99], v[92:95]
    v_mfma_f32_16x16x32_bf16 v[100:103], v[36:39], a[100:103], v[100:103]
    v_mfma_f32_16x16x32_bf16 v[108:111], v[36:39], a[104:107], v[108:111]
    v_mfma_f32_16x16x32_bf16 v[116:119], v[36:39], a[108:111], v[116:119]
    s_add_u32 s33, s23, s50
    buffer_load_dwordx4 v[32:35], v2, s[4:7], s33 offen offset:0
    buffer_load_dwordx4 v[36:39], v2, s[4:7], s33 offen offset:256
    s_lshr_b32 s31, s50, 1
    s_add_u32 s33, s31, s64
    buffer_load_dwordx4 v[144:147], v1, s[4:7], s33 offen
    s_add_u32 s33, s31, s65
    buffer_load_dwordx4 v[148:151], v1, s[4:7], s33 offen
    s_add_u32 s33, s31, s66
    buffer_load_dwordx4 v[152:155], v1, s[4:7], s33 offen
    s_add_u32 s33, s31, s67
    buffer_load_dwordx4 v[156:159], v1, s[4:7], s33 offen
    s_add_u32 s33, s31, s68
    buffer_load_dwordx4 v[160:163], v1, s[4:7], s33 offen
    s_add_u32 s33, s31, s69
    buffer_load_dwordx4 v[164:167], v1, s[4:7], s33 offen
    s_add_u32 s33, s31, s70
    buffer_load_dwordx4 v[168:171], v1, s[4:7], s33 offen
    s_waitcnt vmcnt(54)
    v_mfma_f32_16x16x32_bf16 v[64:67], v[40:43], a[112:115], v[64:67]
    v_mfma_f32_16x16x32_bf16 v[72:75], v[40:43], a[116:119], v[72:75]
    v_mfma_f32_16x16x32_bf16 v[80:83], v[40:43], a[120:123], v[80:83]
    v_mfma_f32_16x16x32_bf16 v[88:91], v[40:43], a[124:127], v[88:91]
    v_mfma_f32_16x16x32_bf16 v[96:99], v[40:43], a[128:131], v[96:99]
    v_mfma_f32_16x16x32_bf16 v[104:107], v[40:43], a[132:135], v[104:107]
    v_mfma_f32_16x16x32_bf16 v[112:115], v[40:43], a[136:139], v[112:115]
    v_mfma_f32_16x16x32_bf16 v[68:71], v[44:47], a[112:115], v[68:71]
    v_mfma_f32_16x16x32_bf16 v[76:79], v[44:47], a[116:119], v[76:79]
    v_mfma_f32_16x16x32_bf16 v[84:87], v[44:47], a[120:123], v[84:87]
    v_mfma_f32_16x16x32_bf16 v[92:95], v[44:47], a[124:127], v[92:95]
    v_mfma_f32_16x16x32_bf16 v[100:103], v[44:47], a[128:131], v[100:103]
    v_mfma_f32_16x16x32_bf16 v[108:111], v[44:47], a[132:135], v[108:111]
    v_mfma_f32_16x16x32_bf16 v[116:119], v[44:47], a[136:139], v[116:119]
    s_add_u32 s33, s23, s51
    buffer_load_dwordx4 v[40:43], v2, s[4:7], s33 offen offset:0
    buffer_load_dwordx4 v[44:47], v2, s[4:7], s33 offen offset:256
    s_lshr_b32 s31, s51, 1
    s_add_u32 s33, s31, s64
    buffer_load_dwordx4 v[172:175], v1, s[4:7], s33 offen
    s_add_u32 s33, s31, s65
    buffer_load_dwordx4 v[176:179], v1, s[4:7], s33 offen
    s_add_u32 s33, s31, s66
    buffer_load_dwordx4 v[180:183], v1, s[4:7], s33 offen
    s_add_u32 s33, s31, s67
    buffer_load_dwordx4 v[184:187], v1, s[4:7], s33 offen
    s_add_u32 s33, s31, s68
    buffer_load_dwordx4 v[188:191], v1, s[4:7], s33 offen
    s_add_u32 s33, s31, s69
    buffer_load_dwordx4 v[192:195], v1, s[4:7], s33 offen
    s_add_u32 s33, s31, s70
    buffer_load_dwordx4 v[196:199], v1, s[4:7], s33 offen
    s_waitcnt vmcnt(54)
    v_mfma_f32_16x16x32_bf16 v[64:67], v[48:51], a[140:143], v[64:67]
    v_mfma_f32_16x16x32_bf16 v[72:75], v[48:51], a[144:147], v[72:75]
    v_mfma_f32_16x16x32_bf16 v[80:83], v[48:51], a[148:151], v[80:83]
    v_mfma_f32_16x16x32_bf16 v[88:91], v[48:51], a[152:155], v[88:91]
    v_mfma_f32_16x16x32_bf16 v[96:99], v[48:51], a[156:159], v[96:99]
    v_mfma_f32_16x16x32_bf16 v[104:107], v[48:51], a[160:163], v[104:107]
    v_mfma_f32_16x16x32_bf16 v[112:115], v[48:51], a[164:167], v[112:115]
    v_mfma_f32_16x16x32_bf16 v[68:71], v[52:55], a[140:143], v[68:71]
    v_mfma_f32_16x16x32_bf16 v[76:79], v[52:55], a[144:147], v[76:79]
    v_mfma_f32_16x16x32_bf16 v[84:87], v[52:55], a[148:151], v[84:87]
    v_mfma_f32_16x16x32_bf16 v[92:95], v[52:55], a[152:155], v[92:95]
    v_mfma_f32_16x16x32_bf16 v[100:103], v[52:55], a[156:159], v[100:103]
    v_mfma_f32_16x16x32_bf16 v[108:111], v[52:55], a[160:163], v[108:111]
    v_mfma_f32_16x16x32_bf16 v[116:119], v[52:55], a[164:167], v[116:119]
    s_add_u32 s33, s23, s52
    buffer_load_dwordx4 v[48:51], v2, s[4:7], s33 offen offset:0
    buffer_load_dwordx4 v[52:55], v2, s[4:7], s33 offen offset:256
    s_lshr_b32 s31, s52, 1
    s_add_u32 s33, s31, s64
    buffer_load_dwordx4 v[200:203], v1, s[4:7], s33 offen
    s_add_u32 s33, s31, s65
    buffer_load_dwordx4 v[204:207], v1, s[4:7], s33 offen
    s_add_u32 s33, s31, s66
    buffer_load_dwordx4 v[208:211], v1, s[4:7], s33 offen
    s_add_u32 s33, s31, s67
    buffer_load_dwordx4 v[212:215], v1, s[4:7], s33 offen
    s_add_u32 s33, s31, s68
    buffer_load_dwordx4 v[216:219], v1, s[4:7], s33 offen
    s_add_u32 s33, s31, s69
    buffer_load_dwordx4 v[220:223], v1, s[4:7], s33 offen
    s_add_u32 s33, s31, s70
    buffer_load_dwordx4 v[224:227], v1, s[4:7], s33 offen
    s_waitcnt vmcnt(54)
    v_mfma_f32_16x16x32_bf16 v[64:67], v[56:59], a[168:171], v[64:67]
    v_mfma_f32_16x16x32_bf16 v[72:75], v[56:59], a[172:175], v[72:75]
    v_mfma_f32_16x16x32_bf16 v[80:83], v[56:59], a[176:179], v[80:83]
    v_mfma_f32_16x16x32_bf16 v[88:91], v[56:59], a[180:183], v[88:91]
    v_mfma_f32_16x16x32_bf16 v[96:99], v[56:59], a[184:187], v[96:99]
    v_mfma_f32_16x16x32_bf16 v[104:107], v[56:59], a[188:191], v[104:107]
    v_mfma_f32_16x16x32_bf16 v[112:115], v[56:59], a[192:195], v[112:115]
    v_mfma_f32_16x16x32_bf16 v[68:71], v[60:63], a[168:171], v[68:71]
    v_mfma_f32_16x16x32_bf16 v[76:79], v[60:63], a[172:175], v[76:79]
    v_mfma_f32_16x16x32_bf16 v[84:87], v[60:63], a[176:179], v[84:87]
    v_mfma_f32_16x16x32_bf16 v[92:95], v[60:63], a[180:183], v[92:95]
    v_mfma_f32_16x16x32_bf16 v[100:103], v[60:63], a[184:187], v[100:103]
    v_mfma_f32_16x16x32_bf16 v[108:111], v[60:63], a[188:191], v[108:111]
    v_mfma_f32_16x16x32_bf16 v[116:119], v[60:63], a[192:195], v[116:119]
    s_add_u32 s33, s23, s53
    buffer_load_dwordx4 v[56:59], v2, s[4:7], s33 offen offset:0
    buffer_load_dwordx4 v[60:63], v2, s[4:7], s33 offen offset:256
    s_lshr_b32 s31, s53, 1
    s_add_u32 s33, s31, s64
    buffer_load_dwordx4 v[228:231], v1, s[4:7], s33 offen
    s_add_u32 s33, s31, s65
    buffer_load_dwordx4 v[232:235], v1, s[4:7], s33 offen
    s_add_u32 s33, s31, s66
    buffer_load_dwordx4 v[236:239], v1, s[4:7], s33 offen
    s_add_u32 s33, s31, s67
    buffer_load_dwordx4 v[240:243], v1, s[4:7], s33 offen
    s_add_u32 s33, s31, s68
    buffer_load_dwordx4 v[244:247], v1, s[4:7], s33 offen
    s_add_u32 s33, s31, s69
    buffer_load_dwordx4 v[248:251], v1, s[4:7], s33 offen
    s_add_u32 s33, s31, s70
    buffer_load_dwordx4 v[252:255], v1, s[4:7], s33 offen
    s_waitcnt vmcnt(54)
    v_mfma_f32_16x16x32_bf16 v[64:67], v[8:11], a[196:199], v[64:67]
    v_mfma_f32_16x16x32_bf16 v[72:75], v[8:11], a[200:203], v[72:75]
    v_mfma_f32_16x16x32_bf16 v[80:83], v[8:11], a[204:207], v[80:83]
    v_mfma_f32_16x16x32_bf16 v[88:91], v[8:11], a[208:211], v[88:91]
    v_mfma_f32_16x16x32_bf16 v[96:99], v[8:11], a[212:215], v[96:99]
    v_mfma_f32_16x16x32_bf16 v[104:107], v[8:11], a[216:219], v[104:107]
    v_mfma_f32_16x16x32_bf16 v[112:115], v[8:11], a[220:223], v[112:115]
    v_mfma_f32_16x16x32_bf16 v[68:71], v[12:15], a[196:199], v[68:71]
    v_mfma_f32_16x16x32_bf16 v[76:79], v[12:15], a[200:203], v[76:79]
    v_mfma_f32_16x16x32_bf16 v[84:87], v[12:15], a[204:207], v[84:87]
    v_mfma_f32_16x16x32_bf16 v[92:95], v[12:15], a[208:211], v[92:95]
    v_mfma_f32_16x16x32_bf16 v[100:103], v[12:15], a[212:215], v[100:103]
    v_mfma_f32_16x16x32_bf16 v[108:111], v[12:15], a[216:219], v[108:111]
    v_mfma_f32_16x16x32_bf16 v[116:119], v[12:15], a[220:223], v[116:119]
    s_waitcnt vmcnt(45)
    v_mfma_f32_16x16x32_bf16 v[64:67], v[16:19], a[224:227], v[64:67]
    v_mfma_f32_16x16x32_bf16 v[72:75], v[16:19], a[228:231], v[72:75]
    v_mfma_f32_16x16x32_bf16 v[80:83], v[16:19], a[232:235], v[80:83]
    v_mfma_f32_16x16x32_bf16 v[88:91], v[16:19], a[236:239], v[88:91]
    v_mfma_f32_16x16x32_bf16 v[96:99], v[16:19], a[240:243], v[96:99]
    v_mfma_f32_16x16x32_bf16 v[104:107], v[16:19], a[244:247], v[104:107]
    v_mfma_f32_16x16x32_bf16 v[112:115], v[16:19], a[248:251], v[112:115]
    v_mfma_f32_16x16x32_bf16 v[68:71], v[20:23], a[224:227], v[68:71]
    v_mfma_f32_16x16x32_bf16 v[76:79], v[20:23], a[228:231], v[76:79]
    v_mfma_f32_16x16x32_bf16 v[84:87], v[20:23], a[232:235], v[84:87]
    v_mfma_f32_16x16x32_bf16 v[92:95], v[20:23], a[236:239], v[92:95]
    v_mfma_f32_16x16x32_bf16 v[100:103], v[20:23], a[240:243], v[100:103]
    v_mfma_f32_16x16x32_bf16 v[108:111], v[20:23], a[244:247], v[108:111]
    v_mfma_f32_16x16x32_bf16 v[116:119], v[20:23], a[248:251], v[116:119]
    s_waitcnt vmcnt(36)
    v_mfma_f32_16x16x32_bf16 v[64:67], v[24:27], a[252:255], v[64:67]
    v_mfma_f32_16x16x32_bf16 v[72:75], v[24:27], v[120:123], v[72:75]
    v_mfma_f32_16x16x32_bf16 v[80:83], v[24:27], v[124:127], v[80:83]
    v_mfma_f32_16x16x32_bf16 v[88:91], v[24:27], v[128:131], v[88:91]
    v_mfma_f32_16x16x32_bf16 v[96:99], v[24:27], v[132:135], v[96:99]
    v_mfma_f32_16x16x32_bf16 v[104:107], v[24:27], v[136:139], v[104:107]
    v_mfma_f32_16x16x32_bf16 v[112:115], v[24:27], v[140:143], v[112:115]
    v_mfma_f32_16x16x32_bf16 v[68:71], v[28:31], a[252:255], v[68:71]
    v_mfma_f32_16x16x32_bf16 v[76:79], v[28:31], v[120:123], v[76:79]
    v_mfma_f32_16x16x32_bf16 v[84:87], v[28:31], v[124:127], v[84:87]
    v_mfma_f32_16x16x32_bf16 v[92:95], v[28:31], v[128:131], v[92:95]
    v_mfma_f32_16x16x32_bf16 v[100:103], v[28:31], v[132:135], v[100:103]
    v_mfma_f32_16x16x32_bf16 v[108:111], v[28:31], v[136:139], v[108:111]
    v_mfma_f32_16x16x32_bf16 v[116:119], v[28:31], v[140:143], v[116:119]
    s_waitcnt vmcnt(27)
    v_mfma_f32_16x16x32_bf16 v[64:67], v[32:35], v[144:147], v[64:67]
    v_mfma_f32_16x16x32_bf16 v[72:75], v[32:35], v[148:151], v[72:75]
    v_mfma_f32_16x16x32_bf16 v[80:83], v[32:35], v[152:155], v[80:83]
    v_mfma_f32_16x16x32_bf16 v[88:91], v[32:35], v[156:159], v[88:91]
    v_mfma_f32_16x16x32_bf16 v[96:99], v[32:35], v[160:163], v[96:99]
    v_mfma_f32_16x16x32_bf16 v[104:107], v[32:35], v[164:167], v[104:107]
    v_mfma_f32_16x16x32_bf16 v[112:115], v[32:35], v[168:171], v[112:115]
    v_mfma_f32_16x16x32_bf16 v[68:71], v[36:39], v[144:147], v[68:71]
    v_mfma_f32_16x16x32_bf16 v[76:79], v[36:39], v[148:151], v[76:79]
    v_mfma_f32_16x16x32_bf16 v[84:87], v[36:39], v[152:155], v[84:87]
    v_mfma_f32_16x16x32_bf16 v[92:95], v[36:39], v[156:159], v[92:95]
    v_mfma_f32_16x16x32_bf16 v[100:103], v[36:39], v[160:163], v[100:103]
    v_mfma_f32_16x16x32_bf16 v[108:111], v[36:39], v[164:167], v[108:111]
    v_mfma_f32_16x16x32_bf16 v[116:119], v[36:39], v[168:171], v[116:119]
    s_waitcnt vmcnt(18)
    v_mfma_f32_16x16x32_bf16 v[64:67], v[40:43], v[172:175], v[64:67]
    v_mfma_f32_16x16x32_bf16 v[72:75], v[40:43], v[176:179], v[72:75]
    v_mfma_f32_16x16x32_bf16 v[80:83], v[40:43], v[180:183], v[80:83]
    v_mfma_f32_16x16x32_bf16 v[88:91], v[40:43], v[184:187], v[88:91]
    v_mfma_f32_16x16x32_bf16 v[96:99], v[40:43], v[188:191], v[96:99]
    v_mfma_f32_16x16x32_bf16 v[104:107], v[40:43], v[192:195], v[104:107]
    v_mfma_f32_16x16x32_bf16 v[112:115], v[40:43], v[196:199], v[112:115]
    v_mfma_f32_16x16x32_bf16 v[68:71], v[44:47], v[172:175], v[68:71]
    v_mfma_f32_16x16x32_bf16 v[76:79], v[44:47], v[176:179], v[76:79]
    v_mfma_f32_16x16x32_bf16 v[84:87], v[44:47], v[180:183], v[84:87]
    v_mfma_f32_16x16x32_bf16 v[92:95], v[44:47], v[184:187], v[92:95]
    v_mfma_f32_16x16x32_bf16 v[100:103], v[44:47], v[188:191], v[100:103]
    v_mfma_f32_16x16x32_bf16 v[108:111], v[44:47], v[192:195], v[108:111]
    v_mfma_f32_16x16x32_bf16 v[116:119], v[44:47], v[196:199], v[116:119]
    s_waitcnt vmcnt(9)
    v_mfma_f32_16x16x32_bf16 v[64:67], v[48:51], v[200:203], v[64:67]
    v_mfma_f32_16x16x32_bf16 v[72:75], v[48:51], v[204:207], v[72:75]
    v_mfma_f32_16x16x32_bf16 v[80:83], v[48:51], v[208:211], v[80:83]
    v_mfma_f32_16x16x32_bf16 v[88:91], v[48:51], v[212:215], v[88:91]
    v_mfma_f32_16x16x32_bf16 v[96:99], v[48:51], v[216:219], v[96:99]
    v_mfma_f32_16x16x32_bf16 v[104:107], v[48:51], v[220:223], v[104:107]
    v_mfma_f32_16x16x32_bf16 v[112:115], v[48:51], v[224:227], v[112:115]
    v_mfma_f32_16x16x32_bf16 v[68:71], v[52:55], v[200:203], v[68:71]
    v_mfma_f32_16x16x32_bf16 v[76:79], v[52:55], v[204:207], v[76:79]
    v_mfma_f32_16x16x32_bf16 v[84:87], v[52:55], v[208:211], v[84:87]
    v_mfma_f32_16x16x32_bf16 v[92:95], v[52:55], v[212:215], v[92:95]
    v_mfma_f32_16x16x32_bf16 v[100:103], v[52:55], v[216:219], v[100:103]
    v_mfma_f32_16x16x32_bf16 v[108:111], v[52:55], v[220:223], v[108:111]
    v_mfma_f32_16x16x32_bf16 v[116:119], v[52:55], v[224:227], v[116:119]
    s_waitcnt vmcnt(0)
    v_mfma_f32_16x16x32_bf16 v[64:67], v[56:59], v[228:231], v[64:67]
    v_mfma_f32_16x16x32_bf16 v[72:75], v[56:59], v[232:235], v[72:75]
    v_mfma_f32_16x16x32_bf16 v[80:83], v[56:59], v[236:239], v[80:83]
    v_mfma_f32_16x16x32_bf16 v[88:91], v[56:59], v[240:243], v[88:91]
    v_mfma_f32_16x16x32_bf16 v[96:99], v[56:59], v[244:247], v[96:99]
    v_mfma_f32_16x16x32_bf16 v[104:107], v[56:59], v[248:251], v[104:107]
    v_mfma_f32_16x16x32_bf16 v[112:115], v[56:59], v[252:255], v[112:115]
    v_mfma_f32_16x16x32_bf16 v[68:71], v[60:63], v[228:231], v[68:71]
    v_mfma_f32_16x16x32_bf16 v[76:79], v[60:63], v[232:235], v[76:79]
    v_mfma_f32_16x16x32_bf16 v[84:87], v[60:63], v[236:239], v[84:87]
    v_mfma_f32_16x16x32_bf16 v[92:95], v[60:63], v[240:243], v[92:95]
    v_mfma_f32_16x16x32_bf16 v[100:103], v[60:63], v[244:247], v[100:103]
    v_mfma_f32_16x16x32_bf16 v[108:111], v[60:63], v[248:251], v[108:111]
    v_mfma_f32_16x16x32_bf16 v[116:119], v[60:63], v[252:255], v[116:119]
    s_branch V_epi
V_loop:
    s_cmp_lt_u32 s21, 8
    s_cbranch_scc0 V_go
    v_and_b32 v8, 1, v0
    v_lshlrev_b32 v8, 4, v8
    v_lshrrev_b32 v12, 1, v0
    v_lshl_add_u32 v12, v12, 7, v8
    v_add_u32 v12, 69828608, v12
    s_cmp_eq_u32 s16, 0
    s_cbranch_scc0 wad_17
wa_16:
    buffer_load_dwordx4 v[8:11], v12, s[4:7], 0 offen sc1
    s_waitcnt vmcnt(0)
    v_min3_u32 v8, v8, v9, v10
    v_min_u32 v8, v8, v11
    v_cmp_eq_u32 vcc, 0, v8
    s_cbranch_vccz wad_17
    s_sub_u32 s18, s18, 1
    s_cbranch_scc1 main_end2
    s_sleep 4
    s_branch wa_16
wad_17:
    s_waitcnt vmcnt(0)
    s_barrier
V_go:
    s_mul_i32 s23, s21, 28672
    s_add_u32 s23, s23, 16056320
    s_add_u32 s33, s23, s40
    buffer_load_dwordx4 v[32:35], v2, s[4:7], s33 offen offset:0
    s_add_u32 s33, s23, s40
    buffer_load_dwordx4 v[36:39], v2, s[4:7], s33 offen offset:256
    s_add_u32 s33, s23, s41
    buffer_load_dwordx4 v[40:43], v2, s[4:7], s33 offen offset:0
    s_add_u32 s33, s23, s41
    buffer_load_dwordx4 v[44:47], v2, s[4:7], s33 offen offset:256
    s_add_u32 s33, s23, s42
    buffer_load_dwordx4 v[48:51], v2, s[4:7], s33 offen offset:0
    s_add_u32 s33, s23, s42
    buffer_load_dwordx4 v[52:55], v2, s[4:7], s33 offen offset:256
    s_add_u32 s33, s23, s43
    buffer_load_dwordx4 v[56:59], v2, s[4:7], s33 offen offset:0
    s_add_u32 s33, s23, s43
    buffer_load_dwordx4 v[60:63], v2, s[4:7], s33 offen offset:256
    s_waitcnt vmcnt(7)
    v_mfma_f32_16x16x32_bf16 v[64:67], v[32:35], a[0:3], 0
    v_mfma_f32_16x16x32_bf16 v[72:75], v[32:35], a[4:7], 0
    v_mfma_f32_16x16x32_bf16 v[80:83], v[32:35], a[8:11], 0
    v_mfma_f32_16x16x32_bf16 v[88:91], v[32:35], a[12:15], 0
    v_mfma_f32_16x16x32_bf16 v[96:99], v[32:35], a[16:19], 0
    v_mfma_f32_16x16x32_bf16 v[104:107], v[32:35], a[20:23], 0
    v_mfma_f32_16x16x32_bf16 v[112:115], v[32:35], a[24:27], 0
    s_add_u32 s33, s23, s44
    buffer_load_dwordx4 v[32:35], v2, s[4:7], s33 offen offset:0
    s_waitcnt vmcnt(7)
    v_mfma_f32_16x16x32_bf16 v[68:71], v[36:39], a[0:3], 0
    v_mfma_f32_16x16x32_bf16 v[76:79], v[36:39], a[4:7], 0
    v_mfma_f32_16x16x32_bf16 v[84:87], v[36:39], a[8:11], 0
    v_mfma_f32_16x16x32_bf16 v[92:95], v[36:39], a[12:15], 0
    v_mfma_f32_16x16x32_bf16 v[100:103], v[36:39], a[16:19], 0
    v_mfma_f32_16x16x32_bf16 v[108:111], v[36:39], a[20:23], 0
    v_mfma_f32_16x16x32_bf16 v[116:119], v[36:39], a[24:27], 0
    s_add_u32 s33, s23, s44
    buffer_load_dwordx4 v[36:39], v2, s[4:7], s33 offen offset:256
    s_waitcnt vmcnt(7)
    v_mfma_f32_16x16x32_bf16 v[64:67], v[40:43], a[28:31], v[64:67]
    v_mfma_f32_16x16x32_bf16 v[72:75], v[40:43], a[32:35], v[72:75]
    v_mfma_f32_16x16x32_bf16 v[80:83], v[40:43], a[36:39], v[80:83]
    v_mfma_f32_16x16x32_bf16 v[88:91], v[40:43], a[40:43], v[88:91]
    v_mfma_f32_16x16x32_bf16 v[96:99], v[40:43], a[44:47], v[96:99]
    v_mfma_f32_16x16x32_bf16 v[104:107], v[40:43], a[48:51], v[104:107]
    v_mfma_f32_16x16x32_bf16 v[112:115], v[40:43], a[52:55], v[112:115]
    s_add_u32 s33, s23, s45
    buffer_load_dwordx4 v[40:43], v2, s[4:7], s33 offen offset:0
    s_waitcnt vmcnt(7)
    v_mfma_f32_16x16x32_bf16 v[68:71], v[44:47], a[28:31], v[68:71]
    v_mfma_f32_16x16x32_bf16 v[76:79], v[44:47], a[32:35], v[76:79]
    v_mfma_f32_16x16x32_bf16 v[84:87], v[44:47], a[36:39], v[84:87]
    v_mfma_f32_16x16x32_bf16 v[92:95], v[44:47], a[40:43], v[92:95]
    v_mfma_f32_16x16x32_bf16 v[100:103], v[44:47], a[44:47], v[100:103]
    v_mfma_f32_16x16x32_bf16 v[108:111], v[44:47], a[48:51], v[108:111]
    v_mfma_f32_16x16x32_bf16 v[116:119], v[44:47], a[52:55], v[116:119]
    s_add_u32 s33, s23, s45
    buffer_load_dwordx4 v[44:47], v2, s[4:7], s33 offen offset:256
    s_waitcnt vmcnt(7)
    v_mfma_f32_16x16x32_bf16 v[64:67], v[48:51], a[56:59], v[64:67]
    v_mfma_f32_16x16x32_bf16 v[72:75], v[48:51], a[60:63], v[72:75]
    v_mfma_f32_16x16x32_bf16 v[80:83], v[48:51], a[64:67], v[80:83]
    v_mfma_f32_16x16x32_bf16 v[88:91], v[48:51], a[68:71], v[88:91]
    v_mfma_f32_16x16x32_bf16 v[96:99], v[48:51], a[72:75], v[96:99]
    v_mfma_f32_16x16x32_bf16 v[104:107], v[48:51], a[76:79], v[104:107]
    v_mfma_f32_16x16x32_bf16 v[112:115], v[48:51], a[80:83], v[112:115]
    s_add_u32 s33, s23, s46
    buffer_load_dwordx4 v[48:51], v2, s[4:7], s33 offen offset:0
    s_waitcnt vmcnt(7)
    v_mfma_f32_16x16x32_bf16 v[68:71], v[52:55], a[56:59], v[68:71]
    v_mfma_f32_16x16x32_bf16 v[76:79], v[52:55], a[60:63], v[76:79]
    v_mfma_f32_16x16x32_bf16 v[84:87], v[52:55], a[64:67], v[84:87]
    v_mfma_f32_16x16x32_bf16 v[92:95], v[52:55], a[68:71], v[92:95]
    v_mfma_f32_16x16x32_bf16 v[100:103], v[52:55], a[72:75], v[100:103]
    v_mfma_f32_16x16x32_bf16 v[108:111], v[52:55], a[76:79], v[108:111]
    v_mfma_f32_16x16x32_bf16 v[116:119], v[52:55], a[80:83], v[116:119]
    s_add_u32 s33, s23, s46
    buffer_load_dwordx4 v[52:55], v2, s[4:7], s33 offen offset:256
    s_waitcnt vmcnt(7)
    v_mfma_f32_16x16x32_bf16 v[64:67], v[56:59], a[84:87], v[64:67]
    v_mfma_f32_16x16x32_bf16 v[72:75], v[56:59], a[88:91], v[72:75]
    v_mfma_f32_16x16x32_bf16 v[80:83], v[56:59], a[92:95], v[80:83]
    v_mfma_f32_16x16x32_bf16 v[88:91], v[56:59], a[96:99], v[88:91]
    v_mfma_f32_16x16x32_bf16 v[96:99], v[56:59], a[100:103], v[96:99]
    v_mfma_f32_16x16x32_bf16 v[104:107], v[56:59], a[104:107], v[104:107]
    v_mfma_f32_16x16x32_bf16 v[112:115], v[56:59], a[108:111], v[112:115]
    s_add_u32 s33, s23, s47
    buffer_load_dwordx4 v[56:59], v2, s[4:7], s33 offen offset:0
    s_waitcnt vmcnt(7)
    v_mfma_f32_16x16x32_bf16 v[68:71], v[60:63], a[84:87], v[68:71]
    v_mfma_f32_16x16x32_bf16 v[76:79], v[60:63], a[88:91], v[76:79]
    v_mfma_f32_16x16x32_bf16 v[84:87], v[60:63], a[92:95], v[84:87]
    v_mfma_f32_16x16x32_bf16 v[92:95], v[60:63], a[96:99], v[92:95]
    v_mfma_f32_16x16x32_bf16 v[100:103], v[60:63], a[100:103], v[100:103]
    v_mfma_f32_16x16x32_bf16 v[108:111], v[60:63], a[104:107], v[108:111]
    v_mfma_f32_16x16x32_bf16 v[116:119], v[60:63], a[108:111], v[116:119]
    s_add_u32 s33, s23, s47
    buffer_load_dwordx4 v[60:63], v2, s[4:7], s33 offen offset:256
    s_waitcnt vmcnt(7)
    v_mfma_f32_16x16x32_bf16 v[64:67], v[32:35], a[112:115], v[64:67]
    v_mfma_f32_16x16x32_bf16 v[72:75], v[32:35], a[116:119], v[72:75]
    v_mfma_f32_16x16x32_bf16 v[80:83], v[32:35], a[120:123], v[80:83]
    v_mfma_f32_16x16x32_bf16 v[88:91], v[32:35], a[124:127], v[88:91]
    v_mfma_f32_16x16x32_bf16 v[96:99], v[32:35], a[128:131], v[96:99]
    v_mfma_f32_16x16x32_bf16 v[104:107], v[32:35], a[132:135], v[104:107]
    v_mfma_f32_16x16x32_bf16 v[112:115], v[32:35], a[136:139], v[112:115]
    s_add_u32 s33, s23, s48
    buffer_load_dwordx4 v[32:35], v2, s[4:7], s33 offen offset:0
    s_waitcnt vmcnt(7)
    v_mfma_f32_16x16x32_bf16 v[68:71], v[36:39], a[112:115], v[68:71]
    v_mfma_f32_16x16x32_bf16 v[76:79], v[36:39], a[116:119], v[76:79]
    v_mfma_f32_16x16x32_bf16 v[84:87], v[36:39], a[120:123], v[84:87]
    v_mfma_f32_16x16x32_bf16 v[92:95], v[36:39], a[124:127], v[92:95]
    v_mfma_f32_16x16x32_bf16 v[100:103], v[36:39], a[128:131], v[100:103]
    v_mfma_f32_16x16x32_bf16 v[108:111], v[36:39], a[132:135], v[108:111]
    v_mfma_f32_16x16x32_bf16 v[116:119], v[36:39], a[136:139], v[116:119]
    s_add_u32 s33, s23, s48
    buffer_load_dwordx4 v[36:39], v2, s[4:7], s33 offen offset:256
    s_waitcnt vmcnt(7)
    v_mfma_f32_16x16x32_bf16 v[64:67], v[40:43], a[140:143], v[64:67]
    v_mfma_f32_16x16x32_bf16 v[72:75], v[40:43], a[144:147], v[72:75]
    v_mfma_f32_16x16x32_bf16 v[80:83], v[40:43], a[148:151], v[80:83]
    v_mfma_f32_16x16x32_bf16 v[88:91], v[40:43], a[152:155], v[88:91]
    v_mfma_f32_16x16x32_bf16 v[96:99], v[40:43], a[156:159], v[96:99]
    v_mfma_f32_16x16x32_bf16 v[104:107], v[40:43], a[160:163], v[104:107]
    v_mfma_f32_16x16x32_bf16 v[112:115], v[40:43], a[164:167], v[112:115]
    s_add_u32 s33, s23, s49
    buffer_load_dwordx4 v[40:43], v2, s[4:7], s33 offen offset:0
    s_waitcnt vmcnt(7)
    v_mfma_f32_16x16x32_bf16 v[68:71], v[44:47], a[140:143], v[68:71]
    v_mfma_f32_16x16x32_bf16 v[76:79], v[44:47], a[144:147], v[76:79]
    v_mfma_f32_16x16x32_bf16 v[84:87], v[44:47], a[148:151], v[84:87]
    v_mfma_f32_16x16x32_bf16 v[92:95], v[44:47], a[152:155], v[92:95]
    v_mfma_f32_16x16x32_bf16 v[100:103], v[44:47], a[156:159], v[100:103]
    v_mfma_f32_16x16x32_bf16 v[108:111], v[44:47], a[160:163], v[108:111]
    v_mfma_f32_16x16x32_bf16 v[116:119], v[44:47], a[164:167], v[116:119]
    s_add_u32 s33, s23, s49
    buffer_load_dwordx4 v[44:47], v2, s[4:7], s33 offen offset:256
    s_waitcnt vmcnt(7)
    v_mfma_f32_16x16x32_bf16 v[64:67], v[48:51], a[168:171], v[64:67]
    v_mfma_f32_16x16x32_bf16 v[72:75], v[48:51], a[172:175], v[72:75]
    v_mfma_f32_16x16x32_bf16 v[80:83], v[48:51], a[176:179], v[80:83]
    v_mfma_f32_16x16x32_bf16 v[88:91], v[48:51], a[180:183], v[88:91]
    v_mfma_f32_16x16x32_bf16 v[96:99], v[48:51], a[184:187], v[96:99]
    v_mfma_f32_16x16x32_bf16 v[104:107], v[48:51], a[188:191], v[104:107]
    v_mfma_f32_16x16x32_bf16 v[112:115], v[48:51], a[192:195], v[112:115]
    s_add_u32 s33, s23, s50
    buffer_load_dwordx4 v[48:51], v2, s[4:7], s33 offen offset:0
    s_waitcnt vmcnt(7)
    v_mfma_f32_16x16x32_bf16 v[68:71], v[52:55], a[168:171], v[68:71]
    v_mfma_f32_16x16x32_bf16 v[76:79], v[52:55], a[172:175], v[76:79]
    v_mfma_f32_16x16x32_bf16 v[84:87], v[52:55], a[176:179], v[84:87]
    v_mfma_f32_16x16x32_bf16 v[92:95], v[52:55], a[180:183], v[92:95]
    v_mfma_f32_16x16x32_bf16 v[100:103], v[52:55], a[184:187], v[100:103]
    v_mfma_f32_16x16x32_bf16 v[108:111], v[52:55], a[188:191], v[108:111]
    v_mfma_f32_16x16x32_bf16 v[116:119], v[52:55], a[192:195], v[116:119]
    s_add_u32 s33, s23, s50
    buffer_load_dwordx4 v[52:55], v2, s[4:7], s33 offen offset:256
    s_waitcnt vmcnt(7)
    v_mfma_f32_16x16x32_bf16 v[64:67], v[56:59], a[196:199], v[64:67]
    v_mfma_f32_16x16x32_bf16 v[72:75], v[56:59], a[200:203], v[72:75]
    v_mfma_f32_16x16x32_bf16 v[80:83], v[56:59], a[204:207], v[80:83]
    v_mfma_f32_16x16x32_bf16 v[88:91], v[56:59], a[208:211], v[88:91]
    v_mfma_f32_16x16x32_bf16 v[96:99], v[56:59], a[212:215], v[96:99]
    v_mfma_f32_16x16x32_bf16 v[104:107], v[56:59], a[216:219], v[104:107]
    v_mfma_f32_16x16x32_bf16 v[112:115], v[56:59], a[220:223], v[112:115]
    s_add_u32 s33, s23, s51
    buffer_load_dwordx4 v[56:59], v2, s[4:7], s33 offen offset:0
    s_waitcnt vmcnt(7)
    v_mfma_f32_16x16x32_bf16 v[68:71], v[60:63], a[196:199], v[68:71]
    v_mfma_f32_16x16x32_bf16 v[76:79], v[60:63], a[200:203], v[76:79]
    v_mfma_f32_16x16x32_bf16 v[84:87], v[60:63], a[204:207], v[84:87]
    v_mfma_f32_16x16x32_bf16 v[92:95], v[60:63], a[208:211], v[92:95]
    v_mfma_f32_16x16x32_bf16 v[100:103], v[60:63], a[212:215], v[100:103]
    v_mfma_f32_16x16x32_bf16 v[108:111], v[60:63], a[216:219], v[108:111]
    v_mfma_f32_16x16x32_bf16 v[116:119], v[60:63], a[220:223], v[116:119]
    s_add_u32 s33, s23, s51
    buffer_load_dwordx4 v[60:63], v2, s[4:7], s33 offen offset:256
    s_waitcnt vmcnt(7)
    v_mfma_f32_16x16x32_bf16 v[64:67], v[32:35], a[224:227], v[64:67]
    v_mfma_f32_16x16x32_bf16 v[72:75], v[32:35], a[228:231], v[72:75]
    v_mfma_f32_16x16x32_bf16 v[80:83], v[32:35], a[232:235], v[80:83]
    v_mfma_f32_16x16x32_bf16 v[88:91], v[32:35], a[236:239], v[88:91]
    v_mfma_f32_16x16x32_bf16 v[96:99], v[32:35], a[240:243], v[96:99]
    v_mfma_f32_16x16x32_bf16 v[104:107], v[32:35], a[244:247], v[104:107]
    v_mfma_f32_16x16x32_bf16 v[112:115], v[32:35], a[248:251], v[112:115]
    s_add_u32 s33, s23, s52
    buffer_load_dwordx4 v[32:35], v2, s[4:7], s33 offen offset:0
    s_waitcnt vmcnt(7)
    v_mfma_f32_16x16x32_bf16 v[68:71], v[36:39], a[224:227], v[68:71]
    v_mfma_f32_16x16x32_bf16 v[76:79], v[36:39], a[228:231], v[76:79]
    v_mfma_f32_16x16x32_bf16 v[84:87], v[36:39], a[232:235], v[84:87]
    v_mfma_f32_16x16x32_bf16 v[92:95], v[36:39], a[236:239], v[92:95]
    v_mfma_f32_16x16x32_bf16 v[100:103], v[36:39], a[240:243], v[100:103]
    v_mfma_f32_16x16x32_bf16 v[108:111], v[36:39], a[244:247], v[108:111]
    v_mfma_f32_16x16x32_bf16 v[116:119], v[36:39], a[248:251], v[116:119]
    s_add_u32 s33, s23, s52
    buffer_load_dwordx4 v[36:39], v2, s[4:7], s33 offen offset:256
    s_waitcnt vmcnt(7)
    v_mfma_f32_16x16x32_bf16 v[64:67], v[40:43], a[252:255], v[64:67]
    v_mfma_f32_16x16x32_bf16 v[72:75], v[40:43], v[120:123], v[72:75]
    v_mfma_f32_16x16x32_bf16 v[80:83], v[40:43], v[124:127], v[80:83]
    v_mfma_f32_16x16x32_bf16 v[88:91], v[40:43], v[128:131], v[88:91]
    v_mfma_f32_16x16x32_bf16 v[96:99], v[40:43], v[132:135], v[96:99]
    v_mfma_f32_16x16x32_bf16 v[104:107], v[40:43], v[136:139], v[104:107]
    v_mfma_f32_16x16x32_bf16 v[112:115], v[40:43], v[140:143], v[112:115]
    s_add_u32 s33, s23, s53
    buffer_load_dwordx4 v[40:43], v2, s[4:7], s33 offen offset:0
    s_waitcnt vmcnt(7)
    v_mfma_f32_16x16x32_bf16 v[68:71], v[44:47], a[252:255], v[68:71]
    v_mfma_f32_16x16x32_bf16 v[76:79], v[44:47], v[120:123], v[76:79]
    v_mfma_f32_16x16x32_bf16 v[84:87], v[44:47], v[124:127], v[84:87]
    v_mfma_f32_16x16x32_bf16 v[92:95], v[44:47], v[128:131], v[92:95]
    v_mfma_f32_16x16x32_bf16 v[100:103], v[44:47], v[132:135], v[100:103]
    v_mfma_f32_16x16x32_bf16 v[108:111], v[44:47], v[136:139], v[108:111]
    v_mfma_f32_16x16x32_bf16 v[116:119], v[44:47], v[140:143], v[116:119]
    s_add_u32 s33, s23, s53
    buffer_load_dwordx4 v[44:47], v2, s[4:7], s33 offen offset:256
    s_waitcnt vmcnt(7)
    v_mfma_f32_16x16x32_bf16 v[64:67], v[48:51], v[144:147], v[64:67]
    v_mfma_f32_16x16x32_bf16 v[72:75], v[48:51], v[148:151], v[72:75]
    v_mfma_f32_16x16x32_bf16 v[80:83], v[48:51], v[152:155], v[80:83]
    v_mfma_f32_16x16x32_bf16 v[88:91], v[48:51], v[156:159], v[88:91]
    v_mfma_f32_16x16x32_bf16 v[96:99], v[48:51], v[160:163], v[96:99]
    v_mfma_f32_16x16x32_bf16 v[104:107], v[48:51], v[164:167], v[104:107]
    v_mfma_f32_16x16x32_bf16 v[112:115], v[48:51], v[168:171], v[112:115]
    s_waitcnt vmcnt(6)
    v_mfma_f32_16x16x32_bf16 v[68:71], v[52:55], v[144:147], v[68:71]
    v_mfma_f32_16x16x32_bf16 v[76:79], v[52:55], v[148:151], v[76:79]
    v_mfma_f32_16x16x32_bf16 v[84:87], v[52:55], v[152:155], v[84:87]
    v_mfma_f32_16x16x32_bf16 v[92:95], v[52:55], v[156:159], v[92:95]
    v_mfma_f32_16x16x32_bf16 v[100:103], v[52:55], v[160:163], v[100:103]
    v_mfma_f32_16x16x32_bf16 v[108:111], v[52:55], v[164:167], v[108:111]
    v_mfma_f32_16x16x32_bf16 v[116:119], v[52:55], v[168:171], v[116:119]
    s_waitcnt vmcnt(5)
    v_mfma_f32_16x16x32_bf16 v[64:67], v[56:59], v[172:175], v[64:67]
    v_mfma_f32_16x16x32_bf16 v[72:75], v[56:59], v[176:179], v[72:75]
    v_mfma_f32_16x16x32_bf16 v[80:83], v[56:59], v[180:183], v[80:83]
    v_mfma_f32_16x16x32_bf16 v[88:91], v[56:59], v[184:187], v[88:91]
    v_mfma_f32_16x16x32_bf16 v[96:99], v[56:59], v[188:191], v[96:99]
    v_mfma_f32_16x16x32_bf16 v[104:107], v[56:59], v[192:195], v[104:107]
    v_mfma_f32_16x16x32_bf16 v[112:115], v[56:59], v[196:199], v[112:115]
    s_waitcnt vmcnt(4)
    v_mfma_f32_16x16x32_bf16 v[68:71], v[60:63], v[172:175], v[68:71]
    v_mfma_f32_16x16x32_bf16 v[76:79], v[60:63], v[176:179], v[76:79]
    v_mfma_f32_16x16x32_bf16 v[84:87], v[60:63], v[180:183], v[84:87]
    v_mfma_f32_16x16x32_bf16 v[92:95], v[60:63], v[184:187], v[92:95]
    v_mfma_f32_16x16x32_bf16 v[100:103], v[60:63], v[188:191], v[100:103]
    v_mfma_f32_16x16x32_bf16 v[108:111], v[60:63], v[192:195], v[108:111]
    v_mfma_f32_16x16x32_bf16 v[116:119], v[60:63], v[196:199], v[116:119]
    s_waitcnt vmcnt(3)
    v_mfma_f32_16x16x32_bf16 v[64:67], v[32:35], v[200:203], v[64:67]
    v_mfma_f32_16x16x32_bf16 v[72:75], v[32:35], v[204:207], v[72:75]
    v_mfma_f32_16x16x32_bf16 v[80:83], v[32:35], v[208:211], v[80:83]
    v_mfma_f32_16x16x32_bf16 v[88:91], v[32:35], v[212:215], v[88:91]
    v_mfma_f32_16x16x32_bf16 v[96:99], v[32:35], v[216:219], v[96:99]
    v_mfma_f32_16x16x32_bf16 v[104:107], v[32:35], v[220:223], v[104:107]
    v_mfma_f32_16x16x32_bf16 v[112:115], v[32:35], v[224:227], v[112:115]
    s_waitcnt vmcnt(2)
    v_mfma_f32_16x16x32_bf16 v[68:71], v[36:39], v[200:203], v[68:71]
    v_mfma_f32_16x16x32_bf16 v[76:79], v[36:39], v[204:207], v[76:79]
    v_mfma_f32_16x16x32_bf16 v[84:87], v[36:39], v[208:211], v[84:87]
    v_mfma_f32_16x16x32_bf16 v[92:95], v[36:39], v[212:215], v[92:95]
    v_mfma_f32_16x16x32_bf16 v[100:103], v[36:39], v[216:219], v[100:103]
    v_mfma_f32_16x16x32_bf16 v[108:111], v[36:39], v[220:223], v[108:111]
    v_mfma_f32_16x16x32_bf16 v[116:119], v[36:39], v[224:227], v[116:119]
    s_waitcnt vmcnt(1)
    v_mfma_f32_16x16x32_bf16 v[64:67], v[40:43], v[228:231], v[64:67]
    v_mfma_f32_16x16x32_bf16 v[72:75], v[40:43], v[232:235], v[72:75]
    v_mfma_f32_16x16x32_bf16 v[80:83], v[40:43], v[236:239], v[80:83]
    v_mfma_f32_16x16x32_bf16 v[88:91], v[40:43], v[240:243], v[88:91]
    v_mfma_f32_16x16x32_bf16 v[96:99], v[40:43], v[244:247], v[96:99]
    v_mfma_f32_16x16x32_bf16 v[104:107], v[40:43], v[248:251], v[104:107]
    v_mfma_f32_16x16x32_bf16 v[112:115], v[40:43], v[252:255], v[112:115]
    s_waitcnt vmcnt(0)
    v_mfma_f32_16x16x32_bf16 v[68:71], v[44:47], v[228:231], v[68:71]
    v_mfma_f32_16x16x32_bf16 v[76:79], v[44:47], v[232:235], v[76:79]
    v_mfma_f32_16x16x32_bf16 v[84:87], v[44:47], v[236:239], v[84:87]
    v_mfma_f32_16x16x32_bf16 v[92:95], v[44:47], v[240:243], v[92:95]
    v_mfma_f32_16x16x32_bf16 v[100:103], v[44:47], v[244:247], v[100:103]
    v_mfma_f32_16x16x32_bf16 v[108:111], v[44:47], v[248:251], v[108:111]
    v_mfma_f32_16x16x32_bf16 v[116:119], v[44:47], v[252:255], v[116:119]
V_epi:
    s_lshl_b32 s24, s21, 4
    s_add_u32 s24, s24, s22
    s_lshl_b32 s25, s24, 2
    s_add_u32 s25, s25, 69812224
    s_mul_i32 s24, s24, 28672
    s_add_u32 s24, s24, 19726336
    s_mul_i32 s33, s16, 7168
    s_add_u32 s24, s24, s33
    v_cvt_pk_bf16_f32 v64, v64, v65
    v_cvt_pk_bf16_f32 v65, v66, v67
    v_cvt_pk_bf16_f32 v66, v68, v69
    v_cvt_pk_bf16_f32 v67, v70, v71
    buffer_store_dwordx4 v[64:67], v1, s[4:7], s24 offen offset:0 sc1
    v_cvt_pk_bf16_f32 v72, v72, v73
    v_cvt_pk_bf16_f32 v73, v74, v75
    v_cvt_pk_bf16_f32 v74, v76, v77
    v_cvt_pk_bf16_f32 v75, v78, v79
    buffer_store_dwordx4 v[72:75], v1, s[4:7], s24 offen offset:1024 sc1
    v_cvt_pk_bf16_f32 v80, v80, v81
    v_cvt_pk_bf16_f32 v81, v82, v83
    v_cvt_pk_bf16_f32 v82, v84, v85
    v_cvt_pk_bf16_f32 v83, v86, v87
    buffer_store_dwordx4 v[80:83], v1, s[4:7], s24 offen offset:2048 sc1
    v_cvt_pk_bf16_f32 v88, v88, v89
    v_cvt_pk_bf16_f32 v89, v90, v91
    v_cvt_pk_bf16_f32 v90, v92, v93
    v_cvt_pk_bf16_f32 v91, v94, v95
    buffer_store_dwordx4 v[88:91], v1, s[4:7], s24 offen offset:3072 sc1
    v_cvt_pk_bf16_f32 v96, v96, v97
    v_cvt_pk_bf16_f32 v97, v98, v99
    v_cvt_pk_bf16_f32 v98, v100, v101
    v_cvt_pk_bf16_f32 v99, v102, v103
    s_add_u32 s24, s24, 4096
    buffer_store_dwordx4 v[96:99], v1, s[4:7], s24 offen offset:0 sc1
    v_cvt_pk_bf16_f32 v104, v104, v105
    v_cvt_pk_bf16_f32 v105, v106, v107
    v_cvt_pk_bf16_f32 v106, v108, v109
    v_cvt_pk_bf16_f32 v107, v110, v111
    buffer_store_dwordx4 v[104:107], v1, s[4:7], s24 offen offset:1024 sc1
    v_cvt_pk_bf16_f32 v112, v112, v113
    v_cvt_pk_bf16_f32 v113, v114, v115
    v_cvt_pk_bf16_f32 v114, v116, v117
    v_cvt_pk_bf16_f32 v115, v118, v119
    buffer_store_dwordx4 v[112:115], v1, s[4:7], s24 offen offset:2048 sc1
    s_waitcnt vmcnt(0)
    s_barrier
    s_cmp_eq_u32 s16, 0
    s_cbranch_scc0 noflag_18
    v_mov_b32 v5, 1
    v_mov_b32 v6, 0
    s_mov_b64 exec, 1
    buffer_store_dword v5, v6, s[4:7], s25 offen sc1
    s_mov_b64 exec, -1
noflag_18:
    s_add_u32 s21, s21, 4
    s_cmp_lt_u32 s21, 64
    s_cbranch_scc1 V_loop
    s_and_b32 s21, s21, 3
    v_and_b32 v7, 7, v4
    v_lshlrev_b32 v7, 4, v7
    v_lshl_add_u32 v7, v3, 7, v7
    v_lshlrev_b32 v2, 4, v4
    v_lshl_add_u32 v2, v3, 3, v2
    v_bfrev_b32 v5, 1
    v_cmp_gt_u32 vcc, 32, v0
    s_nop 1
    v_cndmask_b32 v2, v5, v2, vcc
    s_lshr_b32 s40, s40, 2
    s_lshr_b32 s41, s41, 2
    s_lshr_b32 s42, s42, 2
    s_lshr_b32 s43, s43, 2
    s_lshr_b32 s44, s44, 2
    s_lshr_b32 s45, s45, 2
    s_lshr_b32 s46, s46, 2
    s_lshr_b32 s47, s47, 2
    s_lshr_b32 s48, s48, 2
    s_lshr_b32 s49, s49, 2
    s_lshr_b32 s50, s50, 2
    s_lshr_b32 s51, s51, 2
    s_lshr_b32 s52, s52, 2
    s_lshr_b32 s53, s53, 2
    s_lshr_b32 s30, s17, 5
    s_lshl_b32 s30, s30, 7
    s_add_u32 s30, s30, 69833728
    v_mov_b32 v9, s30
    s_cmp_eq_u32 s16, 0
    s_cbranch_scc0 wad_20
wa_19:
    buffer_load_dword v8, v9, s[4:7], 0 offen sc1
    s_waitcnt vmcnt(0)
    v_cmp_eq_u32 vcc, 0, v8
    s_cbranch_vccz wad_20
    s_sub_u32 s18, s18, 1
    s_cbranch_scc1 main_end2
    s_sleep 8
    s_branch wa_19
wad_20:
    s_waitcnt vmcnt(0)
    s_barrier
    s_mov_b32 s27, s21
G_loop:
    s_mul_i32 s23, s21, 14336
    s_add_u32 s23, s23, 65608704
    s_mov_b32 s34, s23
G_wait:
    buffer_load_dword v8, v7, s[4:7], s34 offen sc1
    s_waitcnt vmcnt(0)
    v_cmp_eq_u32 vcc, -1, v8
    s_cbranch_vccz G_poll
    s_sub_u32 s18, s18, 1
    s_cbranch_scc1 main_end2
    s_sleep 2
    s_branch G_wait
G_poll:
    s_add_u32 s33, s23, s40
    buffer_load_dwordx4 v[8:11], v7, s[4:7], s33 offen sc1
    s_add_u32 s33, s23, s41
    buffer_load_dwordx4 v[12:15], v7, s[4:7], s33 offen sc1
    s_add_u32 s33, s23, s42
    buffer_load_dwordx4 v[16:19], v7, s[4:7], s33 offen sc1
    s_add_u32 s33, s23, s43
    buffer_load_dwordx4 v[20:23], v7, s[4:7], s33 offen sc1
    s_add_u32 s33, s23, s44
    buffer_load_dwordx4 v[24:27], v7, s[4:7], s33 offen sc1
    s_add_u32 s33, s23, s45
    buffer_load_dwordx4 v[28:31], v7, s[4:7], s33 offen sc1
    s_add_u32 s33, s23, s46
    buffer_load_dwordx4 v[32:35], v7, s[4:7], s33 offen sc1
    s_add_u32 s33, s23, s47
    buffer_load_dwordx4 v[36:39], v7, s[4:7], s33 offen sc1
    s_add_u32 s33, s23, s48
    buffer_load_dwordx4 v[40:43], v7, s[4:7], s33 offen sc1
    s_add_u32 s33, s23, s49
    buffer_load_dwordx4 v[44:47], v7, s[4:7], s33 offen sc1
    s_add_u32 s33, s23, s50
    buffer_load_dwordx4 v[48:51], v7, s[4:7], s33 offen sc1
    s_add_u32 s33, s23, s51
    buffer_load_dwordx4 v[52:55], v7, s[4:7], s33 offen sc1
    s_add_u32 s33, s23, s52
    buffer_load_dwordx4 v[56:59], v7, s[4:7], s33 offen sc1
    s_add_u32 s33, s23, s53
    buffer_load_dwordx4 v[60:63], v7, s[4:7], s33 offen sc1
    s_sub_u32 s18, s18, 1
    s_cbranch_scc1 main_end2
    s_waitcnt vmcnt(0)
    v_max3_u32 v92, v8, v9, v10
    v_max3_u32 v92, v92, v11, v12
    v_max3_u32 v92, v92, v13, v14
    v_max3_u32 v92, v92, v15, v16
    v_max3_u32 v92, v92, v17, v18
    v_max3_u32 v92, v92, v19, v20
    v_max3_u32 v92, v92, v21, v22
    v_max3_u32 v92, v92, v23, v24
    v_max3_u32 v92, v92, v25, v26
    v_max3_u32 v92, v92, v27, v28
    v_max3_u32 v92, v92, v29, v30
    v_max3_u32 v92, v92, v31, v32
    v_max3_u32 v92, v92, v33, v34
    v_max3_u32 v92, v92, v35, v36
    v_max3_u32 v92, v92, v37, v38
    v_max3_u32 v92, v92, v39, v40
    v_max3_u32 v92, v92, v41, v42
    v_max3_u32 v92, v92, v43, v44
    v_max3_u32 v92, v92, v45, v46
    v_max3_u32 v92, v92, v47, v48
    v_max3_u32 v92, v92, v49, v50
    v_max3_u32 v92, v92, v51, v52
    v_max3_u32 v92, v92, v53, v54
    v_max3_u32 v92, v92, v55, v56
    v_max3_u32 v92, v92, v57, v58
    v_max3_u32 v92, v92, v59, v60
    v_max3_u32 v92, v92, v61, v62
    v_max_u32 v92, v92, v63
    v_cmp_eq_u32 vcc, -1, v92
    s_cbranch_vccnz G_poll
    s_lshl_b32 s24, s21, 4
    s_add_u32 s24, s24, s22
    s_lshl_b32 s25, s24, 2
    s_add_u32 s25, s25, 69820416
    s_mul_i32 s24, s21, 114688
    s_lshl_b32 s33, s22, 8
    s_add_u32 s24, s24, s33
    s_mul_i32 s33, s16, 28672
    s_add_u32 s24, s24, s33
    s_add_u32 s24, s24, 58261504
    s_cmp_eq_u32 s21, 63
    s_cbranch_scc0 G_all
    s_cmp_eq_u32 s27, 0
    s_cbranch_scc0 G_part0
    v_mfma_f32_16x16x32_bf16 v[64:67], v[8:11], a[0:3], 0
    v_mfma_f32_16x16x32_bf16 v[68:71], v[8:11], a[4:7], 0
    v_mfma_f32_16x16x32_bf16 v[72:75], v[8:11], a[8:11], 0
    v_mfma_f32_16x16x32_bf16 v[64:67], v[12:15], a[28:31], v[64:67]
    v_mfma_f32_16x16x32_bf16 v[68:71], v[12:15], a[32:35], v[68:71]
    v_mfma_f32_16x16x32_bf16 v[72:75], v[12:15], a[36:39], v[72:75]
    v_mfma_f32_16x16x32_bf16 v[64:67], v[16:19], a[56:59], v[64:67]
    v_mfma_f32_16x16x32_bf16 v[68:71], v[16:19], a[60:63], v[68:71]
    v_mfma_f32_16x16x32_bf16 v[72:75], v[16:19], a[64:67], v[72:75]
    v_mfma_f32_16x16x32_bf16 v[64:67], v[20:23], a[84:87], v[64:67]
    v_mfma_f32_16x16x32_bf16 v[68:71], v[20:23], a[88:91], v[68:71]
    v_mfma_f32_16x16x32_bf16 v[72:75], v[20:23], a[92:95], v[72:75]
    v_mfma_f32_16x16x32_bf16 v[64:67], v[24:27], a[112:115], v[64:67]
    v_mfma_f32_16x16x32_bf16 v[68:71], v[24:27], a[116:119], v[68:71]
    v_mfma_f32_16x16x32_bf16 v[72:75], v[24:27], a[120:123], v[72:75]
    v_mfma_f32_16x16x32_bf16 v[64:67], v[28:31], a[140:143], v[64:67]
    v_mfma_f32_16x16x32_bf16 v[68:71], v[28:31], a[144:147], v[68:71]
    v_mfma_f32_16x16x32_bf16 v[72:75], v[28:31], a[148:151], v[72:75]
    v_mfma_f32_16x16x32_bf16 v[64:67], v[32:35], a[168:171], v[64:67]
    v_mfma_f32_16x16x32_bf16 v[68:71], v[32:35], a[172:175], v[68:71]
    v_mfma_f32_16x16x32_bf16 v[72:75], v[32:35], a[176:179], v[72:75]
    v_mfma_f32_16x16x32_bf16 v[64:67], v[36:39], a[196:199], v[64:67]
    v_mfma_f32_16x16x32_bf16 v[68:71], v[36:39], a[200:203], v[68:71]
    v_mfma_f32_16x16x32_bf16 v[72:75], v[36:39], a[204:207], v[72:75]
    v_mfma_f32_16x16x32_bf16 v[64:67], v[40:43], a[224:227], v[64:67]
    v_mfma_f32_16x16x32_bf16 v[68:71], v[40:43], a[228:231], v[68:71]
    v_mfma_f32_16x16x32_bf16 v[72:75], v[40:43], a[232:235], v[72:75]
    v_mfma_f32_16x16x32_bf16 v[64:67], v[44:47], a[252:255], v[64:67]
    v_mfma_f32_16x16x32_bf16 v[68:71], v[44:47], v[120:123], v[68:71]
    v_mfma_f32_16x16x32_bf16 v[72:75], v[44:47], v[124:127], v[72:75]
    v_mfma_f32_16x16x32_bf16 v[64:67], v[48:51], v[144:147], v[64:67]
    v_mfma_f32_16x16x32_bf16 v[68:71], v[48:51], v[148:151], v[68:71]
    v_mfma_f32_16x16x32_bf16 v[72:75], v[48:51], v[152:155], v[72:75]
    v_mfma_f32_16x16x32_bf16 v[64:67], v[52:55], v[172:175], v[64:67]
    v_mfma_f32_16x16x32_bf16 v[68:71], v[52:55], v[176:179], v[68:71]
    v_mfma_f32_16x16x32_bf16 v[72:75], v[52:55], v[180:183], v[72:75]
    v_mfma_f32_16x16x32_bf16 v[64:67], v[56:59], v[200:203], v[64:67]
    v_mfma_f32_16x16x32_bf16 v[68:71], v[56:59], v[204:207], v[68:71]
    v_mfma_f32_16x16x32_bf16 v[72:75], v[56:59], v[208:211], v[72:75]
    v_mfma_f32_16x16x32_bf16 v[64:67], v[60:63], v[228:231], v[64:67]
    v_mfma_f32_16x16x32_bf16 v[68:71], v[60:63], v[232:235], v[68:71]
    v_mfma_f32_16x16x32_bf16 v[72:75], v[60:63], v[236:239], v[72:75]
    s_nop 5
    v_cvt_pk_bf16_f32 v64, v64, v65
    v_cvt_pk_bf16_f32 v65, v66, v67
    v_min_u32 v64, -2, v64
    v_min_u32 v65, -2, v65
    s_add_u32 s33, s24, 0
    buffer_store_dwordx2 v[64:65], v2, s[4:7], s33 offen sc1
    v_cvt_pk_bf16_f32 v68, v68, v69
    v_cvt_pk_bf16_f32 v69, v70, v71
    v_min_u32 v68, -2, v68
    v_min_u32 v69, -2, v69
    s_add_u32 s33, s24, 4096
    buffer_store_dwordx2 v[68:69], v2, s[4:7], s33 offen sc1
    v_cvt_pk_bf16_f32 v72, v72, v73
    v_cvt_pk_bf16_f32 v73, v74, v75
    v_min_u32 v72, -2, v72
    v_min_u32 v73, -2, v73
    s_add_u32 s33, s24, 8192
    buffer_store_dwordx2 v[72:73], v2, s[4:7], s33 offen sc1
    s_endpgm
G_part0:
    s_cmp_eq_u32 s27, 1
    s_cbranch_scc0 G_part1
    v_mfma_f32_16x16x32_bf16 v[76:79], v[8:11], a[12:15], 0
    v_mfma_f32_16x16x32_bf16 v[80:83], v[8:11], a[16:19], 0
    v_mfma_f32_16x16x32_bf16 v[76:79], v[12:15], a[40:43], v[76:79]
    v_mfma_f32_16x16x32_bf16 v[80:83], v[12:15], a[44:47], v[80:83]
    v_mfma_f32_16x16x32_bf16 v[76:79], v[16:19], a[68:71], v[76:79]
    v_mfma_f32_16x16x32_bf16 v[80:83], v[16:19], a[72:75], v[80:83]
    v_mfma_f32_16x16x32_bf16 v[76:79], v[20:23], a[96:99], v[76:79]
    v_mfma_f32_16x16x32_bf16 v[80:83], v[20:23], a[100:103], v[80:83]
    v_mfma_f32_16x16x32_bf16 v[76:79], v[24:27], a[124:127], v[76:79]
    v_mfma_f32_16x16x32_bf16 v[80:83], v[24:27], a[128:131], v[80:83]
    v_mfma_f32_16x16x32_bf16 v[76:79], v[28:31], a[152:155], v[76:79]
    v_mfma_f32_16x16x32_bf16 v[80:83], v[28:31], a[156:159], v[80:83]
    v_mfma_f32_16x16x32_bf16 v[76:79], v[32:35], a[180:183], v[76:79]
    v_mfma_f32_16x16x32_bf16 v[80:83], v[32:35], a[184:187], v[80:83]
    v_mfma_f32_16x16x32_bf16 v[76:79], v[36:39], a[208:211], v[76:79]
    v_mfma_f32_16x16x32_bf16 v[80:83], v[36:39], a[212:215], v[80:83]
    v_mfma_f32_16x16x32_bf16 v[76:79], v[40:43], a[236:239], v[76:79]
    v_mfma_f32_16x16x32_bf16 v[80:83], v[40:43], a[240:243], v[80:83]
    v_mfma_f32_16x16x32_bf16 v[76:79], v[44:47], v[128:131], v[76:79]
    v_mfma_f32_16x16x32_bf16 v[80:83], v[44:47], v[132:135], v[80:83]
    v_mfma_f32_16x16x32_bf16 v[76:79], v[48:51], v[156:159], v[76:79]
    v_mfma_f32_16x16x32_bf16 v[80:83], v[48:51], v[160:163], v[80:83]
    v_mfma_f32_16x16x32_bf16 v[76:79], v[52:55], v[184:187], v[76:79]
    v_mfma_f32_16x16x32_bf16 v[80:83], v[52:55], v[188:191], v[80:83]
    v_mfma_f32_16x16x32_bf16 v[76:79], v[56:59], v[212:215], v[76:79]
    v_mfma_f32_16x16x32_bf16 v[80:83], v[56:59], v[216:219], v[80:83]
    v_mfma_f32_16x16x32_bf16 v[76:79], v[60:63], v[240:243], v[76:79]
    v_mfma_f32_16x16x32_bf16 v[80:83], v[60:63], v[244:247], v[80:83]
    s_nop 6
    v_cvt_pk_bf16_f32 v76, v76, v77
    v_cvt_pk_bf16_f32 v77, v78, v79
    v_min_u32 v76, -2, v76
    v_min_u32 v77, -2, v77
    s_add_u32 s33, s24, 12288
    buffer_store_dwordx2 v[76:77], v2, s[4:7], s33 offen sc1
    v_cvt_pk_bf16_f32 v80, v80, v81
    v_cvt_pk_bf16_f32 v81, v82, v83
    v_min_u32 v80, -2, v80
    v_min_u32 v81, -2, v81
    s_add_u32 s33, s24, 16384
    buffer_store_dwordx2 v[80:81], v2, s[4:7], s33 offen sc1
    s_endpgm
G_part1:
    s_cmp_eq_u32 s27, 2
    s_cbranch_scc0 G_part2
    s_endpgm
G_part2:
    v_mfma_f32_16x16x32_bf16 v[84:87], v[8:11], a[20:23], 0
    v_mfma_f32_16x16x32_bf16 v[88:91], v[8:11], a[24:27], 0
    v_mfma_f32_16x16x32_bf16 v[84:87], v[12:15], a[48:51], v[84:87]
    v_mfma_f32_16x16x32_bf16 v[88:91], v[12:15], a[52:55], v[88:91]
    v_mfma_f32_16x16x32_bf16 v[84:87], v[16:19], a[76:79], v[84:87]
    v_mfma_f32_16x16x32_bf16 v[88:91], v[16:19], a[80:83], v[88:91]
    v_mfma_f32_16x16x32_bf16 v[84:87], v[20:23], a[104:107], v[84:87]
    v_mfma_f32_16x16x32_bf16 v[88:91], v[20:23], a[108:111], v[88:91]
    v_mfma_f32_16x16x32_bf16 v[84:87], v[24:27], a[132:135], v[84:87]
    v_mfma_f32_16x16x32_bf16 v[88:91], v[24:27], a[136:139], v[88:91]
    v_mfma_f32_16x16x32_bf16 v[84:87], v[28:31], a[160:163], v[84:87]
    v_mfma_f32_16x16x32_bf16 v[88:91], v[28:31], a[164:167], v[88:91]
    v_mfma_f32_16x16x32_bf16 v[84:87], v[32:35], a[188:191], v[84:87]
    v_mfma_f32_16x16x32_bf16 v[88:91], v[32:35], a[192:195], v[88:91]
    v_mfma_f32_16x16x32_bf16 v[84:87], v[36:39], a[216:219], v[84:87]
    v_mfma_f32_16x16x32_bf16 v[88:91], v[36:39], a[220:223], v[88:91]
    v_mfma_f32_16x16x32_bf16 v[84:87], v[40:43], a[244:247], v[84:87]
    v_mfma_f32_16x16x32_bf16 v[88:91], v[40:43], a[248:251], v[88:91]
    v_mfma_f32_16x16x32_bf16 v[84:87], v[44:47], v[136:139], v[84:87]
    v_mfma_f32_16x16x32_bf16 v[88:91], v[44:47], v[140:143], v[88:91]
    v_mfma_f32_16x16x32_bf16 v[84:87], v[48:51], v[164:167], v[84:87]
    v_mfma_f32_16x16x32_bf16 v[88:91], v[48:51], v[168:171], v[88:91]
    v_mfma_f32_16x16x32_bf16 v[84:87], v[52:55], v[192:195], v[84:87]
    v_mfma_f32_16x16x32_bf16 v[88:91], v[52:55], v[196:199], v[88:91]
    v_mfma_f32_16x16x32_bf16 v[84:87], v[56:59], v[220:223], v[84:87]
    v_mfma_f32_16x16x32_bf16 v[88:91], v[56:59], v[224:227], v[88:91]
    v_mfma_f32_16x16x32_bf16 v[84:87], v[60:63], v[248:251], v[84:87]
    v_mfma_f32_16x16x32_bf16 v[88:91], v[60:63], v[252:255], v[88:91]
    s_nop 6
    v_cvt_pk_bf16_f32 v84, v84, v85
    v_cvt_pk_bf16_f32 v85, v86, v87
    v_min_u32 v84, -2, v84
    v_min_u32 v85, -2, v85
    s_add_u32 s33, s24, 20480
    buffer_store_dwordx2 v[84:85], v2, s[4:7], s33 offen sc1
    v_cvt_pk_bf16_f32 v88, v88, v89
    v_cvt_pk_bf16_f32 v89, v90, v91
    v_min_u32 v88, -2, v88
    v_min_u32 v89, -2, v89
    s_add_u32 s33, s24, 24576
    buffer_store_dwordx2 v[88:89], v2, s[4:7], s33 offen sc1
    s_endpgm
G_all:
    v_mfma_f32_16x16x32_bf16 v[64:67], v[8:11], a[0:3], 0
    v_mfma_f32_16x16x32_bf16 v[68:71], v[8:11], a[4:7], 0
    v_mfma_f32_16x16x32_bf16 v[72:75], v[8:11], a[8:11], 0
    v_mfma_f32_16x16x32_bf16 v[76:79], v[8:11], a[12:15], 0
    v_mfma_f32_16x16x32_bf16 v[80:83], v[8:11], a[16:19], 0
    v_mfma_f32_16x16x32_bf16 v[84:87], v[8:11], a[20:23], 0
    v_mfma_f32_16x16x32_bf16 v[88:91], v[8:11], a[24:27], 0
    v_mfma_f32_16x16x32_bf16 v[64:67], v[12:15], a[28:31], v[64:67]
    v_mfma_f32_16x16x32_bf16 v[68:71], v[12:15], a[32:35], v[68:71]
    v_mfma_f32_16x16x32_bf16 v[72:75], v[12:15], a[36:39], v[72:75]
    v_mfma_f32_16x16x32_bf16 v[76:79], v[12:15], a[40:43], v[76:79]
    v_mfma_f32_16x16x32_bf16 v[80:83], v[12:15], a[44:47], v[80:83]
    v_mfma_f32_16x16x32_bf16 v[84:87], v[12:15], a[48:51], v[84:87]
    v_mfma_f32_16x16x32_bf16 v[88:91], v[12:15], a[52:55], v[88:91]
    v_mfma_f32_16x16x32_bf16 v[64:67], v[16:19], a[56:59], v[64:67]
    v_mfma_f32_16x16x32_bf16 v[68:71], v[16:19], a[60:63], v[68:71]
    v_mfma_f32_16x16x32_bf16 v[72:75], v[16:19], a[64:67], v[72:75]
    v_mfma_f32_16x16x32_bf16 v[76:79], v[16:19], a[68:71], v[76:79]
    v_mfma_f32_16x16x32_bf16 v[80:83], v[16:19], a[72:75], v[80:83]
    v_mfma_f32_16x16x32_bf16 v[84:87], v[16:19], a[76:79], v[84:87]
    v_mfma_f32_16x16x32_bf16 v[88:91], v[16:19], a[80:83], v[88:91]
    v_mfma_f32_16x16x32_bf16 v[64:67], v[20:23], a[84:87], v[64:67]
    v_mfma_f32_16x16x32_bf16 v[68:71], v[20:23], a[88:91], v[68:71]
    v_mfma_f32_16x16x32_bf16 v[72:75], v[20:23], a[92:95], v[72:75]
    v_mfma_f32_16x16x32_bf16 v[76:79], v[20:23], a[96:99], v[76:79]
    v_mfma_f32_16x16x32_bf16 v[80:83], v[20:23], a[100:103], v[80:83]
    v_mfma_f32_16x16x32_bf16 v[84:87], v[20:23], a[104:107], v[84:87]
    v_mfma_f32_16x16x32_bf16 v[88:91], v[20:23], a[108:111], v[88:91]
    v_mfma_f32_16x16x32_bf16 v[64:67], v[24:27], a[112:115], v[64:67]
    v_mfma_f32_16x16x32_bf16 v[68:71], v[24:27], a[116:119], v[68:71]
    v_mfma_f32_16x16x32_bf16 v[72:75], v[24:27], a[120:123], v[72:75]
    v_mfma_f32_16x16x32_bf16 v[76:79], v[24:27], a[124:127], v[76:79]
    v_mfma_f32_16x16x32_bf16 v[80:83], v[24:27], a[128:131], v[80:83]
    v_mfma_f32_16x16x32_bf16 v[84:87], v[24:27], a[132:135], v[84:87]
    v_mfma_f32_16x16x32_bf16 v[88:91], v[24:27], a[136:139], v[88:91]
    v_mfma_f32_16x16x32_bf16 v[64:67], v[28:31], a[140:143], v[64:67]
    v_mfma_f32_16x16x32_bf16 v[68:71], v[28:31], a[144:147], v[68:71]
    v_mfma_f32_16x16x32_bf16 v[72:75], v[28:31], a[148:151], v[72:75]
    v_mfma_f32_16x16x32_bf16 v[76:79], v[28:31], a[152:155], v[76:79]
    v_mfma_f32_16x16x32_bf16 v[80:83], v[28:31], a[156:159], v[80:83]
    v_mfma_f32_16x16x32_bf16 v[84:87], v[28:31], a[160:163], v[84:87]
    v_mfma_f32_16x16x32_bf16 v[88:91], v[28:31], a[164:167], v[88:91]
    v_mfma_f32_16x16x32_bf16 v[64:67], v[32:35], a[168:171], v[64:67]
    v_mfma_f32_16x16x32_bf16 v[68:71], v[32:35], a[172:175], v[68:71]
    v_mfma_f32_16x16x32_bf16 v[72:75], v[32:35], a[176:179], v[72:75]
    v_mfma_f32_16x16x32_bf16 v[76:79], v[32:35], a[180:183], v[76:79]
    v_mfma_f32_16x16x32_bf16 v[80:83], v[32:35], a[184:187], v[80:83]
    v_mfma_f32_16x16x32_bf16 v[84:87], v[32:35], a[188:191], v[84:87]
    v_mfma_f32_16x16x32_bf16 v[88:91], v[32:35], a[192:195], v[88:91]
    v_mfma_f32_16x16x32_bf16 v[64:67], v[36:39], a[196:199], v[64:67]
    v_mfma_f32_16x16x32_bf16 v[68:71], v[36:39], a[200:203], v[68:71]
    v_mfma_f32_16x16x32_bf16 v[72:75], v[36:39], a[204:207], v[72:75]
    v_mfma_f32_16x16x32_bf16 v[76:79], v[36:39], a[208:211], v[76:79]
    v_mfma_f32_16x16x32_bf16 v[80:83], v[36:39], a[212:215], v[80:83]
    v_mfma_f32_16x16x32_bf16 v[84:87], v[36:39], a[216:219], v[84:87]
    v_mfma_f32_16x16x32_bf16 v[88:91], v[36:39], a[220:223], v[88:91]
    v_mfma_f32_16x16x32_bf16 v[64:67], v[40:43], a[224:227], v[64:67]
    v_mfma_f32_16x16x32_bf16 v[68:71], v[40:43], a[228:231], v[68:71]
    v_mfma_f32_16x16x32_bf16 v[72:75], v[40:43], a[232:235], v[72:75]
    v_mfma_f32_16x16x32_bf16 v[76:79], v[40:43], a[236:239], v[76:79]
    v_mfma_f32_16x16x32_bf16 v[80:83], v[40:43], a[240:243], v[80:83]
    v_mfma_f32_16x16x32_bf16 v[84:87], v[40:43], a[244:247], v[84:87]
    v_mfma_f32_16x16x32_bf16 v[88:91], v[40:43], a[248:251], v[88:91]
    v_mfma_f32_16x16x32_bf16 v[64:67], v[44:47], a[252:255], v[64:67]
    v_mfma_f32_16x16x32_bf16 v[68:71], v[44:47], v[120:123], v[68:71]
    v_mfma_f32_16x16x32_bf16 v[72:75], v[44:47], v[124:127], v[72:75]
    v_mfma_f32_16x16x32_bf16 v[76:79], v[44:47], v[128:131], v[76:79]
    v_mfma_f32_16x16x32_bf16 v[80:83], v[44:47], v[132:135], v[80:83]
    v_mfma_f32_16x16x32_bf16 v[84:87], v[44:47], v[136:139], v[84:87]
    v_mfma_f32_16x16x32_bf16 v[88:91], v[44:47], v[140:143], v[88:91]
    v_mfma_f32_16x16x32_bf16 v[64:67], v[48:51], v[144:147], v[64:67]
    v_mfma_f32_16x16x32_bf16 v[68:71], v[48:51], v[148:151], v[68:71]
    v_mfma_f32_16x16x32_bf16 v[72:75], v[48:51], v[152:155], v[72:75]
    v_mfma_f32_16x16x32_bf16 v[76:79], v[48:51], v[156:159], v[76:79]
    v_mfma_f32_16x16x32_bf16 v[80:83], v[48:51], v[160:163], v[80:83]
    v_mfma_f32_16x16x32_bf16 v[84:87], v[48:51], v[164:167], v[84:87]
    v_mfma_f32_16x16x32_bf16 v[88:91], v[48:51], v[168:171], v[88:91]
    v_mfma_f32_16x16x32_bf16 v[64:67], v[52:55], v[172:175], v[64:67]
    v_mfma_f32_16x16x32_bf16 v[68:71], v[52:55], v[176:179], v[68:71]
    v_mfma_f32_16x16x32_bf16 v[72:75], v[52:55], v[180:183], v[72:75]
    v_mfma_f32_16x16x32_bf16 v[76:79], v[52:55], v[184:187], v[76:79]
    v_mfma_f32_16x16x32_bf16 v[80:83], v[52:55], v[188:191], v[80:83]
    v_mfma_f32_16x16x32_bf16 v[84:87], v[52:55], v[192:195], v[84:87]
    v_mfma_f32_16x16x32_bf16 v[88:91], v[52:55], v[196:199], v[88:91]
    v_mfma_f32_16x16x32_bf16 v[64:67], v[56:59], v[200:203], v[64:67]
    v_mfma_f32_16x16x32_bf16 v[68:71], v[56:59], v[204:207], v[68:71]
    v_mfma_f32_16x16x32_bf16 v[72:75], v[56:59], v[208:211], v[72:75]
    v_mfma_f32_16x16x32_bf16 v[76:79], v[56:59], v[212:215], v[76:79]
    v_mfma_f32_16x16x32_bf16 v[80:83], v[56:59], v[216:219], v[80:83]
    v_mfma_f32_16x16x32_bf16 v[84:87], v[56:59], v[220:223], v[84:87]
    v_mfma_f32_16x16x32_bf16 v[88:91], v[56:59], v[224:227], v[88:91]
    v_mfma_f32_16x16x32_bf16 v[64:67], v[60:63], v[228:231], v[64:67]
    v_mfma_f32_16x16x32_bf16 v[68:71], v[60:63], v[232:235], v[68:71]
    v_mfma_f32_16x16x32_bf16 v[72:75], v[60:63], v[236:239], v[72:75]
    v_mfma_f32_16x16x32_bf16 v[76:79], v[60:63], v[240:243], v[76:79]
    v_mfma_f32_16x16x32_bf16 v[80:83], v[60:63], v[244:247], v[80:83]
    v_mfma_f32_16x16x32_bf16 v[84:87], v[60:63], v[248:251], v[84:87]
    v_mfma_f32_16x16x32_bf16 v[88:91], v[60:63], v[252:255], v[88:91]
    s_nop 1
    v_cvt_pk_bf16_f32 v64, v64, v65
    v_cvt_pk_bf16_f32 v65, v66, v67
    v_min_u32 v64, -2, v64
    v_min_u32 v65, -2, v65
    s_add_u32 s33, s24, 0
    buffer_store_dwordx2 v[64:65], v2, s[4:7], s33 offen sc1
    v_cvt_pk_bf16_f32 v68, v68, v69
    v_cvt_pk_bf16_f32 v69, v70, v71
    v_min_u32 v68, -2, v68
    v_min_u32 v69, -2, v69
    s_add_u32 s33, s24, 4096
    buffer_store_dwordx2 v[68:69], v2, s[4:7], s33 offen sc1
    v_cvt_pk_bf16_f32 v72, v72, v73
    v_cvt_pk_bf16_f32 v73, v74, v75
    v_min_u32 v72, -2, v72
    v_min_u32 v73, -2, v73
    s_add_u32 s33, s24, 8192
    buffer_store_dwordx2 v[72:73], v2, s[4:7], s33 offen sc1
    v_cvt_pk_bf16_f32 v76, v76, v77
    v_cvt_pk_bf16_f32 v77, v78, v79
    v_min_u32 v76, -2, v76
    v_min_u32 v77, -2, v77
    s_add_u32 s33, s24, 12288
    buffer_store_dwordx2 v[76:77], v2, s[4:7], s33 offen sc1
    v_cvt_pk_bf16_f32 v80, v80, v81
    v_cvt_pk_bf16_f32 v81, v82, v83
    v_min_u32 v80, -2, v80
    v_min_u32 v81, -2, v81
    s_add_u32 s33, s24, 16384
    buffer_store_dwordx2 v[80:81], v2, s[4:7], s33 offen sc1
    v_cvt_pk_bf16_f32 v84, v84, v85
    v_cvt_pk_bf16_f32 v85, v86, v87
    v_min_u32 v84, -2, v84
    v_min_u32 v85, -2, v85
    s_add_u32 s33, s24, 20480
    buffer_store_dwordx2 v[84:85], v2, s[4:7], s33 offen sc1
    v_cvt_pk_bf16_f32 v88, v88, v89
    v_cvt_pk_bf16_f32 v89, v90, v91
    v_min_u32 v88, -2, v88
    v_min_u32 v89, -2, v89
    s_add_u32 s33, s24, 24576
    buffer_store_dwordx2 v[88:89], v2, s[4:7], s33 offen sc1
    s_waitcnt vmcnt(0)
    s_barrier
    s_cmp_eq_u32 s16, 0
    s_cbranch_scc0 noflag_21
    v_mov_b32 v5, 1
    v_mov_b32 v6, 0
    s_mov_b64 exec, 1
    buffer_store_dword v5, v6, s[4:7], s25 offen sc1
    s_mov_b64 exec, -1
noflag_21:
    s_add_u32 s21, s21, 4
    s_cmp_eq_u32 s21, 66
    s_cbranch_scc1 G_out
    s_min_u32 s21, s21, 63
    s_branch G_loop
G_out:
    s_endpgm
role_P:
    s_sub_u32 s27, s17, 96
    s_lshr_b32 s22, s27, 2
    s_and_b32 s21, s27, 3
    s_mov_b32 s20, s22
    v_and_b32 v9, 7, v0
    v_bfe_u32 v10, v0, 3, 0
    v_add_u32 v10, s20, v10
    v_lshlrev_b32 v10, 7, v10
    v_lshl_add_u32 v9, v9, 2, v10
    v_add_u32 v9, 69828608, v9
    s_cmp_eq_u32 s16, 0
    s_cbranch_scc0 wad_23
wa_22:
    buffer_load_dword v8, v9, s[4:7], 0 offen sc1
    s_waitcnt vmcnt(0)
    v_cmp_eq_u32 vcc, 0, v8
    s_cbranch_vccz wad_23
    s_sub_u32 s18, s18, 1
    s_cbranch_scc1 main_end2
    s_sleep 2
    s_branch wa_22
wad_23:
    s_waitcnt vmcnt(0)
    s_barrier
    s_lshr_b32 s28, s16, 1
    s_mul_i32 s28, s28, 7
    s_and_b32 s29, s16, 1
    s_cmp_eq_u32 s29, 0
    s_cselect_b32 s30, 4, 16
    s_add_u32 s30, s30, s28
    s_sub_u32 s31, s30, 14
    s_cselect_b32 s30, s30, s31
    s_sub_u32 s31, s30, 14
    s_cselect_b32 s30, s30, s31
    s_lshl_b32 s40, s30, 11
    s_cmp_eq_u32 s29, 0
    s_cselect_b32 s30, 5, 15
    s_add_u32 s30, s30, s28
    s_sub_u32 s31, s30, 14
    s_cselect_b32 s30, s30, s31
    s_sub_u32 s31, s30, 14
    s_cselect_b32 s30, s30, s31
    s_lshl_b32 s41, s30, 11
    s_cmp_eq_u32 s29, 0
    s_cselect_b32 s30, 6, 14
    s_add_u32 s30, s30, s28
    s_sub_u32 s31, s30, 14
    s_cselect_b32 s30, s30, s31
    s_sub_u32 s31, s30, 14
    s_cselect_b32 s30, s30, s31
    s_lshl_b32 s42, s30, 11
    s_cmp_eq_u32 s29, 0
    s_cselect_b32 s30, 7, 13
    s_add_u32 s30, s30, s28
    s_sub_u32 s31, s30, 14
    s_cselect_b32 s30, s30, s31
    s_sub_u32 s31, s30, 14
    s_cselect_b32 s30, s30, s31
    s_lshl_b32 s43, s30, 11
    s_cmp_eq_u32 s29, 0
    s_cselect_b32 s30, 8, 12
    s_add_u32 s30, s30, s28
    s_sub_u32 s31, s30, 14
    s_cselect_b32 s30, s30, s31
    s_sub_u32 s31, s30, 14
    s_cselect_b32 s30, s30, s31
    s_lshl_b32 s44, s30, 11
    s_cmp_eq_u32 s29, 0
    s_cselect_b32 s30, 9, 11
    s_add_u32 s30, s30, s28
    s_sub_u32 s31, s30, 14
    s_cselect_b32 s30, s30, s31
    s_sub_u32 s31, s30, 14
    s_cselect_b32 s30, s30, s31
    s_lshl_b32 s45, s30, 11
    s_cmp_eq_u32 s29, 0
    s_cselect_b32 s30, 10, 10
    s_add_u32 s30, s30, s28
    s_sub_u32 s31, s30, 14
    s_cselect_b32 s30, s30, s31
    s_sub_u32 s31, s30, 14
    s_cselect_b32 s30, s30, s31
    s_lshl_b32 s46, s30, 11
    s_cmp_eq_u32 s29, 0
    s_cselect_b32 s30, 11, 9
    s_add_u32 s30, s30, s28
    s_sub_u32 s31, s30, 14
    s_cselect_b32 s30, s30, s31
    s_sub_u32 s31, s30, 14
    s_cselect_b32 s30, s30, s31
    s_lshl_b32 s47, s30, 11
    s_cmp_eq_u32 s29, 0
    s_cselect_b32 s30, 12, 8
    s_add_u32 s30, s30, s28
    s_sub_u32 s31, s30, 14
    s_cselect_b32 s30, s30, s31
    s_sub_u32 s31, s30, 14
    s_cselect_b32 s30, s30, s31
    s_lshl_b32 s48, s30, 11
    s_cmp_eq_u32 s29, 0
    s_cselect_b32 s30, 13, 7
    s_add_u32 s30, s30, s28
    s_sub_u32 s31, s30, 14
    s_cselect_b32 s30, s30, s31
    s_sub_u32 s31, s30, 14
    s_cselect_b32 s30, s30, s31
    s_lshl_b32 s49, s30, 11
    s_cmp_eq_u32 s29, 0
    s_cselect_b32 s30, 14, 6
    s_add_u32 s30, s30, s28
    s_sub_u32 s31, s30, 14
    s_cselect_b32 s30, s30, s31
    s_sub_u32 s31, s30, 14
    s_cselect_b32 s30, s30, s31
    s_lshl_b32 s50, s30, 11
    s_cmp_eq_u32 s29, 0
    s_cselect_b32 s30, 15, 5
    s_add_u32 s30, s30, s28
    s_sub_u32 s31, s30, 14
    s_cselect_b32 s30, s30, s31
    s_sub_u32 s31, s30, 14
    s_cselect_b32 s30, s30, s31
    s_lshl_b32 s51, s30, 11
    s_cmp_eq_u32 s29, 0
    s_cselect_b32 s30, 16, 4
    s_add_u32 s30, s30, s28
    s_sub_u32 s31, s30, 14
    s_cselect_b32 s30, s30, s31
    s_sub_u32 s31, s30, 14
    s_cselect_b32 s30, s30, s31
    s_lshl_b32 s52, s30, 11
    s_cmp_eq_u32 s29, 0
    s_cselect_b32 s30, 17, 3
    s_add_u32 s30, s30, s28
    s_sub_u32 s31, s30, 14
    s_cselect_b32 s30, s30, s31
    s_sub_u32 s31, s30, 14
    s_cselect_b32 s30, s30, s31
    s_lshl_b32 s53, s30, 11
    s_lshr_b32 s56, s50, 10
    s_add_u32 s57, s56, 1
    s_lshr_b32 s58, s51, 10
    s_add_u32 s59, s58, 1
    s_lshr_b32 s60, s52, 10
    s_add_u32 s61, s60, 1
    s_lshr_b32 s62, s53, 10
    s_add_u32 s62, s62, s29
    v_lshlrev_b32 v1, 4, v0
    v_lshrrev_b32 v3, 4, v0
    v_and_b32 v4, 15, v0
    v_lshlrev_b32 v2, 9, v3
    v_lshl_add_u32 v2, v4, 4, v2
    s_mul_i32 s30, s20, 401408
    s_mul_i32 s64, s56, 14336
    s_add_u32 s64, s64, s30
    s_mul_i32 s65, s57, 14336
    s_add_u32 s65, s65, s30
    s_mul_i32 s66, s58, 14336
    s_add_u32 s66, s66, s30
    s_mul_i32 s67, s59, 14336
    s_add_u32 s67, s67, s30
    s_mul_i32 s68, s60, 14336
    s_add_u32 s68, s68, s30
    s_mul_i32 s69, s61, 14336
    s_add_u32 s69, s69, s30
    s_mul_i32 s70, s62, 14336
    s_add_u32 s70, s70, s30
    s_lshr_b32 s31, s40, 1
    s_add_u32 s33, s31, s64
    buffer_load_dwordx4 a[0:3], v1, s[4:7], s33 offen
    s_add_u32 s33, s31, s65
    buffer_load_dwordx4 a[4:7], v1, s[4:7], s33 offen
    s_add_u32 s33, s31, s66
    buffer_load_dwordx4 a[8:11], v1, s[4:7], s33 offen
    s_add_u32 s33, s31, s67
    buffer_load_dwordx4 a[12:15], v1, s[4:7], s33 offen
    s_add_u32 s33, s31, s68
    buffer_load_dwordx4 a[16:19], v1, s[4:7], s33 offen
    s_add_u32 s33, s31, s69
    buffer_load_dwordx4 a[20:23], v1, s[4:7], s33 offen
    s_add_u32 s33, s31, s70
    buffer_load_dwordx4 a[24:27], v1, s[4:7], s33 offen
    s_lshr_b32 s31, s41, 1
    s_add_u32 s33, s31, s64
    buffer_load_dwordx4 a[28:31], v1, s[4:7], s33 offen
    s_add_u32 s33, s31, s65
    buffer_load_dwordx4 a[32:35], v1, s[4:7], s33 offen
    s_add_u32 s33, s31, s66
    buffer_load_dwordx4 a[36:39], v1, s[4:7], s33 offen
    s_add_u32 s33, s31, s67
    buffer_load_dwordx4 a[40:43], v1, s[4:7], s33 offen
    s_add_u32 s33, s31, s68
    buffer_load_dwordx4 a[44:47], v1, s[4:7], s33 offen
    s_add_u32 s33, s31, s69
    buffer_load_dwordx4 a[48:51], v1, s[4:7], s33 offen
    s_add_u32 s33, s31, s70
    buffer_load_dwordx4 a[52:55], v1, s[4:7], s33 offen
    s_lshr_b32 s31, s42, 1
    s_add_u32 s33, s31, s64
    buffer_load_dwordx4 a[56:59], v1, s[4:7], s33 offen
    s_add_u32 s33, s31, s65
    buffer_load_dwordx4 a[60:63], v1, s[4:7], s33 offen
    s_add_u32 s33, s31, s66
    buffer_load_dwordx4 a[64:67], v1, s[4:7], s33 offen
    s_add_u32 s33, s31, s67
    buffer_load_dwordx4 a[68:71], v1, s[4:7], s33 offen
    s_add_u32 s33, s31, s68
    buffer_load_dwordx4 a[72:75], v1, s[4:7], s33 offen
    s_add_u32 s33, s31, s69
    buffer_load_dwordx4 a[76:79], v1, s[4:7], s33 offen
    s_add_u32 s33, s31, s70
    buffer_load_dwordx4 a[80:83], v1, s[4:7], s33 offen
    s_lshr_b32 s31, s43, 1
    s_add_u32 s33, s31, s64
    buffer_load_dwordx4 a[84:87], v1, s[4:7], s33 offen
    s_add_u32 s33, s31, s65
    buffer_load_dwordx4 a[88:91], v1, s[4:7], s33 offen
    s_add_u32 s33, s31, s66
    buffer_load_dwordx4 a[92:95], v1, s[4:7], s33 offen
    s_add_u32 s33, s31, s67
    buffer_load_dwordx4 a[96:99], v1, s[4:7], s33 offen
    s_add_u32 s33, s31, s68
    buffer_load_dwordx4 a[100:103], v1, s[4:7], s33 offen
    s_add_u32 s33, s31, s69
    buffer_load_dwordx4 a[104:107], v1, s[4:7], s33 offen
    s_add_u32 s33, s31, s70
    buffer_load_dwordx4 a[108:111], v1, s[4:7], s33 offen
    s_lshr_b32 s31, s44, 1
    s_add_u32 s33, s31, s64
    buffer_load_dwordx4 a[112:115], v1, s[4:7], s33 offen
    s_add_u32 s33, s31, s65
    buffer_load_dwordx4 a[116:119], v1, s[4:7], s33 offen
    s_add_u32 s33, s31, s66
    buffer_load_dwordx4 a[120:123], v1, s[4:7], s33 offen
    s_add_u32 s33, s31, s67
    buffer_load_dwordx4 a[124:127], v1, s[4:7], s33 offen
    s_add_u32 s33, s31, s68
    buffer_load_dwordx4 a[128:131], v1, s[4:7], s33 offen
    s_add_u32 s33, s31, s69
    buffer_load_dwordx4 a[132:135], v1, s[4:7], s33 offen
    s_add_u32 s33, s31, s70
    buffer_load_dwordx4 a[136:139], v1, s[4:7], s33 offen
    s_lshr_b32 s31, s45, 1
    s_add_u32 s33, s31, s64
    buffer_load_dwordx4 a[140:143], v1, s[4:7], s33 offen
    s_add_u32 s33, s31, s65
    buffer_load_dwordx4 a[144:147], v1, s[4:7], s33 offen
    s_add_u32 s33, s31, s66
    buffer_load_dwordx4 a[148:151], v1, s[4:7], s33 offen
    s_add_u32 s33, s31, s67
    buffer_load_dwordx4 a[152:155], v1, s[4:7], s33 offen
    s_add_u32 s33, s31, s68
    buffer_load_dwordx4 a[156:159], v1, s[4:7], s33 offen
    s_add_u32 s33, s31, s69
    buffer_load_dwordx4 a[160:163], v1, s[4:7], s33 offen
    s_add_u32 s33, s31, s70
    buffer_load_dwordx4 a[164:167], v1, s[4:7], s33 offen
    s_lshr_b32 s31, s46, 1
    s_add_u32 s33, s31, s64
    buffer_load_dwordx4 a[168:171], v1, s[4:7], s33 offen
    s_add_u32 s33, s31, s65
    buffer_load_dwordx4 a[172:175], v1, s[4:7], s33 offen
    s_add_u32 s33, s31, s66
    buffer_load_dwordx4 a[176:179], v1, s[4:7], s33 offen
    s_add_u32 s33, s31, s67
    buffer_load_dwordx4 a[180:183], v1, s[4:7], s33 offen
    s_add_u32 s33, s31, s68
    buffer_load_dwordx4 a[184:187], v1, s[4:7], s33 offen
    s_add_u32 s33, s31, s69
    buffer_load_dwordx4 a[188:191], v1, s[4:7], s33 offen
    s_add_u32 s33, s31, s70
    buffer_load_dwordx4 a[192:195], v1, s[4:7], s33 offen
    s_lshr_b32 s31, s47, 1
    s_add_u32 s33, s31, s64
    buffer_load_dwordx4 a[196:199], v1, s[4:7], s33 offen
    s_add_u32 s33, s31, s65
    buffer_load_dwordx4 a[200:203], v1, s[4:7], s33 offen
    s_add_u32 s33, s31, s66
    buffer_load_dwordx4 a[204:207], v1, s[4:7], s33 offen
    s_add_u32 s33, s31, s67
    buffer_load_dwordx4 a[208:211], v1, s[4:7], s33 offen
    s_add_u32 s33, s31, s68
    buffer_load_dwordx4 a[212:215], v1, s[4:7], s33 offen
    s_add_u32 s33, s31, s69
    buffer_load_dwordx4 a[216:219], v1, s[4:7], s33 offen
    s_add_u32 s33, s31, s70
    buffer_load_dwordx4 a[220:223], v1, s[4:7], s33 offen
    s_lshr_b32 s31, s48, 1
    s_add_u32 s33, s31, s64
    buffer_load_dwordx4 a[224:227], v1, s[4:7], s33 offen
    s_add_u32 s33, s31, s65
    buffer_load_dwordx4 a[228:231], v1, s[4:7], s33 offen
    s_add_u32 s33, s31, s66
    buffer_load_dwordx4 a[232:235], v1, s[4:7], s33 offen
    s_add_u32 s33, s31, s67
    buffer_load_dwordx4 a[236:239], v1, s[4:7], s33 offen
    s_add_u32 s33, s31, s68
    buffer_load_dwordx4 a[240:243], v1, s[4:7], s33 offen
    s_add_u32 s33, s31, s69
    buffer_load_dwordx4 a[244:247], v1, s[4:7], s33 offen
    s_add_u32 s33, s31, s70
    buffer_load_dwordx4 a[248:251], v1, s[4:7], s33 offen
    s_lshr_b32 s31, s49, 1
    s_add_u32 s33, s31, s64
    buffer_load_dwordx4 a[252:255], v1, s[4:7], s33 offen
    s_add_u32 s33, s31, s65
    buffer_load_dwordx4 v[120:123], v1, s[4:7], s33 offen
    s_add_u32 s33, s31, s66
    buffer_load_dwordx4 v[124:127], v1, s[4:7], s33 offen
    s_add_u32 s33, s31, s67
    buffer_load_dwordx4 v[128:131], v1, s[4:7], s33 offen
    s_add_u32 s33, s31, s68
    buffer_load_dwordx4 v[132:135], v1, s[4:7], s33 offen
    s_add_u32 s33, s31, s69
    buffer_load_dwordx4 v[136:139], v1, s[4:7], s33 offen
    s_add_u32 s33, s31, s70
    buffer_load_dwordx4 v[140:143], v1, s[4:7], s33 offen
    s_lshr_b32 s31, s50, 1
    s_add_u32 s33, s31, s64
    buffer_load_dwordx4 v[144:147], v1, s[4:7], s33 offen
    s_add_u32 s33, s31, s65
    buffer_load_dwordx4 v[148:151], v1, s[4:7], s33 offen
    s_add_u32 s33, s31, s66
    buffer_load_dwordx4 v[152:155], v1, s[4:7], s33 offen
    s_add_u32 s33, s31, s67
    buffer_load_dwordx4 v[156:159], v1, s[4:7], s33 offen
    s_add_u32 s33, s31, s68
    buffer_load_dwordx4 v[160:163], v1, s[4:7], s33 offen
    s_add_u32 s33, s31, s69
    buffer_load_dwordx4 v[164:167], v1, s[4:7], s33 offen
    s_add_u32 s33, s31, s70
    buffer_load_dwordx4 v[168:171], v1, s[4:7], s33 offen
    s_lshr_b32 s31, s51, 1
    s_add_u32 s33, s31, s64
    buffer_load_dwordx4 v[172:175], v1, s[4:7], s33 offen
    s_add_u32 s33, s31, s65
    buffer_load_dwordx4 v[176:179], v1, s[4:7], s33 offen
    s_add_u32 s33, s31, s66
    buffer_load_dwordx4 v[180:183], v1, s[4:7], s33 offen
    s_add_u32 s33, s31, s67
    buffer_load_dwordx4 v[184:187], v1, s[4:7], s33 offen
    s_add_u32 s33, s31, s68
    buffer_load_dwordx4 v[188:191], v1, s[4:7], s33 offen
    s_add_u32 s33, s31, s69
    buffer_load_dwordx4 v[192:195], v1, s[4:7], s33 offen
    s_add_u32 s33, s31, s70
    buffer_load_dwordx4 v[196:199], v1, s[4:7], s33 offen
    s_lshr_b32 s31, s52, 1
    s_add_u32 s33, s31, s64
    buffer_load_dwordx4 v[200:203], v1, s[4:7], s33 offen
    s_add_u32 s33, s31, s65
    buffer_load_dwordx4 v[204:207], v1, s[4:7], s33 offen
    s_add_u32 s33, s31, s66
    buffer_load_dwordx4 v[208:211], v1, s[4:7], s33 offen
    s_add_u32 s33, s31, s67
    buffer_load_dwordx4 v[212:215], v1, s[4:7], s33 offen
    s_add_u32 s33, s31, s68
    buffer_load_dwordx4 v[216:219], v1, s[4:7], s33 offen
    s_add_u32 s33, s31, s69
    buffer_load_dwordx4 v[220:223], v1, s[4:7], s33 offen
    s_add_u32 s33, s31, s70
    buffer_load_dwordx4 v[224:227], v1, s[4:7], s33 offen
    s_lshr_b32 s31, s53, 1
    s_add_u32 s33, s31, s64
    buffer_load_dwordx4 v[228:231], v1, s[4:7], s33 offen
    s_add_u32 s33, s31, s65
    buffer_load_dwordx4 v[232:235], v1, s[4:7], s33 offen
    s_add_u32 s33, s31, s66
    buffer_load_dwordx4 v[236:239], v1, s[4:7], s33 offen
    s_add_u32 s33, s31, s67
    buffer_load_dwordx4 v[240:243], v1, s[4:7], s33 offen
    s_add_u32 s33, s31, s68
    buffer_load_dwordx4 v[244:247], v1, s[4:7], s33 offen
    s_add_u32 s33, s31, s69
    buffer_load_dwordx4 v[248:251], v1, s[4:7], s33 offen
    s_add_u32 s33, s31, s70
    buffer_load_dwordx4 v[252:255], v1, s[4:7], s33 offen
    s_lshr_b32 s30, s17, 5
    s_lshl_b32 s30, s30, 7
    s_add_u32 s30, s30, 69833728
    v_mov_b32 v9, s30
    s_cmp_eq_u32 s16, 0
    s_cbranch_scc0 wad_25
wa_24:
    buffer_load_dword v8, v9, s[4:7], 0 offen sc1
    s_waitcnt vmcnt(0)
    v_cmp_eq_u32 vcc, 0, v8
    s_cbranch_vccz wad_25
    s_sub_u32 s18, s18, 1
    s_cbranch_scc1 main_end2
    s_sleep 8
    s_branch wa_24
wad_25:
    s_waitcnt vmcnt(0)
    s_barrier
    v_and_b32 v7, 7, v4
    v_lshlrev_b32 v7, 4, v7
    v_lshl_add_u32 v7, v3, 7, v7
    s_mul_i32 s34, s16, 5120
    v_add_u32 v12, s34, v1
    s_lshl_b32 s34, s16, 10
    v_add_u32 v13, s34, v1
    v_mov_b32 v14, v1
    s_lshl_b32 s34, s16, 4
    v_lshlrev_b32 v15, 2, v3
    v_sub_u32 v15, v4, v15
    v_add_u32 v15, s34, v15
    v_lshlrev_b32 v16, 4, v4
    v_lshl_add_u32 v16, v3, 3, v16
    v_mov_b32 v17, 0x80000000
    s_mov_b32 s36, -1
    s_mov_b32 s37, 0
    v_cndmask_b32 v16, v17, v16, s[36:37]
    v_mov_b32 v18, 0xceabfb8f
P_loop:
    s_mul_i32 s23, s21, 28672
    s_add_u32 s23, s23, 16056320
    s_add_u32 s33, s23, s40
    buffer_load_dwordx4 v[32:35], v2, s[4:7], s33 offen offset:0
    s_add_u32 s33, s23, s40
    buffer_load_dwordx4 v[36:39], v2, s[4:7], s33 offen offset:256
    s_add_u32 s33, s23, s41
    buffer_load_dwordx4 v[40:43], v2, s[4:7], s33 offen offset:0
    s_add_u32 s33, s23, s41
    buffer_load_dwordx4 v[44:47], v2, s[4:7], s33 offen offset:256
    s_add_u32 s33, s23, s42
    buffer_load_dwordx4 v[48:51], v2, s[4:7], s33 offen offset:0
    s_add_u32 s33, s23, s42
    buffer_load_dwordx4 v[52:55], v2, s[4:7], s33 offen offset:256
    s_add_u32 s33, s23, s43
    buffer_load_dwordx4 v[56:59], v2, s[4:7], s33 offen offset:0
    s_add_u32 s33, s23, s43
    buffer_load_dwordx4 v[60:63], v2, s[4:7], s33 offen offset:256
    s_waitcnt vmcnt(7)
    v_mfma_f32_16x16x32_bf16 v[64:67], a[0:3], v[32:35], 0
    v_mfma_f32_16x16x32_bf16 v[72:75], a[4:7], v[32:35], 0
    v_mfma_f32_16x16x32_bf16 v[80:83], a[8:11], v[32:35], 0
    v_mfma_f32_16x16x32_bf16 v[88:91], a[12:15], v[32:35], 0
    v_mfma_f32_16x16x32_bf16 v[96:99], a[16:19], v[32:35], 0
    v_mfma_f32_16x16x32_bf16 v[104:107], a[20:23], v[32:35], 0
    v_mfma_f32_16x16x32_bf16 v[112:115], a[24:27], v[32:35], 0
    s_add_u32 s33, s23, s44
    buffer_load_dwordx4 v[32:35], v2, s[4:7], s33 offen offset:0
    s_waitcnt vmcnt(7)
    v_mfma_f32_16x16x32_bf16 v[68:71], a[0:3], v[36:39], 0
    v_mfma_f32_16x16x32_bf16 v[76:79], a[4:7], v[36:39], 0
    v_mfma_f32_16x16x32_bf16 v[84:87], a[8:11], v[36:39], 0
    v_mfma_f32_16x16x32_bf16 v[92:95], a[12:15], v[36:39], 0
    v_mfma_f32_16x16x32_bf16 v[100:103], a[16:19], v[36:39], 0
    v_mfma_f32_16x16x32_bf16 v[108:111], a[20:23], v[36:39], 0
    v_mfma_f32_16x16x32_bf16 v[116:119], a[24:27], v[36:39], 0
    s_add_u32 s33, s23, s44
    buffer_load_dwordx4 v[36:39], v2, s[4:7], s33 offen offset:256
    s_waitcnt vmcnt(7)
    v_mfma_f32_16x16x32_bf16 v[64:67], a[28:31], v[40:43], v[64:67]
    v_mfma_f32_16x16x32_bf16 v[72:75], a[32:35], v[40:43], v[72:75]
    v_mfma_f32_16x16x32_bf16 v[80:83], a[36:39], v[40:43], v[80:83]
    v_mfma_f32_16x16x32_bf16 v[88:91], a[40:43], v[40:43], v[88:91]
    v_mfma_f32_16x16x32_bf16 v[96:99], a[44:47], v[40:43], v[96:99]
    v_mfma_f32_16x16x32_bf16 v[104:107], a[48:51], v[40:43], v[104:107]
    v_mfma_f32_16x16x32_bf16 v[112:115], a[52:55], v[40:43], v[112:115]
    s_add_u32 s33, s23, s45
    buffer_load_dwordx4 v[40:43], v2, s[4:7], s33 offen offset:0
    s_waitcnt vmcnt(7)
    v_mfma_f32_16x16x32_bf16 v[68:71], a[28:31], v[44:47], v[68:71]
    v_mfma_f32_16x16x32_bf16 v[76:79], a[32:35], v[44:47], v[76:79]
    v_mfma_f32_16x16x32_bf16 v[84:87], a[36:39], v[44:47], v[84:87]
    v_mfma_f32_16x16x32_bf16 v[92:95], a[40:43], v[44:47], v[92:95]
    v_mfma_f32_16x16x32_bf16 v[100:103], a[44:47], v[44:47], v[100:103]
    v_mfma_f32_16x16x32_bf16 v[108:111], a[48:51], v[44:47], v[108:111]
    v_mfma_f32_16x16x32_bf16 v[116:119], a[52:55], v[44:47], v[116:119]
    s_add_u32 s33, s23, s45
    buffer_load_dwordx4 v[44:47], v2, s[4:7], s33 offen offset:256
    s_waitcnt vmcnt(7)
    v_mfma_f32_16x16x32_bf16 v[64:67], a[56:59], v[48:51], v[64:67]
    v_mfma_f32_16x16x32_bf16 v[72:75], a[60:63], v[48:51], v[72:75]
    v_mfma_f32_16x16x32_bf16 v[80:83], a[64:67], v[48:51], v[80:83]
    v_mfma_f32_16x16x32_bf16 v[88:91], a[68:71], v[48:51], v[88:91]
    v_mfma_f32_16x16x32_bf16 v[96:99], a[72:75], v[48:51], v[96:99]
    v_mfma_f32_16x16x32_bf16 v[104:107], a[76:79], v[48:51], v[104:107]
    v_mfma_f32_16x16x32_bf16 v[112:115], a[80:83], v[48:51], v[112:115]
    s_add_u32 s33, s23, s46
    buffer_load_dwordx4 v[48:51], v2, s[4:7], s33 offen offset:0
    s_waitcnt vmcnt(7)
    v_mfma_f32_16x16x32_bf16 v[68:71], a[56:59], v[52:55], v[68:71]
    v_mfma_f32_16x16x32_bf16 v[76:79], a[60:63], v[52:55], v[76:79]
    v_mfma_f32_16x16x32_bf16 v[84:87], a[64:67], v[52:55], v[84:87]
    v_mfma_f32_16x16x32_bf16 v[92:95], a[68:71], v[52:55], v[92:95]
    v_mfma_f32_16x16x32_bf16 v[100:103], a[72:75], v[52:55], v[100:103]
    v_mfma_f32_16x16x32_bf16 v[108:111], a[76:79], v[52:55], v[108:111]
    v_mfma_f32_16x16x32_bf16 v[116:119], a[80:83], v[52:55], v[116:119]
    s_add_u32 s33, s23, s46
    buffer_load_dwordx4 v[52:55], v2, s[4:7], s33 offen offset:256
    s_waitcnt vmcnt(7)
    v_mfma_f32_16x16x32_bf16 v[64:67], a[84:87], v[56:59], v[64:67]
    v_mfma_f32_16x16x32_bf16 v[72:75], a[88:91], v[56:59], v[72:75]
    v_mfma_f32_16x16x32_bf16 v[80:83], a[92:95], v[56:59], v[80:83]
    v_mfma_f32_16x16x32_bf16 v[88:91], a[96:99], v[56:59], v[88:91]
    v_mfma_f32_16x16x32_bf16 v[96:99], a[100:103], v[56:59], v[96:99]
    v_mfma_f32_16x16x32_bf16 v[104:107], a[104:107], v[56:59], v[104:107]
    v_mfma_f32_16x16x32_bf16 v[112:115], a[108:111], v[56:59], v[112:115]
    s_add_u32 s33, s23, s47
    buffer_load_dwordx4 v[56:59], v2, s[4:7], s33 offen offset:0
    s_waitcnt vmcnt(7)
    v_mfma_f32_16x16x32_bf16 v[68:71], a[84:87], v[60:63], v[68:71]
    v_mfma_f32_16x16x32_bf16 v[76:79], a[88:91], v[60:63], v[76:79]
    v_mfma_f32_16x16x32_bf16 v[84:87], a[92:95], v[60:63], v[84:87]
    v_mfma_f32_16x16x32_bf16 v[92:95], a[96:99], v[60:63], v[92:95]
    v_mfma_f32_16x16x32_bf16 v[100:103], a[100:103], v[60:63], v[100:103]
    v_mfma_f32_16x16x32_bf16 v[108:111], a[104:107], v[60:63], v[108:111]
    v_mfma_f32_16x16x32_bf16 v[116:119], a[108:111], v[60:63], v[116:119]
    s_add_u32 s33, s23, s47
    buffer_load_dwordx4 v[60:63], v2, s[4:7], s33 offen offset:256
    s_waitcnt vmcnt(7)
    v_mfma_f32_16x16x32_bf16 v[64:67], a[112:115], v[32:35], v[64:67]
    v_mfma_f32_16x16x32_bf16 v[72:75], a[116:119], v[32:35], v[72:75]
    v_mfma_f32_16x16x32_bf16 v[80:83], a[120:123], v[32:35], v[80:83]
    v_mfma_f32_16x16x32_bf16 v[88:91], a[124:127], v[32:35], v[88:91]
    v_mfma_f32_16x16x32_bf16 v[96:99], a[128:131], v[32:35], v[96:99]
    v_mfma_f32_16x16x32_bf16 v[104:107], a[132:135], v[32:35], v[104:107]
    v_mfma_f32_16x16x32_bf16 v[112:115], a[136:139], v[32:35], v[112:115]
    s_add_u32 s33, s23, s48
    buffer_load_dwordx4 v[32:35], v2, s[4:7], s33 offen offset:0
    s_waitcnt vmcnt(7)
    v_mfma_f32_16x16x32_bf16 v[68:71], a[112:115], v[36:39], v[68:71]
    v_mfma_f32_16x16x32_bf16 v[76:79], a[116:119], v[36:39], v[76:79]
    v_mfma_f32_16x16x32_bf16 v[84:87], a[120:123], v[36:39], v[84:87]
    v_mfma_f32_16x16x32_bf16 v[92:95], a[124:127], v[36:39], v[92:95]
    v_mfma_f32_16x16x32_bf16 v[100:103], a[128:131], v[36:39], v[100:103]
    v_mfma_f32_16x16x32_bf16 v[108:111], a[132:135], v[36:39], v[108:111]
    v_mfma_f32_16x16x32_bf16 v[116:119], a[136:139], v[36:39], v[116:119]
    s_add_u32 s33, s23, s48
    buffer_load_dwordx4 v[36:39], v2, s[4:7], s33 offen offset:256
    s_waitcnt vmcnt(7)
    v_mfma_f32_16x16x32_bf16 v[64:67], a[140:143], v[40:43], v[64:67]
    v_mfma_f32_16x16x32_bf16 v[72:75], a[144:147], v[40:43], v[72:75]
    v_mfma_f32_16x16x32_bf16 v[80:83], a[148:151], v[40:43], v[80:83]
    v_mfma_f32_16x16x32_bf16 v[88:91], a[152:155], v[40:43], v[88:91]
    v_mfma_f32_16x16x32_bf16 v[96:99], a[156:159], v[40:43], v[96:99]
    v_mfma_f32_16x16x32_bf16 v[104:107], a[160:163], v[40:43], v[104:107]
    v_mfma_f32_16x16x32_bf16 v[112:115], a[164:167], v[40:43], v[112:115]
    s_add_u32 s33, s23, s49
    buffer_load_dwordx4 v[40:43], v2, s[4:7], s33 offen offset:0
    s_waitcnt vmcnt(7)
    v_mfma_f32_16x16x32_bf16 v[68:71], a[140:143], v[44:47], v[68:71]
    v_mfma_f32_16x16x32_bf16 v[76:79], a[144:147], v[44:47], v[76:79]
    v_mfma_f32_16x16x32_bf16 v[84:87], a[148:151], v[44:47], v[84:87]
    v_mfma_f32_16x16x32_bf16 v[92:95], a[152:155], v[44:47], v[92:95]
    v_mfma_f32_16x16x32_bf16 v[100:103], a[156:159], v[44:47], v[100:103]
    v_mfma_f32_16x16x32_bf16 v[108:111], a[160:163], v[44:47], v[108:111]
    v_mfma_f32_16x16x32_bf16 v[116:119], a[164:167], v[44:47], v[116:119]
    s_add_u32 s33, s23, s49
    buffer_load_dwordx4 v[44:47], v2, s[4:7], s33 offen offset:256
    s_waitcnt vmcnt(7)
    v_mfma_f32_16x16x32_bf16 v[64:67], a[168:171], v[48:51], v[64:67]
    v_mfma_f32_16x16x32_bf16 v[72:75], a[172:175], v[48:51], v[72:75]
    v_mfma_f32_16x16x32_bf16 v[80:83], a[176:179], v[48:51], v[80:83]
    v_mfma_f32_16x16x32_bf16 v[88:91], a[180:183], v[48:51], v[88:91]
    v_mfma_f32_16x16x32_bf16 v[96:99], a[184:187], v[48:51], v[96:99]
    v_mfma_f32_16x16x32_bf16 v[104:107], a[188:191], v[48:51], v[104:107]
    v_mfma_f32_16x16x32_bf16 v[112:115], a[192:195], v[48:51], v[112:115]
    s_add_u32 s33, s23, s50
    buffer_load_dwordx4 v[48:51], v2, s[4:7], s33 offen offset:0
    s_waitcnt vmcnt(7)
    v_mfma_f32_16x16x32_bf16 v[68:71], a[168:171], v[52:55], v[68:71]
    v_mfma_f32_16x16x32_bf16 v[76:79], a[172:175], v[52:55], v[76:79]
    v_mfma_f32_16x16x32_bf16 v[84:87], a[176:179], v[52:55], v[84:87]
    v_mfma_f32_16x16x32_bf16 v[92:95], a[180:183], v[52:55], v[92:95]
    v_mfma_f32_16x16x32_bf16 v[100:103], a[184:187], v[52:55], v[100:103]
    v_mfma_f32_16x16x32_bf16 v[108:111], a[188:191], v[52:55], v[108:111]
    v_mfma_f32_16x16x32_bf16 v[116:119], a[192:195], v[52:55], v[116:119]
    s_add_u32 s33, s23, s50
    buffer_load_dwordx4 v[52:55], v2, s[4:7], s33 offen offset:256
    s_waitcnt vmcnt(7)
    v_mfma_f32_16x16x32_bf16 v[64:67], a[196:199], v[56:59], v[64:67]
    v_mfma_f32_16x16x32_bf16 v[72:75], a[200:203], v[56:59], v[72:75]
    v_mfma_f32_16x16x32_bf16 v[80:83], a[204:207], v[56:59], v[80:83]
    v_mfma_f32_16x16x32_bf16 v[88:91], a[208:211], v[56:59], v[88:91]
    v_mfma_f32_16x16x32_bf16 v[96:99], a[212:215], v[56:59], v[96:99]
    v_mfma_f32_16x16x32_bf16 v[104:107], a[216:219], v[56:59], v[104:107]
    v_mfma_f32_16x16x32_bf16 v[112:115], a[220:223], v[56:59], v[112:115]
    s_add_u32 s33, s23, s51
    buffer_load_dwordx4 v[56:59], v2, s[4:7], s33 offen offset:0
    s_waitcnt vmcnt(7)
    v_mfma_f32_16x16x32_bf16 v[68:71], a[196:199], v[60:63], v[68:71]
    v_mfma_f32_16x16x32_bf16 v[76:79], a[200:203], v[60:63], v[76:79]
    v_mfma_f32_16x16x32_bf16 v[84:87], a[204:207], v[60:63], v[84:87]
    v_mfma_f32_16x16x32_bf16 v[92:95], a[208:211], v[60:63], v[92:95]
    v_mfma_f32_16x16x32_bf16 v[100:103], a[212:215], v[60:63], v[100:103]
    v_mfma_f32_16x16x32_bf16 v[108:111], a[216:219], v[60:63], v[108:111]
    v_mfma_f32_16x16x32_bf16 v[116:119], a[220:223], v[60:63], v[116:119]
    s_add_u32 s33, s23, s51
    buffer_load_dwordx4 v[60:63], v2, s[4:7], s33 offen offset:256
    s_waitcnt vmcnt(7)
    v_mfma_f32_16x16x32_bf16 v[64:67], a[224:227], v[32:35], v[64:67]
    v_mfma_f32_16x16x32_bf16 v[72:75], a[228:231], v[32:35], v[72:75]
    v_mfma_f32_16x16x32_bf16 v[80:83], a[232:235], v[32:35], v[80:83]
    v_mfma_f32_16x16x32_bf16 v[88:91], a[236:239], v[32:35], v[88:91]
    v_mfma_f32_16x16x32_bf16 v[96:99], a[240:243], v[32:35], v[96:99]
    v_mfma_f32_16x16x32_bf16 v[104:107], a[244:247], v[32:35], v[104:107]
    v_mfma_f32_16x16x32_bf16 v[112:115], a[248:251], v[32:35], v[112:115]
    s_add_u32 s33, s23, s52
    buffer_load_dwordx4 v[32:35], v2, s[4:7], s33 offen offset:0
    s_waitcnt vmcnt(7)
    v_mfma_f32_16x16x32_bf16 v[68:71], a[224:227], v[36:39], v[68:71]
    v_mfma_f32_16x16x32_bf16 v[76:79], a[228:231], v[36:39], v[76:79]
    v_mfma_f32_16x16x32_bf16 v[84:87], a[232:235], v[36:39], v[84:87]
    v_mfma_f32_16x16x32_bf16 v[92:95], a[236:239], v[36:39], v[92:95]
    v_mfma_f32_16x16x32_bf16 v[100:103], a[240:243], v[36:39], v[100:103]
    v_mfma_f32_16x16x32_bf16 v[108:111], a[244:247], v[36:39], v[108:111]
    v_mfma_f32_16x16x32_bf16 v[116:119], a[248:251], v[36:39], v[116:119]
    s_add_u32 s33, s23, s52
    buffer_load_dwordx4 v[36:39], v2, s[4:7], s33 offen offset:256
    s_waitcnt vmcnt(7)
    v_mfma_f32_16x16x32_bf16 v[64:67], a[252:255], v[40:43], v[64:67]
    v_mfma_f32_16x16x32_bf16 v[72:75], v[120:123], v[40:43], v[72:75]
    v_mfma_f32_16x16x32_bf16 v[80:83], v[124:127], v[40:43], v[80:83]
    v_mfma_f32_16x16x32_bf16 v[88:91], v[128:131], v[40:43], v[88:91]
    v_mfma_f32_16x16x32_bf16 v[96:99], v[132:135], v[40:43], v[96:99]
    v_mfma_f32_16x16x32_bf16 v[104:107], v[136:139], v[40:43], v[104:107]
    v_mfma_f32_16x16x32_bf16 v[112:115], v[140:143], v[40:43], v[112:115]
    s_add_u32 s33, s23, s53
    buffer_load_dwordx4 v[40:43], v2, s[4:7], s33 offen offset:0
    s_waitcnt vmcnt(7)
    v_mfma_f32_16x16x32_bf16 v[68:71], a[252:255], v[44:47], v[68:71]
    v_mfma_f32_16x16x32_bf16 v[76:79], v[120:123], v[44:47], v[76:79]
    v_mfma_f32_16x16x32_bf16 v[84:87], v[124:127], v[44:47], v[84:87]
    v_mfma_f32_16x16x32_bf16 v[92:95], v[128:131], v[44:47], v[92:95]
    v_mfma_f32_16x16x32_bf16 v[100:103], v[132:135], v[44:47], v[100:103]
    v_mfma_f32_16x16x32_bf16 v[108:111], v[136:139], v[44:47], v[108:111]
    v_mfma_f32_16x16x32_bf16 v[116:119], v[140:143], v[44:47], v[116:119]
    s_add_u32 s33, s23, s53
    buffer_load_dwordx4 v[44:47], v2, s[4:7], s33 offen offset:256
    s_waitcnt vmcnt(7)
    v_mfma_f32_16x16x32_bf16 v[64:67], v[144:147], v[48:51], v[64:67]
    v_mfma_f32_16x16x32_bf16 v[72:75], v[148:151], v[48:51], v[72:75]
    v_mfma_f32_16x16x32_bf16 v[80:83], v[152:155], v[48:51], v[80:83]
    v_mfma_f32_16x16x32_bf16 v[88:91], v[156:159], v[48:51], v[88:91]
    v_mfma_f32_16x16x32_bf16 v[96:99], v[160:163], v[48:51], v[96:99]
    v_mfma_f32_16x16x32_bf16 v[104:107], v[164:167], v[48:51], v[104:107]
    v_mfma_f32_16x16x32_bf16 v[112:115], v[168:171], v[48:51], v[112:115]
    s_waitcnt vmcnt(6)
    v_mfma_f32_16x16x32_bf16 v[68:71], v[144:147], v[52:55], v[68:71]
    v_mfma_f32_16x16x32_bf16 v[76:79], v[148:151], v[52:55], v[76:79]
    v_mfma_f32_16x16x32_bf16 v[84:87], v[152:155], v[52:55], v[84:87]
    v_mfma_f32_16x16x32_bf16 v[92:95], v[156:159], v[52:55], v[92:95]
    v_mfma_f32_16x16x32_bf16 v[100:103], v[160:163], v[52:55], v[100:103]
    v_mfma_f32_16x16x32_bf16 v[108:111], v[164:167], v[52:55], v[108:111]
    v_mfma_f32_16x16x32_bf16 v[116:119], v[168:171], v[52:55], v[116:119]
    s_waitcnt vmcnt(5)
    v_mfma_f32_16x16x32_bf16 v[64:67], v[172:175], v[56:59], v[64:67]
    v_mfma_f32_16x16x32_bf16 v[72:75], v[176:179], v[56:59], v[72:75]
    v_mfma_f32_16x16x32_bf16 v[80:83], v[180:183], v[56:59], v[80:83]
    v_mfma_f32_16x16x32_bf16 v[88:91], v[184:187], v[56:59], v[88:91]
    v_mfma_f32_16x16x32_bf16 v[96:99], v[188:191], v[56:59], v[96:99]
    v_mfma_f32_16x16x32_bf16 v[104:107], v[192:195], v[56:59], v[104:107]
    v_mfma_f32_16x16x32_bf16 v[112:115], v[196:199], v[56:59], v[112:115]
    s_waitcnt vmcnt(4)
    v_mfma_f32_16x16x32_bf16 v[68:71], v[172:175], v[60:63], v[68:71]
    v_mfma_f32_16x16x32_bf16 v[76:79], v[176:179], v[60:63], v[76:79]
    v_mfma_f32_16x16x32_bf16 v[84:87], v[180:183], v[60:63], v[84:87]
    v_mfma_f32_16x16x32_bf16 v[92:95], v[184:187], v[60:63], v[92:95]
    v_mfma_f32_16x16x32_bf16 v[100:103], v[188:191], v[60:63], v[100:103]
    v_mfma_f32_16x16x32_bf16 v[108:111], v[192:195], v[60:63], v[108:111]
    v_mfma_f32_16x16x32_bf16 v[116:119], v[196:199], v[60:63], v[116:119]
    s_waitcnt vmcnt(3)
    v_mfma_f32_16x16x32_bf16 v[64:67], v[200:203], v[32:35], v[64:67]
    v_mfma_f32_16x16x32_bf16 v[72:75], v[204:207], v[32:35], v[72:75]
    v_mfma_f32_16x16x32_bf16 v[80:83], v[208:211], v[32:35], v[80:83]
    v_mfma_f32_16x16x32_bf16 v[88:91], v[212:215], v[32:35], v[88:91]
    v_mfma_f32_16x16x32_bf16 v[96:99], v[216:219], v[32:35], v[96:99]
    v_mfma_f32_16x16x32_bf16 v[104:107], v[220:223], v[32:35], v[104:107]
    v_mfma_f32_16x16x32_bf16 v[112:115], v[224:227], v[32:35], v[112:115]
    s_waitcnt vmcnt(2)
    v_mfma_f32_16x16x32_bf16 v[68:71], v[200:203], v[36:39], v[68:71]
    v_mfma_f32_16x16x32_bf16 v[76:79], v[204:207], v[36:39], v[76:79]
    v_mfma_f32_16x16x32_bf16 v[84:87], v[208:211], v[36:39], v[84:87]
    v_mfma_f32_16x16x32_bf16 v[92:95], v[212:215], v[36:39], v[92:95]
    v_mfma_f32_16x16x32_bf16 v[100:103], v[216:219], v[36:39], v[100:103]
    v_mfma_f32_16x16x32_bf16 v[108:111], v[220:223], v[36:39], v[108:111]
    v_mfma_f32_16x16x32_bf16 v[116:119], v[224:227], v[36:39], v[116:119]
    s_waitcnt vmcnt(1)
    v_mfma_f32_16x16x32_bf16 v[64:67], v[228:231], v[40:43], v[64:67]
    v_mfma_f32_16x16x32_bf16 v[72:75], v[232:235], v[40:43], v[72:75]
    v_mfma_f32_16x16x32_bf16 v[80:83], v[236:239], v[40:43], v[80:83]
    v_mfma_f32_16x16x32_bf16 v[88:91], v[240:243], v[40:43], v[88:91]
    v_mfma_f32_16x16x32_bf16 v[96:99], v[244:247], v[40:43], v[96:99]
    v_mfma_f32_16x16x32_bf16 v[104:107], v[248:251], v[40:43], v[104:107]
    v_mfma_f32_16x16x32_bf16 v[112:115], v[252:255], v[40:43], v[112:115]
    s_waitcnt vmcnt(0)
    v_mfma_f32_16x16x32_bf16 v[68:71], v[228:231], v[44:47], v[68:71]
    v_mfma_f32_16x16x32_bf16 v[76:79], v[232:235], v[44:47], v[76:79]
    v_mfma_f32_16x16x32_bf16 v[84:87], v[236:239], v[44:47], v[84:87]
    v_mfma_f32_16x16x32_bf16 v[92:95], v[240:243], v[44:47], v[92:95]
    v_mfma_f32_16x16x32_bf16 v[100:103], v[244:247], v[44:47], v[100:103]
    v_mfma_f32_16x16x32_bf16 v[108:111], v[248:251], v[44:47], v[108:111]
    v_mfma_f32_16x16x32_bf16 v[116:119], v[252:255], v[44:47], v[116:119]
    v_cvt_pk_bf16_f32 v64, v64, v65
    v_cvt_pk_bf16_f32 v65, v66, v67
    v_cvt_pk_bf16_f32 v66, v72, v73
    v_cvt_pk_bf16_f32 v67, v74, v75
    v_cvt_pk_bf16_f32 v68, v68, v69
    v_cvt_pk_bf16_f32 v69, v70, v71
    v_cvt_pk_bf16_f32 v70, v76, v77
    v_cvt_pk_bf16_f32 v71, v78, v79
    v_cvt_pk_bf16_f32 v80, v80, v81
    v_cvt_pk_bf16_f32 v81, v82, v83
    v_cvt_pk_bf16_f32 v82, v88, v89
    v_cvt_pk_bf16_f32 v83, v90, v91
    v_cvt_pk_bf16_f32 v84, v84, v85
    v_cvt_pk_bf16_f32 v85, v86, v87
    v_cvt_pk_bf16_f32 v86, v92, v93
    v_cvt_pk_bf16_f32 v87, v94, v95
    v_cvt_pk_bf16_f32 v96, v96, v97
    v_cvt_pk_bf16_f32 v97, v98, v99
    v_cvt_pk_bf16_f32 v98, v104, v105
    v_cvt_pk_bf16_f32 v99, v106, v107
    v_cvt_pk_bf16_f32 v100, v100, v101
    v_cvt_pk_bf16_f32 v101, v102, v103
    v_cvt_pk_bf16_f32 v102, v108, v109
    v_cvt_pk_bf16_f32 v103, v110, v111
    s_cmp_eq_u32 s29, 0
    s_cbranch_scc0 P_odd
    v_cvt_pk_bf16_f32 v112, v112, v113
    v_cvt_pk_bf16_f32 v113, v114, v115
    v_mov_b32 v114, 0
    v_mov_b32 v115, 0
    v_cvt_pk_bf16_f32 v116, v116, v117
    v_cvt_pk_bf16_f32 v117, v118, v119
    v_mov_b32 v118, 0
    v_mov_b32 v119, 0
    s_branch P_join
P_odd:
    v_cvt_pk_bf16_f32 v115, v114, v115
    v_cvt_pk_bf16_f32 v114, v112, v113
    v_mov_b32 v112, 0
    v_mov_b32 v113, 0
    v_cvt_pk_bf16_f32 v119, v118, v119
    v_cvt_pk_bf16_f32 v118, v116, v117
    v_mov_b32 v116, 0
    v_mov_b32 v117, 0
P_join:
    s_nop 1
    v_mfma_f32_16x16x32_bf16 v[72:75], v[48:51], v[64:67], 0
    v_mfma_f32_16x16x32_bf16 v[76:79], v[48:51], v[68:71], 0
    v_mfma_f32_16x16x32_bf16 v[88:91], v[52:55], v[68:71], 0
    v_mfma_f32_16x16x32_bf16 v[72:75], v[56:59], v[80:83], v[72:75]
    v_mfma_f32_16x16x32_bf16 v[76:79], v[56:59], v[84:87], v[76:79]
    v_mfma_f32_16x16x32_bf16 v[88:91], v[60:63], v[84:87], v[88:91]
    v_mfma_f32_16x16x32_bf16 v[72:75], v[32:35], v[96:99], v[72:75]
    v_mfma_f32_16x16x32_bf16 v[76:79], v[32:35], v[100:103], v[76:79]
    v_mfma_f32_16x16x32_bf16 v[88:91], v[36:39], v[100:103], v[88:91]
    v_mfma_f32_16x16x32_bf16 v[72:75], v[40:43], v[112:115], v[72:75]
    v_mfma_f32_16x16x32_bf16 v[76:79], v[40:43], v[116:119], v[76:79]
    v_mfma_f32_16x16x32_bf16 v[88:91], v[44:47], v[116:119], v[88:91]
    s_mul_i32 s24, s21, 14336
    s_add_u32 s24, s24, 65608704
    s_lshr_b32 s33, s50, 2
    s_add_u32 s72, s33, s24
    s_lshr_b32 s33, s51, 2
    s_add_u32 s73, s33, s24
    s_lshr_b32 s33, s52, 2
    s_add_u32 s74, s33, s24
    s_lshr_b32 s33, s53, 2
    s_add_u32 s75, s33, s24
P_poll:
    buffer_load_dwordx4 v[32:35], v7, s[4:7], s72 offen sc1
    buffer_load_dwordx4 v[36:39], v7, s[4:7], s73 offen sc1
    buffer_load_dwordx4 v[40:43], v7, s[4:7], s74 offen sc1
    buffer_load_dwordx4 v[44:47], v7, s[4:7], s75 offen sc1
    s_waitcnt vmcnt(0)
    v_max3_u32 v8, v32, v33, v34
    v_max3_u32 v8, v8, v35, v36
    v_max3_u32 v8, v8, v37, v38
    v_max3_u32 v8, v8, v39, v40
    v_max3_u32 v8, v8, v41, v42
    v_max3_u32 v8, v8, v43, v44
    v_max3_u32 v8, v8, v45, v46
    v_max_u32 v8, v8, v47
    v_cmp_eq_u32 vcc, -1, v8
    s_cbranch_vccz P_got
    s_sub_u32 s18, s18, 1
    s_cbranch_scc1 main_end2
    s_sleep 1
    s_branch P_poll
P_got:
    v_mfma_f32_16x16x32_bf16 v[92:95], v[32:35], v[64:67], 0
    v_mfma_f32_16x16x32_bf16 v[104:107], v[32:35], v[68:71], 0
    v_mfma_f32_16x16x32_bf16 v[92:95], v[36:39], v[80:83], v[92:95]
    v_mfma_f32_16x16x32_bf16 v[104:107], v[36:39], v[84:87], v[104:107]
    v_mfma_f32_16x16x32_bf16 v[92:95], v[40:43], v[96:99], v[92:95]
    v_mfma_f32_16x16x32_bf16 v[104:107], v[40:43], v[100:103], v[104:107]
    v_mfma_f32_16x16x32_bf16 v[92:95], v[44:47], v[112:115], v[92:95]
    v_mfma_f32_16x16x32_bf16 v[104:107], v[44:47], v[116:119], v[104:107]
    ds_write_b128 v12, v[72:75] offset:0
    ds_write_b128 v12, v[76:79] offset:1024
    ds_write_b128 v12, v[88:91] offset:2048
    s_nop 3
    ds_write_b128 v12, v[92:95] offset:3072
    ds_write_b128 v12, v[104:107] offset:4096
    v_xor_b32 v12, 0x8000, v12
    s_waitcnt lgkmcnt(0)
    s_barrier
    s_cmp_lt_u32 s16, 2
    s_cbranch_scc0 P_next
    ds_read_b128 v[32:35], v13 offset:0
    ds_read_b128 v[36:39], v13 offset:5120
    ds_read_b128 v[40:43], v13 offset:10240
    ds_read_b128 v[44:47], v13 offset:15360
    ds_read_b128 v[48:51], v14 offset:2048
    ds_read_b128 v[52:55], v14 offset:7168
    ds_read_b128 v[56:59], v14 offset:12288
    ds_read_b128 v[60:63], v14 offset:17408
    ds_read_b128 v[64:67], v13 offset:3072
    ds_read_b128 v[68:71], v13 offset:8192
    ds_read_b128 v[72:75], v13 offset:13312
    ds_read_b128 v[76:79], v13 offset:18432
    s_mul_i32 s24, s21, 40960
    s_add_u32 s24, s24, 67174400
    s_lshr_b32 s25, s22, 2
    s_lshl_b32 s25, s25, 1
    s_add_u32 s25, s25, s16
    s_lshl_b32 s25, s25, 2
    s_and_b32 s33, s22, 3
    s_add_u32 s25, s25, s33
    s_lshl_b32 s25, s25, 8
    s_add_u32 s25, s25, s24
    s_add_u32 s25, s25, 32768
    s_lshl_b32 s33, s22, 1
    s_add_u32 s33, s33, s16
    s_lshl_b32 s33, s33, 10
    s_add_u32 s24, s24, s33
    s_waitcnt lgkmcnt(8)
    v_add_f32 v32, v32, v36
    v_add_f32 v40, v40, v44
    v_add_f32 v32, v32, v40
    v_add_f32 v33, v33, v37
    v_add_f32 v41, v41, v45
    v_add_f32 v33, v33, v41
    v_add_f32 v34, v34, v38
    v_add_f32 v42, v42, v46
    v_add_f32 v34, v34, v42
    v_add_f32 v35, v35, v39
    v_add_f32 v43, v43, v47
    v_add_f32 v35, v35, v43
    v_cmp_le_i32 vcc, 0, v15
    s_nop 1
    v_cndmask_b32 v32, v18, v32, vcc
    v_cmp_le_i32 vcc, 1, v15
    s_nop 1
    v_cndmask_b32 v33, v18, v33, vcc
    v_cmp_le_i32 vcc, 2, v15
    s_nop 1
    v_cndmask_b32 v34, v18, v34, vcc
    v_cmp_le_i32 vcc, 3, v15
    s_nop 1
    v_cndmask_b32 v35, v18, v35, vcc
    s_waitcnt lgkmcnt(4)
    v_add_f32 v48, v48, v52
    v_add_f32 v56, v56, v60
    v_add_f32 v48, v48, v56
    v_add_f32 v49, v49, v53
    v_add_f32 v57, v57, v61
    v_add_f32 v49, v49, v57
    v_add_f32 v50, v50, v54
    v_add_f32 v58, v58, v62
    v_add_f32 v50, v50, v58
    v_add_f32 v51, v51, v55
    v_add_f32 v59, v59, v63
    v_add_f32 v51, v51, v59
    v_cmp_le_i32 vcc, 16, v15
    s_nop 1
    v_cndmask_b32 v48, v18, v48, vcc
    v_cmp_le_i32 vcc, 17, v15
    s_nop 1
    v_cndmask_b32 v49, v18, v49, vcc
    v_cmp_le_i32 vcc, 18, v15
    s_nop 1
    v_cndmask_b32 v50, v18, v50, vcc
    v_cmp_le_i32 vcc, 19, v15
    s_nop 1
    v_cndmask_b32 v51, v18, v51, vcc
    s_waitcnt lgkmcnt(0)
    v_add_f32 v64, v64, v68
    v_add_f32 v72, v72, v76
    v_add_f32 v64, v64, v72
    v_add_f32 v65, v65, v69
    v_add_f32 v73, v73, v77
    v_add_f32 v65, v65, v73
    v_add_f32 v66, v66, v70
    v_add_f32 v74, v74, v78
    v_add_f32 v66, v66, v74
    v_add_f32 v67, v67, v71
    v_add_f32 v75, v75, v79
    v_add_f32 v67, v67, v75
    v_max3_f32 v8, v32, v33, v34
    v_max3_f32 v8, v8, v35, v48
    v_max3_f32 v8, v8, v49, v50
    v_max3_f32 v8, v8, v51, v64
    v_max3_f32 v8, v8, v65, v66
    v_max_f32 v8, v8, v67
    v_mov_b32 v9, v8
    s_nop 1
    v_permlane16_swap_b32 v8, v9
    v_max_f32 v8, v8, v9
    v_mov_b32 v9, v8
    s_nop 1
    v_permlane32_swap_b32 v8, v9
    v_max_f32 v8, v8, v9
    v_sub_f32 v32, v32, v8
    v_sub_f32 v33, v33, v8
    v_sub_f32 v34, v34, v8
    v_sub_f32 v35, v35, v8
    v_sub_f32 v48, v48, v8
    v_sub_f32 v49, v49, v8
    v_sub_f32 v50, v50, v8
    v_sub_f32 v51, v51, v8
    v_sub_f32 v64, v64, v8
    v_sub_f32 v65, v65, v8
    v_sub_f32 v66, v66, v8
    v_sub_f32 v67, v67, v8
    v_exp_f32 v32, v32
    v_exp_f32 v33, v33
    v_exp_f32 v34, v34
    v_exp_f32 v35, v35
    v_exp_f32 v48, v48
    v_exp_f32 v49, v49
    v_exp_f32 v50, v50
    v_exp_f32 v51, v51
    v_exp_f32 v64, v64
    v_exp_f32 v65, v65
    v_exp_f32 v66, v66
    v_exp_f32 v67, v67
    v_add_f32 v10, v64, v65
    v_add_f32 v11, v66, v67
    v_add_f32 v10, v10, v11
    v_cndmask_b32 v10, 0, v10, s[36:37]
    v_add_f32 v10, v10, v32
    v_add_f32 v10, v10, v33
    v_add_f32 v10, v10, v34
    v_add_f32 v10, v10, v35
    v_add_f32 v10, v10, v48
    v_add_f32 v10, v10, v49
    v_add_f32 v10, v10, v50
    v_add_f32 v10, v10, v51
    v_mov_b32 v9, v10
    s_nop 1
    v_permlane16_swap_b32 v10, v9
    v_add_f32 v10, v10, v9
    v_mov_b32 v9, v10
    s_nop 1
    v_permlane32_swap_b32 v10, v9
    v_add_f32 v10, v10, v9
    v_rcp_f32 v10, v10
    s_nop 0
    v_mul_f32 v32, v32, v10
    v_mul_f32 v33, v33, v10
    v_mul_f32 v34, v34, v10
    v_mul_f32 v35, v35, v10
    v_mul_f32 v48, v48, v10
    v_mul_f32 v49, v49, v10
    v_mul_f32 v50, v50, v10
    v_mul_f32 v51, v51, v10
    v_mul_f32 v64, v64, v10
    v_mul_f32 v65, v65, v10
    v_mul_f32 v66, v66, v10
    v_mul_f32 v67, v67, v10
    v_cvt_pk_bf16_f32 v36, v32, v33
    v_cvt_pk_bf16_f32 v37, v34, v35
    v_cvt_pk_bf16_f32 v38, v48, v49
    v_cvt_pk_bf16_f32 v39, v50, v51
    v_cvt_pk_bf16_f32 v40, v64, v65
    v_cvt_pk_bf16_f32 v41, v66, v67
    v_min_u32 v36, -2, v36
    v_min_u32 v37, -2, v37
    v_min_u32 v38, -2, v38
    v_min_u32 v39, -2, v39
    v_min_u32 v40, -2, v40
    v_min_u32 v41, -2, v41
    buffer_store_dwordx4 v[36:39], v1, s[4:7], s24 offen sc1
    buffer_store_dwordx2 v[40:41], v16, s[4:7], s25 offen sc1
P_next:
    v_xor_b32 v13, 0x8000, v13
    v_xor_b32 v14, 0x8000, v14
    s_add_u32 s21, s21, 4
    s_cmp_lt_u32 s21, 64
    s_cbranch_scc1 P_loop
    s_endpgm
role_H:
    s_sub_u32 s27, s17, 160
    s_lshr_b32 s22, s27, 2
    s_and_b32 s21, s27, 3
    s_add_u32 s20, s22, 32
    s_lshr_b32 s30, s17, 5
    s_lshl_b32 s30, s30, 7
    s_add_u32 s30, s30, 69833728
    v_mov_b32 v9, s30
    s_cmp_eq_u32 s16, 0
    s_cbranch_scc0 wad_27
wa_26:
    buffer_load_dword v8, v9, s[4:7], 0 offen sc1
    s_waitcnt vmcnt(0)
    v_cmp_eq_u32 vcc, 0, v8
    s_cbranch_vccz wad_27
    s_sub_u32 s18, s18, 1
    s_cbranch_scc1 main_end2
    s_sleep 8
    s_branch wa_26
wad_27:
    s_waitcnt vmcnt(0)
    s_barrier
    s_lshr_b32 s28, s16, 1
    s_mul_i32 s28, s28, 7
    s_and_b32 s29, s16, 1
    s_cmp_eq_u32 s29, 0
    s_cselect_b32 s30, 4, 16
    s_add_u32 s30, s30, s28
    s_sub_u32 s31, s30, 14
    s_cselect_b32 s30, s30, s31
    s_sub_u32 s31, s30, 14
    s_cselect_b32 s30, s30, s31
    s_lshl_b32 s40, s30, 11
    s_cmp_eq_u32 s29, 0
    s_cselect_b32 s30, 5, 15
    s_add_u32 s30, s30, s28
    s_sub_u32 s31, s30, 14
    s_cselect_b32 s30, s30, s31
    s_sub_u32 s31, s30, 14
    s_cselect_b32 s30, s30, s31
    s_lshl_b32 s41, s30, 11
    s_cmp_eq_u32 s29, 0
    s_cselect_b32 s30, 6, 14
    s_add_u32 s30, s30, s28
    s_sub_u32 s31, s30, 14
    s_cselect_b32 s30, s30, s31
    s_sub_u32 s31, s30, 14
    s_cselect_b32 s30, s30, s31
    s_lshl_b32 s42, s30, 11
    s_cmp_eq_u32 s29, 0
    s_cselect_b32 s30, 7, 13
    s_add_u32 s30, s30, s28
    s_sub_u32 s31, s30, 14
    s_cselect_b32 s30, s30, s31
    s_sub_u32 s31, s30, 14
    s_cselect_b32 s30, s30, s31
    s_lshl_b32 s43, s30, 11
    s_cmp_eq_u32 s29, 0
    s_cselect_b32 s30, 8, 12
    s_add_u32 s30, s30, s28
    s_sub_u32 s31, s30, 14
    s_cselect_b32 s30, s30, s31
    s_sub_u32 s31, s30, 14
    s_cselect_b32 s30, s30, s31
    s_lshl_b32 s44, s30, 11
    s_cmp_eq_u32 s29, 0
    s_cselect_b32 s30, 9, 11
    s_add_u32 s30, s30, s28
    s_sub_u32 s31, s30, 14
    s_cselect_b32 s30, s30, s31
    s_sub_u32 s31, s30, 14
    s_cselect_b32 s30, s30, s31
    s_lshl_b32 s45, s30, 11
    s_cmp_eq_u32 s29, 0
    s_cselect_b32 s30, 10, 10
    s_add_u32 s30, s30, s28
    s_sub_u32 s31, s30, 14
    s_cselect_b32 s30, s30, s31
    s_sub_u32 s31, s30, 14
    s_cselect_b32 s30, s30, s31
    s_lshl_b32 s46, s30, 11
    s_cmp_eq_u32 s29, 0
    s_cselect_b32 s30, 11, 9
    s_add_u32 s30, s30, s28
    s_sub_u32 s31, s30, 14
    s_cselect_b32 s30, s30, s31
    s_sub_u32 s31, s30, 14
    s_cselect_b32 s30, s30, s31
    s_lshl_b32 s47, s30, 11
    s_cmp_eq_u32 s29, 0
    s_cselect_b32 s30, 12, 8
    s_add_u32 s30, s30, s28
    s_sub_u32 s31, s30, 14
    s_cselect_b32 s30, s30, s31
    s_sub_u32 s31, s30, 14
    s_cselect_b32 s30, s30, s31
    s_lshl_b32 s48, s30, 11
    s_cmp_eq_u32 s29, 0
    s_cselect_b32 s30, 13, 7
    s_add_u32 s30, s30, s28
    s_sub_u32 s31, s30, 14
    s_cselect_b32 s30, s30, s31
    s_sub_u32 s31, s30, 14
    s_cselect_b32 s30, s30, s31
    s_lshl_b32 s49, s30, 11
    s_cmp_eq_u32 s29, 0
    s_cselect_b32 s30, 14, 6
    s_add_u32 s30, s30, s28
    s_sub_u32 s31, s30, 14
    s_cselect_b32 s30, s30, s31
    s_sub_u32 s31, s30, 14
    s_cselect_b32 s30, s30, s31
    s_lshl_b32 s50, s30, 11
    s_cmp_eq_u32 s29, 0
    s_cselect_b32 s30, 15, 5
    s_add_u32 s30, s30, s28
    s_sub_u32 s31, s30, 14
    s_cselect_b32 s30, s30, s31
    s_sub_u32 s31, s30, 14
    s_cselect_b32 s30, s30, s31
    s_lshl_b32 s51, s30, 11
    s_cmp_eq_u32 s29, 0
    s_cselect_b32 s30, 16, 4
    s_add_u32 s30, s30, s28
    s_sub_u32 s31, s30, 14
    s_cselect_b32 s30, s30, s31
    s_sub_u32 s31, s30, 14
    s_cselect_b32 s30, s30, s31
    s_lshl_b32 s52, s30, 11
    s_cmp_eq_u32 s29, 0
    s_cselect_b32 s30, 17, 3
    s_add_u32 s30, s30, s28
    s_sub_u32 s31, s30, 14
    s_cselect_b32 s30, s30, s31
    s_sub_u32 s31, s30, 14
    s_cselect_b32 s30, s30, s31
    s_lshl_b32 s53, s30, 11
    s_lshr_b32 s56, s50, 10
    s_add_u32 s57, s56, 1
    s_lshr_b32 s58, s51, 10
    s_add_u32 s59, s58, 1
    s_lshr_b32 s60, s52, 10
    s_add_u32 s61, s60, 1
    s_lshr_b32 s62, s53, 10
    s_add_u32 s62, s62, s29
    v_lshlrev_b32 v1, 4, v0
    v_lshrrev_b32 v3, 4, v0
    v_and_b32 v4, 15, v0
    v_lshlrev_b32 v2, 9, v3
    v_lshl_add_u32 v2, v4, 4, v2
    s_mul_i32 s30, s20, 401408
    s_mul_i32 s64, s56, 14336
    s_add_u32 s64, s64, s30
    s_mul_i32 s65, s57, 14336
    s_add_u32 s65, s65, s30
    s_mul_i32 s66, s58, 14336
    s_add_u32 s66, s66, s30
    s_mul_i32 s67, s59, 14336
    s_add_u32 s67, s67, s30
    s_mul_i32 s68, s60, 14336
    s_add_u32 s68, s68, s30
    s_mul_i32 s69, s61, 14336
    s_add_u32 s69, s69, s30
    s_mul_i32 s70, s62, 14336
    s_add_u32 s70, s70, s30
    s_lshr_b32 s31, s40, 1
    s_add_u32 s33, s31, s64
    buffer_load_dwordx4 a[0:3], v1, s[4:7], s33 offen
    s_add_u32 s33, s31, s65
    buffer_load_dwordx4 a[4:7], v1, s[4:7], s33 offen
    s_add_u32 s33, s31, s66
    buffer_load_dwordx4 a[8:11], v1, s[4:7], s33 offen
    s_add_u32 s33, s31, s67
    buffer_load_dwordx4 a[12:15], v1, s[4:7], s33 offen
    s_add_u32 s33, s31, s68
    buffer_load_dwordx4 a[16:19], v1, s[4:7], s33 offen
    s_add_u32 s33, s31, s69
    buffer_load_dwordx4 a[20:23], v1, s[4:7], s33 offen
    s_add_u32 s33, s31, s70
    buffer_load_dwordx4 a[24:27], v1, s[4:7], s33 offen
    s_lshr_b32 s31, s41, 1
    s_add_u32 s33, s31, s64
    buffer_load_dwordx4 a[28:31], v1, s[4:7], s33 offen
    s_add_u32 s33, s31, s65
    buffer_load_dwordx4 a[32:35], v1, s[4:7], s33 offen
    s_add_u32 s33, s31, s66
    buffer_load_dwordx4 a[36:39], v1, s[4:7], s33 offen
    s_add_u32 s33, s31, s67
    buffer_load_dwordx4 a[40:43], v1, s[4:7], s33 offen
    s_add_u32 s33, s31, s68
    buffer_load_dwordx4 a[44:47], v1, s[4:7], s33 offen
    s_add_u32 s33, s31, s69
    buffer_load_dwordx4 a[48:51], v1, s[4:7], s33 offen
    s_add_u32 s33, s31, s70
    buffer_load_dwordx4 a[52:55], v1, s[4:7], s33 offen
    s_lshr_b32 s31, s42, 1
    s_add_u32 s33, s31, s64
    buffer_load_dwordx4 a[56:59], v1, s[4:7], s33 offen
    s_add_u32 s33, s31, s65
    buffer_load_dwordx4 a[60:63], v1, s[4:7], s33 offen
    s_add_u32 s33, s31, s66
    buffer_load_dwordx4 a[64:67], v1, s[4:7], s33 offen
    s_add_u32 s33, s31, s67
    buffer_load_dwordx4 a[68:71], v1, s[4:7], s33 offen
    s_add_u32 s33, s31, s68
    buffer_load_dwordx4 a[72:75], v1, s[4:7], s33 offen
    s_add_u32 s33, s31, s69
    buffer_load_dwordx4 a[76:79], v1, s[4:7], s33 offen
    s_add_u32 s33, s31, s70
    buffer_load_dwordx4 a[80:83], v1, s[4:7], s33 offen
    s_lshr_b32 s31, s43, 1
    s_add_u32 s33, s31, s64
    buffer_load_dwordx4 a[84:87], v1, s[4:7], s33 offen
    s_add_u32 s33, s31, s65
    buffer_load_dwordx4 a[88:91], v1, s[4:7], s33 offen
    s_add_u32 s33, s31, s66
    buffer_load_dwordx4 a[92:95], v1, s[4:7], s33 offen
    s_add_u32 s33, s31, s67
    buffer_load_dwordx4 a[96:99], v1, s[4:7], s33 offen
    s_add_u32 s33, s31, s68
    buffer_load_dwordx4 a[100:103], v1, s[4:7], s33 offen
    s_add_u32 s33, s31, s69
    buffer_load_dwordx4 a[104:107], v1, s[4:7], s33 offen
    s_add_u32 s33, s31, s70
    buffer_load_dwordx4 a[108:111], v1, s[4:7], s33 offen
    s_lshr_b32 s31, s44, 1
    s_add_u32 s33, s31, s64
    buffer_load_dwordx4 a[112:115], v1, s[4:7], s33 offen
    s_add_u32 s33, s31, s65
    buffer_load_dwordx4 a[116:119], v1, s[4:7], s33 offen
    s_add_u32 s33, s31, s66
    buffer_load_dwordx4 a[120:123], v1, s[4:7], s33 offen
    s_add_u32 s33, s31, s67
    buffer_load_dwordx4 a[124:127], v1, s[4:7], s33 offen
    s_add_u32 s33, s31, s68
    buffer_load_dwordx4 a[128:131], v1, s[4:7], s33 offen
    s_add_u32 s33, s31, s69
    buffer_load_dwordx4 a[132:135], v1, s[4:7], s33 offen
    s_add_u32 s33, s31, s70
    buffer_load_dwordx4 a[136:139], v1, s[4:7], s33 offen
    s_lshr_b32 s31, s45, 1
    s_add_u32 s33, s31, s64
    buffer_load_dwordx4 a[140:143], v1, s[4:7], s33 offen
    s_add_u32 s33, s31, s65
    buffer_load_dwordx4 a[144:147], v1, s[4:7], s33 offen
    s_add_u32 s33, s31, s66
    buffer_load_dwordx4 a[148:151], v1, s[4:7], s33 offen
    s_add_u32 s33, s31, s67
    buffer_load_dwordx4 a[152:155], v1, s[4:7], s33 offen
    s_add_u32 s33, s31, s68
    buffer_load_dwordx4 a[156:159], v1, s[4:7], s33 offen
    s_add_u32 s33, s31, s69
    buffer_load_dwordx4 a[160:163], v1, s[4:7], s33 offen
    s_add_u32 s33, s31, s70
    buffer_load_dwordx4 a[164:167], v1, s[4:7], s33 offen
    s_lshr_b32 s31, s46, 1
    s_add_u32 s33, s31, s64
    buffer_load_dwordx4 a[168:171], v1, s[4:7], s33 offen
    s_add_u32 s33, s31, s65
    buffer_load_dwordx4 a[172:175], v1, s[4:7], s33 offen
    s_add_u32 s33, s31, s66
    buffer_load_dwordx4 a[176:179], v1, s[4:7], s33 offen
    s_add_u32 s33, s31, s67
    buffer_load_dwordx4 a[180:183], v1, s[4:7], s33 offen
    s_add_u32 s33, s31, s68
    buffer_load_dwordx4 a[184:187], v1, s[4:7], s33 offen
    s_add_u32 s33, s31, s69
    buffer_load_dwordx4 a[188:191], v1, s[4:7], s33 offen
    s_add_u32 s33, s31, s70
    buffer_load_dwordx4 a[192:195], v1, s[4:7], s33 offen
    s_lshr_b32 s31, s47, 1
    s_add_u32 s33, s31, s64
    buffer_load_dwordx4 a[196:199], v1, s[4:7], s33 offen
    s_add_u32 s33, s31, s65
    buffer_load_dwordx4 a[200:203], v1, s[4:7], s33 offen
    s_add_u32 s33, s31, s66
    buffer_load_dwordx4 a[204:207], v1, s[4:7], s33 offen
    s_add_u32 s33, s31, s67
    buffer_load_dwordx4 a[208:211], v1, s[4:7], s33 offen
    s_add_u32 s33, s31, s68
    buffer_load_dwordx4 a[212:215], v1, s[4:7], s33 offen
    s_add_u32 s33, s31, s69
    buffer_load_dwordx4 a[216:219], v1, s[4:7], s33 offen
    s_add_u32 s33, s31, s70
    buffer_load_dwordx4 a[220:223], v1, s[4:7], s33 offen
    s_lshr_b32 s31, s48, 1
    s_add_u32 s33, s31, s64
    buffer_load_dwordx4 a[224:227], v1, s[4:7], s33 offen
    s_add_u32 s33, s31, s65
    buffer_load_dwordx4 a[228:231], v1, s[4:7], s33 offen
    s_add_u32 s33, s31, s66
    buffer_load_dwordx4 a[232:235], v1, s[4:7], s33 offen
    s_add_u32 s33, s31, s67
    buffer_load_dwordx4 a[236:239], v1, s[4:7], s33 offen
    s_add_u32 s33, s31, s68
    buffer_load_dwordx4 a[240:243], v1, s[4:7], s33 offen
    s_add_u32 s33, s31, s69
    buffer_load_dwordx4 a[244:247], v1, s[4:7], s33 offen
    s_add_u32 s33, s31, s70
    buffer_load_dwordx4 a[248:251], v1, s[4:7], s33 offen
    s_lshr_b32 s31, s49, 1
    s_add_u32 s33, s31, s64
    buffer_load_dwordx4 a[252:255], v1, s[4:7], s33 offen
    s_add_u32 s33, s31, s65
    buffer_load_dwordx4 v[120:123], v1, s[4:7], s33 offen
    s_add_u32 s33, s31, s66
    buffer_load_dwordx4 v[124:127], v1, s[4:7], s33 offen
    s_add_u32 s33, s31, s67
    buffer_load_dwordx4 v[128:131], v1, s[4:7], s33 offen
    s_add_u32 s33, s31, s68
    buffer_load_dwordx4 v[132:135], v1, s[4:7], s33 offen
    s_add_u32 s33, s31, s69
    buffer_load_dwordx4 v[136:139], v1, s[4:7], s33 offen
    s_add_u32 s33, s31, s70
    buffer_load_dwordx4 v[140:143], v1, s[4:7], s33 offen
    s_lshr_b32 s31, s50, 1
    s_add_u32 s33, s31, s64
    buffer_load_dwordx4 v[144:147], v1, s[4:7], s33 offen
    s_add_u32 s33, s31, s65
    buffer_load_dwordx4 v[148:151], v1, s[4:7], s33 offen
    s_add_u32 s33, s31, s66
    buffer_load_dwordx4 v[152:155], v1, s[4:7], s33 offen
    s_add_u32 s33, s31, s67
    buffer_load_dwordx4 v[156:159], v1, s[4:7], s33 offen
    s_add_u32 s33, s31, s68
    buffer_load_dwordx4 v[160:163], v1, s[4:7], s33 offen
    s_add_u32 s33, s31, s69
    buffer_load_dwordx4 v[164:167], v1, s[4:7], s33 offen
    s_add_u32 s33, s31, s70
    buffer_load_dwordx4 v[168:171], v1, s[4:7], s33 offen
    s_lshr_b32 s31, s51, 1
    s_add_u32 s33, s31, s64
    buffer_load_dwordx4 v[172:175], v1, s[4:7], s33 offen
    s_add_u32 s33, s31, s65
    buffer_load_dwordx4 v[176:179], v1, s[4:7], s33 offen
    s_add_u32 s33, s31, s66
    buffer_load_dwordx4 v[180:183], v1, s[4:7], s33 offen
    s_add_u32 s33, s31, s67
    buffer_load_dwordx4 v[184:187], v1, s[4:7], s33 offen
    s_add_u32 s33, s31, s68
    buffer_load_dwordx4 v[188:191], v1, s[4:7], s33 offen
    s_add_u32 s33, s31, s69
    buffer_load_dwordx4 v[192:195], v1, s[4:7], s33 offen
    s_add_u32 s33, s31, s70
    buffer_load_dwordx4 v[196:199], v1, s[4:7], s33 offen
    s_lshr_b32 s31, s52, 1
    s_add_u32 s33, s31, s64
    buffer_load_dwordx4 v[200:203], v1, s[4:7], s33 offen
    s_add_u32 s33, s31, s65
    buffer_load_dwordx4 v[204:207], v1, s[4:7], s33 offen
    s_add_u32 s33, s31, s66
    buffer_load_dwordx4 v[208:211], v1, s[4:7], s33 offen
    s_add_u32 s33, s31, s67
    buffer_load_dwordx4 v[212:215], v1, s[4:7], s33 offen
    s_add_u32 s33, s31, s68
    buffer_load_dwordx4 v[216:219], v1, s[4:7], s33 offen
    s_add_u32 s33, s31, s69
    buffer_load_dwordx4 v[220:223], v1, s[4:7], s33 offen
    s_add_u32 s33, s31, s70
    buffer_load_dwordx4 v[224:227], v1, s[4:7], s33 offen
    s_lshr_b32 s31, s53, 1
    s_add_u32 s33, s31, s64
    buffer_load_dwordx4 v[228:231], v1, s[4:7], s33 offen
    s_add_u32 s33, s31, s65
    buffer_load_dwordx4 v[232:235], v1, s[4:7], s33 offen
    s_add_u32 s33, s31, s66
    buffer_load_dwordx4 v[236:239], v1, s[4:7], s33 offen
    s_add_u32 s33, s31, s67
    buffer_load_dwordx4 v[240:243], v1, s[4:7], s33 offen
    s_add_u32 s33, s31, s68
    buffer_load_dwordx4 v[244:247], v1, s[4:7], s33 offen
    s_add_u32 s33, s31, s69
    buffer_load_dwordx4 v[248:251], v1, s[4:7], s33 offen
    s_add_u32 s33, s31, s70
    buffer_load_dwordx4 v[252:255], v1, s[4:7], s33 offen
    s_lshl_b32 s34, s29, 3
    v_add_u32 v7, s34, v2
H_loop:
    s_mul_i32 s23, s21, 28672
    s_add_u32 s23, s23, 16056320
    s_add_u32 s33, s23, s40
    buffer_load_dwordx4 v[32:35], v2, s[4:7], s33 offen offset:0
    s_add_u32 s33, s23, s40
    buffer_load_dwordx4 v[36:39], v2, s[4:7], s33 offen offset:256
    s_add_u32 s33, s23, s41
    buffer_load_dwordx4 v[40:43], v2, s[4:7], s33 offen offset:0
    s_add_u32 s33, s23, s41
    buffer_load_dwordx4 v[44:47], v2, s[4:7], s33 offen offset:256
    s_add_u32 s33, s23, s42
    buffer_load_dwordx4 v[48:51], v2, s[4:7], s33 offen offset:0
    s_add_u32 s33, s23, s42
    buffer_load_dwordx4 v[52:55], v2, s[4:7], s33 offen offset:256
    s_add_u32 s33, s23, s43
    buffer_load_dwordx4 v[56:59], v2, s[4:7], s33 offen offset:0
    s_add_u32 s33, s23, s43
    buffer_load_dwordx4 v[60:63], v2, s[4:7], s33 offen offset:256
    s_waitcnt vmcnt(7)
    v_mfma_f32_16x16x32_bf16 v[64:67], a[0:3], v[32:35], 0
    v_mfma_f32_16x16x32_bf16 v[72:75], a[4:7], v[32:35], 0
    v_mfma_f32_16x16x32_bf16 v[80:83], a[8:11], v[32:35], 0
    v_mfma_f32_16x16x32_bf16 v[88:91], a[12:15], v[32:35], 0
    v_mfma_f32_16x16x32_bf16 v[96:99], a[16:19], v[32:35], 0
    v_mfma_f32_16x16x32_bf16 v[104:107], a[20:23], v[32:35], 0
    v_mfma_f32_16x16x32_bf16 v[112:115], a[24:27], v[32:35], 0
    s_add_u32 s33, s23, s44
    buffer_load_dwordx4 v[32:35], v2, s[4:7], s33 offen offset:0
    s_waitcnt vmcnt(7)
    v_mfma_f32_16x16x32_bf16 v[68:71], a[0:3], v[36:39], 0
    v_mfma_f32_16x16x32_bf16 v[76:79], a[4:7], v[36:39], 0
    v_mfma_f32_16x16x32_bf16 v[84:87], a[8:11], v[36:39], 0
    v_mfma_f32_16x16x32_bf16 v[92:95], a[12:15], v[36:39], 0
    v_mfma_f32_16x16x32_bf16 v[100:103], a[16:19], v[36:39], 0
    v_mfma_f32_16x16x32_bf16 v[108:111], a[20:23], v[36:39], 0
    v_mfma_f32_16x16x32_bf16 v[116:119], a[24:27], v[36:39], 0
    s_add_u32 s33, s23, s44
    buffer_load_dwordx4 v[36:39], v2, s[4:7], s33 offen offset:256
    s_waitcnt vmcnt(7)
    v_mfma_f32_16x16x32_bf16 v[64:67], a[28:31], v[40:43], v[64:67]
    v_mfma_f32_16x16x32_bf16 v[72:75], a[32:35], v[40:43], v[72:75]
    v_mfma_f32_16x16x32_bf16 v[80:83], a[36:39], v[40:43], v[80:83]
    v_mfma_f32_16x16x32_bf16 v[88:91], a[40:43], v[40:43], v[88:91]
    v_mfma_f32_16x16x32_bf16 v[96:99], a[44:47], v[40:43], v[96:99]
    v_mfma_f32_16x16x32_bf16 v[104:107], a[48:51], v[40:43], v[104:107]
    v_mfma_f32_16x16x32_bf16 v[112:115], a[52:55], v[40:43], v[112:115]
    s_add_u32 s33, s23, s45
    buffer_load_dwordx4 v[40:43], v2, s[4:7], s33 offen offset:0
    s_waitcnt vmcnt(7)
    v_mfma_f32_16x16x32_bf16 v[68:71], a[28:31], v[44:47], v[68:71]
    v_mfma_f32_16x16x32_bf16 v[76:79], a[32:35], v[44:47], v[76:79]
    v_mfma_f32_16x16x32_bf16 v[84:87], a[36:39], v[44:47], v[84:87]
    v_mfma_f32_16x16x32_bf16 v[92:95], a[40:43], v[44:47], v[92:95]
    v_mfma_f32_16x16x32_bf16 v[100:103], a[44:47], v[44:47], v[100:103]
    v_mfma_f32_16x16x32_bf16 v[108:111], a[48:51], v[44:47], v[108:111]
    v_mfma_f32_16x16x32_bf16 v[116:119], a[52:55], v[44:47], v[116:119]
    s_add_u32 s33, s23, s45
    buffer_load_dwordx4 v[44:47], v2, s[4:7], s33 offen offset:256
    s_waitcnt vmcnt(7)
    v_mfma_f32_16x16x32_bf16 v[64:67], a[56:59], v[48:51], v[64:67]
    v_mfma_f32_16x16x32_bf16 v[72:75], a[60:63], v[48:51], v[72:75]
    v_mfma_f32_16x16x32_bf16 v[80:83], a[64:67], v[48:51], v[80:83]
    v_mfma_f32_16x16x32_bf16 v[88:91], a[68:71], v[48:51], v[88:91]
    v_mfma_f32_16x16x32_bf16 v[96:99], a[72:75], v[48:51], v[96:99]
    v_mfma_f32_16x16x32_bf16 v[104:107], a[76:79], v[48:51], v[104:107]
    v_mfma_f32_16x16x32_bf16 v[112:115], a[80:83], v[48:51], v[112:115]
    s_add_u32 s33, s23, s46
    buffer_load_dwordx4 v[48:51], v2, s[4:7], s33 offen offset:0
    s_waitcnt vmcnt(7)
    v_mfma_f32_16x16x32_bf16 v[68:71], a[56:59], v[52:55], v[68:71]
    v_mfma_f32_16x16x32_bf16 v[76:79], a[60:63], v[52:55], v[76:79]
    v_mfma_f32_16x16x32_bf16 v[84:87], a[64:67], v[52:55], v[84:87]
    v_mfma_f32_16x16x32_bf16 v[92:95], a[68:71], v[52:55], v[92:95]
    v_mfma_f32_16x16x32_bf16 v[100:103], a[72:75], v[52:55], v[100:103]
    v_mfma_f32_16x16x32_bf16 v[108:111], a[76:79], v[52:55], v[108:111]
    v_mfma_f32_16x16x32_bf16 v[116:119], a[80:83], v[52:55], v[116:119]
    s_add_u32 s33, s23, s46
    buffer_load_dwordx4 v[52:55], v2, s[4:7], s33 offen offset:256
    s_waitcnt vmcnt(7)
    v_mfma_f32_16x16x32_bf16 v[64:67], a[84:87], v[56:59], v[64:67]
    v_mfma_f32_16x16x32_bf16 v[72:75], a[88:91], v[56:59], v[72:75]
    v_mfma_f32_16x16x32_bf16 v[80:83], a[92:95], v[56:59], v[80:83]
    v_mfma_f32_16x16x32_bf16 v[88:91], a[96:99], v[56:59], v[88:91]
    v_mfma_f32_16x16x32_bf16 v[96:99], a[100:103], v[56:59], v[96:99]
    v_mfma_f32_16x16x32_bf16 v[104:107], a[104:107], v[56:59], v[104:107]
    v_mfma_f32_16x16x32_bf16 v[112:115], a[108:111], v[56:59], v[112:115]
    s_add_u32 s33, s23, s47
    buffer_load_dwordx4 v[56:59], v2, s[4:7], s33 offen offset:0
    s_waitcnt vmcnt(7)
    v_mfma_f32_16x16x32_bf16 v[68:71], a[84:87], v[60:63], v[68:71]
    v_mfma_f32_16x16x32_bf16 v[76:79], a[88:91], v[60:63], v[76:79]
    v_mfma_f32_16x16x32_bf16 v[84:87], a[92:95], v[60:63], v[84:87]
    v_mfma_f32_16x16x32_bf16 v[92:95], a[96:99], v[60:63], v[92:95]
    v_mfma_f32_16x16x32_bf16 v[100:103], a[100:103], v[60:63], v[100:103]
    v_mfma_f32_16x16x32_bf16 v[108:111], a[104:107], v[60:63], v[108:111]
    v_mfma_f32_16x16x32_bf16 v[116:119], a[108:111], v[60:63], v[116:119]
    s_add_u32 s33, s23, s47
    buffer_load_dwordx4 v[60:63], v2, s[4:7], s33 offen offset:256
    s_waitcnt vmcnt(7)
    v_mfma_f32_16x16x32_bf16 v[64:67], a[112:115], v[32:35], v[64:67]
    v_mfma_f32_16x16x32_bf16 v[72:75], a[116:119], v[32:35], v[72:75]
    v_mfma_f32_16x16x32_bf16 v[80:83], a[120:123], v[32:35], v[80:83]
    v_mfma_f32_16x16x32_bf16 v[88:91], a[124:127], v[32:35], v[88:91]
    v_mfma_f32_16x16x32_bf16 v[96:99], a[128:131], v[32:35], v[96:99]
    v_mfma_f32_16x16x32_bf16 v[104:107], a[132:135], v[32:35], v[104:107]
    v_mfma_f32_16x16x32_bf16 v[112:115], a[136:139], v[32:35], v[112:115]
    s_add_u32 s33, s23, s48
    buffer_load_dwordx4 v[32:35], v2, s[4:7], s33 offen offset:0
    s_waitcnt vmcnt(7)
    v_mfma_f32_16x16x32_bf16 v[68:71], a[112:115], v[36:39], v[68:71]
    v_mfma_f32_16x16x32_bf16 v[76:79], a[116:119], v[36:39], v[76:79]
    v_mfma_f32_16x16x32_bf16 v[84:87], a[120:123], v[36:39], v[84:87]
    v_mfma_f32_16x16x32_bf16 v[92:95], a[124:127], v[36:39], v[92:95]
    v_mfma_f32_16x16x32_bf16 v[100:103], a[128:131], v[36:39], v[100:103]
    v_mfma_f32_16x16x32_bf16 v[108:111], a[132:135], v[36:39], v[108:111]
    v_mfma_f32_16x16x32_bf16 v[116:119], a[136:139], v[36:39], v[116:119]
    s_add_u32 s33, s23, s48
    buffer_load_dwordx4 v[36:39], v2, s[4:7], s33 offen offset:256
    s_waitcnt vmcnt(7)
    v_mfma_f32_16x16x32_bf16 v[64:67], a[140:143], v[40:43], v[64:67]
    v_mfma_f32_16x16x32_bf16 v[72:75], a[144:147], v[40:43], v[72:75]
    v_mfma_f32_16x16x32_bf16 v[80:83], a[148:151], v[40:43], v[80:83]
    v_mfma_f32_16x16x32_bf16 v[88:91], a[152:155], v[40:43], v[88:91]
    v_mfma_f32_16x16x32_bf16 v[96:99], a[156:159], v[40:43], v[96:99]
    v_mfma_f32_16x16x32_bf16 v[104:107], a[160:163], v[40:43], v[104:107]
    v_mfma_f32_16x16x32_bf16 v[112:115], a[164:167], v[40:43], v[112:115]
    s_add_u32 s33, s23, s49
    buffer_load_dwordx4 v[40:43], v2, s[4:7], s33 offen offset:0
    s_waitcnt vmcnt(7)
    v_mfma_f32_16x16x32_bf16 v[68:71], a[140:143], v[44:47], v[68:71]
    v_mfma_f32_16x16x32_bf16 v[76:79], a[144:147], v[44:47], v[76:79]
    v_mfma_f32_16x16x32_bf16 v[84:87], a[148:151], v[44:47], v[84:87]
    v_mfma_f32_16x16x32_bf16 v[92:95], a[152:155], v[44:47], v[92:95]
    v_mfma_f32_16x16x32_bf16 v[100:103], a[156:159], v[44:47], v[100:103]
    v_mfma_f32_16x16x32_bf16 v[108:111], a[160:163], v[44:47], v[108:111]
    v_mfma_f32_16x16x32_bf16 v[116:119], a[164:167], v[44:47], v[116:119]
    s_add_u32 s33, s23, s49
    buffer_load_dwordx4 v[44:47], v2, s[4:7], s33 offen offset:256
    s_waitcnt vmcnt(7)
    v_mfma_f32_16x16x32_bf16 v[64:67], a[168:171], v[48:51], v[64:67]
    v_mfma_f32_16x16x32_bf16 v[72:75], a[172:175], v[48:51], v[72:75]
    v_mfma_f32_16x16x32_bf16 v[80:83], a[176:179], v[48:51], v[80:83]
    v_mfma_f32_16x16x32_bf16 v[88:91], a[180:183], v[48:51], v[88:91]
    v_mfma_f32_16x16x32_bf16 v[96:99], a[184:187], v[48:51], v[96:99]
    v_mfma_f32_16x16x32_bf16 v[104:107], a[188:191], v[48:51], v[104:107]
    v_mfma_f32_16x16x32_bf16 v[112:115], a[192:195], v[48:51], v[112:115]
    s_add_u32 s33, s23, s50
    buffer_load_dwordx4 v[48:51], v2, s[4:7], s33 offen offset:0
    s_waitcnt vmcnt(7)
    v_mfma_f32_16x16x32_bf16 v[68:71], a[168:171], v[52:55], v[68:71]
    v_mfma_f32_16x16x32_bf16 v[76:79], a[172:175], v[52:55], v[76:79]
    v_mfma_f32_16x16x32_bf16 v[84:87], a[176:179], v[52:55], v[84:87]
    v_mfma_f32_16x16x32_bf16 v[92:95], a[180:183], v[52:55], v[92:95]
    v_mfma_f32_16x16x32_bf16 v[100:103], a[184:187], v[52:55], v[100:103]
    v_mfma_f32_16x16x32_bf16 v[108:111], a[188:191], v[52:55], v[108:111]
    v_mfma_f32_16x16x32_bf16 v[116:119], a[192:195], v[52:55], v[116:119]
    s_add_u32 s33, s23, s50
    buffer_load_dwordx4 v[52:55], v2, s[4:7], s33 offen offset:256
    s_waitcnt vmcnt(7)
    v_mfma_f32_16x16x32_bf16 v[64:67], a[196:199], v[56:59], v[64:67]
    v_mfma_f32_16x16x32_bf16 v[72:75], a[200:203], v[56:59], v[72:75]
    v_mfma_f32_16x16x32_bf16 v[80:83], a[204:207], v[56:59], v[80:83]
    v_mfma_f32_16x16x32_bf16 v[88:91], a[208:211], v[56:59], v[88:91]
    v_mfma_f32_16x16x32_bf16 v[96:99], a[212:215], v[56:59], v[96:99]
    v_mfma_f32_16x16x32_bf16 v[104:107], a[216:219], v[56:59], v[104:107]
    v_mfma_f32_16x16x32_bf16 v[112:115], a[220:223], v[56:59], v[112:115]
    s_add_u32 s33, s23, s51
    buffer_load_dwordx4 v[56:59], v2, s[4:7], s33 offen offset:0
    s_waitcnt vmcnt(7)
    v_mfma_f32_16x16x32_bf16 v[68:71], a[196:199], v[60:63], v[68:71]
    v_mfma_f32_16x16x32_bf16 v[76:79], a[200:203], v[60:63], v[76:79]
    v_mfma_f32_16x16x32_bf16 v[84:87], a[204:207], v[60:63], v[84:87]
    v_mfma_f32_16x16x32_bf16 v[92:95], a[208:211], v[60:63], v[92:95]
    v_mfma_f32_16x16x32_bf16 v[100:103], a[212:215], v[60:63], v[100:103]
    v_mfma_f32_16x16x32_bf16 v[108:111], a[216:219], v[60:63], v[108:111]
    v_mfma_f32_16x16x32_bf16 v[116:119], a[220:223], v[60:63], v[116:119]
    s_add_u32 s33, s23, s51
    buffer_load_dwordx4 v[60:63], v2, s[4:7], s33 offen offset:256
    s_waitcnt vmcnt(7)
    v_mfma_f32_16x16x32_bf16 v[64:67], a[224:227], v[32:35], v[64:67]
    v_mfma_f32_16x16x32_bf16 v[72:75], a[228:231], v[32:35], v[72:75]
    v_mfma_f32_16x16x32_bf16 v[80:83], a[232:235], v[32:35], v[80:83]
    v_mfma_f32_16x16x32_bf16 v[88:91], a[236:239], v[32:35], v[88:91]
    v_mfma_f32_16x16x32_bf16 v[96:99], a[240:243], v[32:35], v[96:99]
    v_mfma_f32_16x16x32_bf16 v[104:107], a[244:247], v[32:35], v[104:107]
    v_mfma_f32_16x16x32_bf16 v[112:115], a[248:251], v[32:35], v[112:115]
    s_add_u32 s33, s23, s52
    buffer_load_dwordx4 v[32:35], v2, s[4:7], s33 offen offset:0
    s_waitcnt vmcnt(7)
    v_mfma_f32_16x16x32_bf16 v[68:71], a[224:227], v[36:39], v[68:71]
    v_mfma_f32_16x16x32_bf16 v[76:79], a[228:231], v[36:39], v[76:79]
    v_mfma_f32_16x16x32_bf16 v[84:87], a[232:235], v[36:39], v[84:87]
    v_mfma_f32_16x16x32_bf16 v[92:95], a[236:239], v[36:39], v[92:95]
    v_mfma_f32_16x16x32_bf16 v[100:103], a[240:243], v[36:39], v[100:103]
    v_mfma_f32_16x16x32_bf16 v[108:111], a[244:247], v[36:39], v[108:111]
    v_mfma_f32_16x16x32_bf16 v[116:119], a[248:251], v[36:39], v[116:119]
    s_add_u32 s33, s23, s52
    buffer_load_dwordx4 v[36:39], v2, s[4:7], s33 offen offset:256
    s_waitcnt vmcnt(7)
    v_mfma_f32_16x16x32_bf16 v[64:67], a[252:255], v[40:43], v[64:67]
    v_mfma_f32_16x16x32_bf16 v[72:75], v[120:123], v[40:43], v[72:75]
    v_mfma_f32_16x16x32_bf16 v[80:83], v[124:127], v[40:43], v[80:83]
    v_mfma_f32_16x16x32_bf16 v[88:91], v[128:131], v[40:43], v[88:91]
    v_mfma_f32_16x16x32_bf16 v[96:99], v[132:135], v[40:43], v[96:99]
    v_mfma_f32_16x16x32_bf16 v[104:107], v[136:139], v[40:43], v[104:107]
    v_mfma_f32_16x16x32_bf16 v[112:115], v[140:143], v[40:43], v[112:115]
    s_add_u32 s33, s23, s53
    buffer_load_dwordx4 v[40:43], v2, s[4:7], s33 offen offset:0
    s_waitcnt vmcnt(7)
    v_mfma_f32_16x16x32_bf16 v[68:71], a[252:255], v[44:47], v[68:71]
    v_mfma_f32_16x16x32_bf16 v[76:79], v[120:123], v[44:47], v[76:79]
    v_mfma_f32_16x16x32_bf16 v[84:87], v[124:127], v[44:47], v[84:87]
    v_mfma_f32_16x16x32_bf16 v[92:95], v[128:131], v[44:47], v[92:95]
    v_mfma_f32_16x16x32_bf16 v[100:103], v[132:135], v[44:47], v[100:103]
    v_mfma_f32_16x16x32_bf16 v[108:111], v[136:139], v[44:47], v[108:111]
    v_mfma_f32_16x16x32_bf16 v[116:119], v[140:143], v[44:47], v[116:119]
    s_add_u32 s33, s23, s53
    buffer_load_dwordx4 v[44:47], v2, s[4:7], s33 offen offset:256
    s_waitcnt vmcnt(7)
    v_mfma_f32_16x16x32_bf16 v[64:67], v[144:147], v[48:51], v[64:67]
    v_mfma_f32_16x16x32_bf16 v[72:75], v[148:151], v[48:51], v[72:75]
    v_mfma_f32_16x16x32_bf16 v[80:83], v[152:155], v[48:51], v[80:83]
    v_mfma_f32_16x16x32_bf16 v[88:91], v[156:159], v[48:51], v[88:91]
    v_mfma_f32_16x16x32_bf16 v[96:99], v[160:163], v[48:51], v[96:99]
    v_mfma_f32_16x16x32_bf16 v[104:107], v[164:167], v[48:51], v[104:107]
    v_mfma_f32_16x16x32_bf16 v[112:115], v[168:171], v[48:51], v[112:115]
    s_waitcnt vmcnt(6)
    v_mfma_f32_16x16x32_bf16 v[68:71], v[144:147], v[52:55], v[68:71]
    v_mfma_f32_16x16x32_bf16 v[76:79], v[148:151], v[52:55], v[76:79]
    v_mfma_f32_16x16x32_bf16 v[84:87], v[152:155], v[52:55], v[84:87]
    v_mfma_f32_16x16x32_bf16 v[92:95], v[156:159], v[52:55], v[92:95]
    v_mfma_f32_16x16x32_bf16 v[100:103], v[160:163], v[52:55], v[100:103]
    v_mfma_f32_16x16x32_bf16 v[108:111], v[164:167], v[52:55], v[108:111]
    v_mfma_f32_16x16x32_bf16 v[116:119], v[168:171], v[52:55], v[116:119]
    s_waitcnt vmcnt(5)
    v_mfma_f32_16x16x32_bf16 v[64:67], v[172:175], v[56:59], v[64:67]
    v_mfma_f32_16x16x32_bf16 v[72:75], v[176:179], v[56:59], v[72:75]
    v_mfma_f32_16x16x32_bf16 v[80:83], v[180:183], v[56:59], v[80:83]
    v_mfma_f32_16x16x32_bf16 v[88:91], v[184:187], v[56:59], v[88:91]
    v_mfma_f32_16x16x32_bf16 v[96:99], v[188:191], v[56:59], v[96:99]
    v_mfma_f32_16x16x32_bf16 v[104:107], v[192:195], v[56:59], v[104:107]
    v_mfma_f32_16x16x32_bf16 v[112:115], v[196:199], v[56:59], v[112:115]
    s_waitcnt vmcnt(4)
    v_mfma_f32_16x16x32_bf16 v[68:71], v[172:175], v[60:63], v[68:71]
    v_mfma_f32_16x16x32_bf16 v[76:79], v[176:179], v[60:63], v[76:79]
    v_mfma_f32_16x16x32_bf16 v[84:87], v[180:183], v[60:63], v[84:87]
    v_mfma_f32_16x16x32_bf16 v[92:95], v[184:187], v[60:63], v[92:95]
    v_mfma_f32_16x16x32_bf16 v[100:103], v[188:191], v[60:63], v[100:103]
    v_mfma_f32_16x16x32_bf16 v[108:111], v[192:195], v[60:63], v[108:111]
    v_mfma_f32_16x16x32_bf16 v[116:119], v[196:199], v[60:63], v[116:119]
    s_waitcnt vmcnt(3)
    v_mfma_f32_16x16x32_bf16 v[64:67], v[200:203], v[32:35], v[64:67]
    v_mfma_f32_16x16x32_bf16 v[72:75], v[204:207], v[32:35], v[72:75]
    v_mfma_f32_16x16x32_bf16 v[80:83], v[208:211], v[32:35], v[80:83]
    v_mfma_f32_16x16x32_bf16 v[88:91], v[212:215], v[32:35], v[88:91]
    v_mfma_f32_16x16x32_bf16 v[96:99], v[216:219], v[32:35], v[96:99]
    v_mfma_f32_16x16x32_bf16 v[104:107], v[220:223], v[32:35], v[104:107]
    v_mfma_f32_16x16x32_bf16 v[112:115], v[224:227], v[32:35], v[112:115]
    s_waitcnt vmcnt(2)
    v_mfma_f32_16x16x32_bf16 v[68:71], v[200:203], v[36:39], v[68:71]
    v_mfma_f32_16x16x32_bf16 v[76:79], v[204:207], v[36:39], v[76:79]
    v_mfma_f32_16x16x32_bf16 v[84:87], v[208:211], v[36:39], v[84:87]
    v_mfma_f32_16x16x32_bf16 v[92:95], v[212:215], v[36:39], v[92:95]
    v_mfma_f32_16x16x32_bf16 v[100:103], v[216:219], v[36:39], v[100:103]
    v_mfma_f32_16x16x32_bf16 v[108:111], v[220:223], v[36:39], v[108:111]
    v_mfma_f32_16x16x32_bf16 v[116:119], v[224:227], v[36:39], v[116:119]
    s_waitcnt vmcnt(1)
    v_mfma_f32_16x16x32_bf16 v[64:67], v[228:231], v[40:43], v[64:67]
    v_mfma_f32_16x16x32_bf16 v[72:75], v[232:235], v[40:43], v[72:75]
    v_mfma_f32_16x16x32_bf16 v[80:83], v[236:239], v[40:43], v[80:83]
    v_mfma_f32_16x16x32_bf16 v[88:91], v[240:243], v[40:43], v[88:91]
    v_mfma_f32_16x16x32_bf16 v[96:99], v[244:247], v[40:43], v[96:99]
    v_mfma_f32_16x16x32_bf16 v[104:107], v[248:251], v[40:43], v[104:107]
    v_mfma_f32_16x16x32_bf16 v[112:115], v[252:255], v[40:43], v[112:115]
    s_waitcnt vmcnt(0)
    v_mfma_f32_16x16x32_bf16 v[68:71], v[228:231], v[44:47], v[68:71]
    v_mfma_f32_16x16x32_bf16 v[76:79], v[232:235], v[44:47], v[76:79]
    v_mfma_f32_16x16x32_bf16 v[84:87], v[236:239], v[44:47], v[84:87]
    v_mfma_f32_16x16x32_bf16 v[92:95], v[240:243], v[44:47], v[92:95]
    v_mfma_f32_16x16x32_bf16 v[100:103], v[244:247], v[44:47], v[100:103]
    v_mfma_f32_16x16x32_bf16 v[108:111], v[248:251], v[44:47], v[108:111]
    v_mfma_f32_16x16x32_bf16 v[116:119], v[252:255], v[44:47], v[116:119]
    s_lshl_b32 s24, s21, 2
    s_add_u32 s24, s24, s22
    s_lshl_b32 s25, s24, 2
    s_add_u32 s25, s25, 69816320
    s_mul_i32 s24, s24, 28672
    s_add_u32 s24, s24, 49086464
    s_add_u32 s33, s24, s50
    v_mul_f32 v8, 0xbfb8aa3b, v64
    v_mul_f32 v9, 0xbfb8aa3b, v65
    v_mul_f32 v10, 0xbfb8aa3b, v66
    v_mul_f32 v11, 0xbfb8aa3b, v67
    v_exp_f32 v8, v8
    v_exp_f32 v9, v9
    v_exp_f32 v10, v10
    v_exp_f32 v11, v11
    v_add_f32 v8, 1.0, v8
    v_add_f32 v9, 1.0, v9
    v_add_f32 v10, 1.0, v10
    v_add_f32 v11, 1.0, v11
    v_rcp_f32 v8, v8
    v_rcp_f32 v9, v9
    v_rcp_f32 v10, v10
    v_rcp_f32 v11, v11
    v_mul_f32 v64, v64, v8
    v_mul_f32 v65, v65, v9
    v_mul_f32 v66, v66, v10
    v_mul_f32 v67, v67, v11
    v_mul_f32 v8, 0xbfb8aa3b, v72
    v_mul_f32 v9, 0xbfb8aa3b, v73
    v_mul_f32 v10, 0xbfb8aa3b, v74
    v_mul_f32 v11, 0xbfb8aa3b, v75
    v_exp_f32 v8, v8
    v_exp_f32 v9, v9
    v_exp_f32 v10, v10
    v_exp_f32 v11, v11
    v_add_f32 v8, 1.0, v8
    v_add_f32 v9, 1.0, v9
    v_add_f32 v10, 1.0, v10
    v_add_f32 v11, 1.0, v11
    v_rcp_f32 v8, v8
    v_rcp_f32 v9, v9
    v_rcp_f32 v10, v10
    v_rcp_f32 v11, v11
    v_mul_f32 v72, v72, v8
    v_mul_f32 v73, v73, v9
    v_mul_f32 v74, v74, v10
    v_mul_f32 v75, v75, v11
    v_cvt_pk_bf16_f32 v64, v64, v65
    v_cvt_pk_bf16_f32 v65, v66, v67
    v_cvt_pk_bf16_f32 v66, v72, v73
    v_cvt_pk_bf16_f32 v67, v74, v75
    buffer_store_dwordx4 v[64:67], v2, s[4:7], s33 offen offset:0 sc1
    v_mul_f32 v8, 0xbfb8aa3b, v68
    v_mul_f32 v9, 0xbfb8aa3b, v69
    v_mul_f32 v10, 0xbfb8aa3b, v70
    v_mul_f32 v11, 0xbfb8aa3b, v71
    v_exp_f32 v8, v8
    v_exp_f32 v9, v9
    v_exp_f32 v10, v10
    v_exp_f32 v11, v11
    v_add_f32 v8, 1.0, v8
    v_add_f32 v9, 1.0, v9
    v_add_f32 v10, 1.0, v10
    v_add_f32 v11, 1.0, v11
    v_rcp_f32 v8, v8
    v_rcp_f32 v9, v9
    v_rcp_f32 v10, v10
    v_rcp_f32 v11, v11
    v_mul_f32 v68, v68, v8
    v_mul_f32 v69, v69, v9
    v_mul_f32 v70, v70, v10
    v_mul_f32 v71, v71, v11
    v_mul_f32 v8, 0xbfb8aa3b, v76
    v_mul_f32 v9, 0xbfb8aa3b, v77
    v_mul_f32 v10, 0xbfb8aa3b, v78
    v_mul_f32 v11, 0xbfb8aa3b, v79
    v_exp_f32 v8, v8
    v_exp_f32 v9, v9
    v_exp_f32 v10, v10
    v_exp_f32 v11, v11
    v_add_f32 v8, 1.0, v8
    v_add_f32 v9, 1.0, v9
    v_add_f32 v10, 1.0, v10
    v_add_f32 v11, 1.0, v11
    v_rcp_f32 v8, v8
    v_rcp_f32 v9, v9
    v_rcp_f32 v10, v10
    v_rcp_f32 v11, v11
    v_mul_f32 v76, v76, v8
    v_mul_f32 v77, v77, v9
    v_mul_f32 v78, v78, v10
    v_mul_f32 v79, v79, v11
    v_cvt_pk_bf16_f32 v68, v68, v69
    v_cvt_pk_bf16_f32 v69, v70, v71
    v_cvt_pk_bf16_f32 v70, v76, v77
    v_cvt_pk_bf16_f32 v71, v78, v79
    buffer_store_dwordx4 v[68:71], v2, s[4:7], s33 offen offset:256 sc1
    s_add_u32 s33, s24, s51
    v_mul_f32 v8, 0xbfb8aa3b, v80
    v_mul_f32 v9, 0xbfb8aa3b, v81
    v_mul_f32 v10, 0xbfb8aa3b, v82
    v_mul_f32 v11, 0xbfb8aa3b, v83
    v_exp_f32 v8, v8
    v_exp_f32 v9, v9
    v_exp_f32 v10, v10
    v_exp_f32 v11, v11
    v_add_f32 v8, 1.0, v8
    v_add_f32 v9, 1.0, v9
    v_add_f32 v10, 1.0, v10
    v_add_f32 v11, 1.0, v11
    v_rcp_f32 v8, v8
    v_rcp_f32 v9, v9
    v_rcp_f32 v10, v10
    v_rcp_f32 v11, v11
    v_mul_f32 v80, v80, v8
    v_mul_f32 v81, v81, v9
    v_mul_f32 v82, v82, v10
    v_mul_f32 v83, v83, v11
    v_mul_f32 v8, 0xbfb8aa3b, v88
    v_mul_f32 v9, 0xbfb8aa3b, v89
    v_mul_f32 v10, 0xbfb8aa3b, v90
    v_mul_f32 v11, 0xbfb8aa3b, v91
    v_exp_f32 v8, v8
    v_exp_f32 v9, v9
    v_exp_f32 v10, v10
    v_exp_f32 v11, v11
    v_add_f32 v8, 1.0, v8
    v_add_f32 v9, 1.0, v9
    v_add_f32 v10, 1.0, v10
    v_add_f32 v11, 1.0, v11
    v_rcp_f32 v8, v8
    v_rcp_f32 v9, v9
    v_rcp_f32 v10, v10
    v_rcp_f32 v11, v11
    v_mul_f32 v88, v88, v8
    v_mul_f32 v89, v89, v9
    v_mul_f32 v90, v90, v10
    v_mul_f32 v91, v91, v11
    v_cvt_pk_bf16_f32 v80, v80, v81
    v_cvt_pk_bf16_f32 v81, v82, v83
    v_cvt_pk_bf16_f32 v82, v88, v89
    v_cvt_pk_bf16_f32 v83, v90, v91
    buffer_store_dwordx4 v[80:83], v2, s[4:7], s33 offen offset:0 sc1
    v_mul_f32 v8, 0xbfb8aa3b, v84
    v_mul_f32 v9, 0xbfb8aa3b, v85
    v_mul_f32 v10, 0xbfb8aa3b, v86
    v_mul_f32 v11, 0xbfb8aa3b, v87
    v_exp_f32 v8, v8
    v_exp_f32 v9, v9
    v_exp_f32 v10, v10
    v_exp_f32 v11, v11
    v_add_f32 v8, 1.0, v8
    v_add_f32 v9, 1.0, v9
    v_add_f32 v10, 1.0, v10
    v_add_f32 v11, 1.0, v11
    v_rcp_f32 v8, v8
    v_rcp_f32 v9, v9
    v_rcp_f32 v10, v10
    v_rcp_f32 v11, v11
    v_mul_f32 v84, v84, v8
    v_mul_f32 v85, v85, v9
    v_mul_f32 v86, v86, v10
    v_mul_f32 v87, v87, v11
    v_mul_f32 v8, 0xbfb8aa3b, v92
    v_mul_f32 v9, 0xbfb8aa3b, v93
    v_mul_f32 v10, 0xbfb8aa3b, v94
    v_mul_f32 v11, 0xbfb8aa3b, v95
    v_exp_f32 v8, v8
    v_exp_f32 v9, v9
    v_exp_f32 v10, v10
    v_exp_f32 v11, v11
    v_add_f32 v8, 1.0, v8
    v_add_f32 v9, 1.0, v9
    v_add_f32 v10, 1.0, v10
    v_add_f32 v11, 1.0, v11
    v_rcp_f32 v8, v8
    v_rcp_f32 v9, v9
    v_rcp_f32 v10, v10
    v_rcp_f32 v11, v11
    v_mul_f32 v92, v92, v8
    v_mul_f32 v93, v93, v9
    v_mul_f32 v94, v94, v10
    v_mul_f32 v95, v95, v11
    v_cvt_pk_bf16_f32 v84, v84, v85
    v_cvt_pk_bf16_f32 v85, v86, v87
    v_cvt_pk_bf16_f32 v86, v92, v93
    v_cvt_pk_bf16_f32 v87, v94, v95
    buffer_store_dwordx4 v[84:87], v2, s[4:7], s33 offen offset:256 sc1
    s_add_u32 s33, s24, s52
    v_mul_f32 v8, 0xbfb8aa3b, v96
    v_mul_f32 v9, 0xbfb8aa3b, v97
    v_mul_f32 v10, 0xbfb8aa3b, v98
    v_mul_f32 v11, 0xbfb8aa3b, v99
    v_exp_f32 v8, v8
    v_exp_f32 v9, v9
    v_exp_f32 v10, v10
    v_exp_f32 v11, v11
    v_add_f32 v8, 1.0, v8
    v_add_f32 v9, 1.0, v9
    v_add_f32 v10, 1.0, v10
    v_add_f32 v11, 1.0, v11
    v_rcp_f32 v8, v8
    v_rcp_f32 v9, v9
    v_rcp_f32 v10, v10
    v_rcp_f32 v11, v11
    v_mul_f32 v96, v96, v8
    v_mul_f32 v97, v97, v9
    v_mul_f32 v98, v98, v10
    v_mul_f32 v99, v99, v11
    v_mul_f32 v8, 0xbfb8aa3b, v104
    v_mul_f32 v9, 0xbfb8aa3b, v105
    v_mul_f32 v10, 0xbfb8aa3b, v106
    v_mul_f32 v11, 0xbfb8aa3b, v107
    v_exp_f32 v8, v8
    v_exp_f32 v9, v9
    v_exp_f32 v10, v10
    v_exp_f32 v11, v11
    v_add_f32 v8, 1.0, v8
    v_add_f32 v9, 1.0, v9
    v_add_f32 v10, 1.0, v10
    v_add_f32 v11, 1.0, v11
    v_rcp_f32 v8, v8
    v_rcp_f32 v9, v9
    v_rcp_f32 v10, v10
    v_rcp_f32 v11, v11
    v_mul_f32 v104, v104, v8
    v_mul_f32 v105, v105, v9
    v_mul_f32 v106, v106, v10
    v_mul_f32 v107, v107, v11
    v_cvt_pk_bf16_f32 v96, v96, v97
    v_cvt_pk_bf16_f32 v97, v98, v99
    v_cvt_pk_bf16_f32 v98, v104, v105
    v_cvt_pk_bf16_f32 v99, v106, v107
    buffer_store_dwordx4 v[96:99], v2, s[4:7], s33 offen offset:0 sc1
    v_mul_f32 v8, 0xbfb8aa3b, v100
    v_mul_f32 v9, 0xbfb8aa3b, v101
    v_mul_f32 v10, 0xbfb8aa3b, v102
    v_mul_f32 v11, 0xbfb8aa3b, v103
    v_exp_f32 v8, v8
    v_exp_f32 v9, v9
    v_exp_f32 v10, v10
    v_exp_f32 v11, v11
    v_add_f32 v8, 1.0, v8
    v_add_f32 v9, 1.0, v9
    v_add_f32 v10, 1.0, v10
    v_add_f32 v11, 1.0, v11
    v_rcp_f32 v8, v8
    v_rcp_f32 v9, v9
    v_rcp_f32 v10, v10
    v_rcp_f32 v11, v11
    v_mul_f32 v100, v100, v8
    v_mul_f32 v101, v101, v9
    v_mul_f32 v102, v102, v10
    v_mul_f32 v103, v103, v11
    v_mul_f32 v8, 0xbfb8aa3b, v108
    v_mul_f32 v9, 0xbfb8aa3b, v109
    v_mul_f32 v10, 0xbfb8aa3b, v110
    v_mul_f32 v11, 0xbfb8aa3b, v111
    v_exp_f32 v8, v8
    v_exp_f32 v9, v9
    v_exp_f32 v10, v10
    v_exp_f32 v11, v11
    v_add_f32 v8, 1.0, v8
    v_add_f32 v9, 1.0, v9
    v_add_f32 v10, 1.0, v10
    v_add_f32 v11, 1.0, v11
    v_rcp_f32 v8, v8
    v_rcp_f32 v9, v9
    v_rcp_f32 v10, v10
    v_rcp_f32 v11, v11
    v_mul_f32 v108, v108, v8
    v_mul_f32 v109, v109, v9
    v_mul_f32 v110, v110, v10
    v_mul_f32 v111, v111, v11
    v_cvt_pk_bf16_f32 v100, v100, v101
    v_cvt_pk_bf16_f32 v101, v102, v103
    v_cvt_pk_bf16_f32 v102, v108, v109
    v_cvt_pk_bf16_f32 v103, v110, v111
    buffer_store_dwordx4 v[100:103], v2, s[4:7], s33 offen offset:256 sc1
    s_add_u32 s33, s24, s53
    v_mul_f32 v8, 0xbfb8aa3b, v112
    v_mul_f32 v9, 0xbfb8aa3b, v113
    v_mul_f32 v10, 0xbfb8aa3b, v114
    v_mul_f32 v11, 0xbfb8aa3b, v115
    v_exp_f32 v8, v8
    v_exp_f32 v9, v9
    v_exp_f32 v10, v10
    v_exp_f32 v11, v11
    v_add_f32 v8, 1.0, v8
    v_add_f32 v9, 1.0, v9
    v_add_f32 v10, 1.0, v10
    v_add_f32 v11, 1.0, v11
    v_rcp_f32 v8, v8
    v_rcp_f32 v9, v9
    v_rcp_f32 v10, v10
    v_rcp_f32 v11, v11
    v_mul_f32 v112, v112, v8
    v_mul_f32 v113, v113, v9
    v_mul_f32 v114, v114, v10
    v_mul_f32 v115, v115, v11
    v_cvt_pk_bf16_f32 v112, v112, v113
    v_cvt_pk_bf16_f32 v113, v114, v115
    buffer_store_dwordx2 v[112:113], v7, s[4:7], s33 offen offset:0 sc1
    v_mul_f32 v8, 0xbfb8aa3b, v116
    v_mul_f32 v9, 0xbfb8aa3b, v117
    v_mul_f32 v10, 0xbfb8aa3b, v118
    v_mul_f32 v11, 0xbfb8aa3b, v119
    v_exp_f32 v8, v8
    v_exp_f32 v9, v9
    v_exp_f32 v10, v10
    v_exp_f32 v11, v11
    v_add_f32 v8, 1.0, v8
    v_add_f32 v9, 1.0, v9
    v_add_f32 v10, 1.0, v10
    v_add_f32 v11, 1.0, v11
    v_rcp_f32 v8, v8
    v_rcp_f32 v9, v9
    v_rcp_f32 v10, v10
    v_rcp_f32 v11, v11
    v_mul_f32 v116, v116, v8
    v_mul_f32 v117, v117, v9
    v_mul_f32 v118, v118, v10
    v_mul_f32 v119, v119, v11
    v_cvt_pk_bf16_f32 v116, v116, v117
    v_cvt_pk_bf16_f32 v117, v118, v119
    buffer_store_dwordx2 v[116:117], v7, s[4:7], s33 offen offset:256 sc1
    s_waitcnt vmcnt(0)
    s_barrier
    s_cmp_eq_u32 s16, 0
    s_cbranch_scc0 noflag_28
    v_mov_b32 v5, 1
    v_mov_b32 v6, 0
    s_mov_b64 exec, 1
    buffer_store_dword v5, v6, s[4:7], s25 offen sc1
    s_mov_b64 exec, -1
noflag_28:
    s_add_u32 s21, s21, 4
    s_cmp_lt_u32 s21, 64
    s_cbranch_scc1 H_loop
    s_endpgm
role_F:
    s_sub_u32 s27, s17, 176
    s_lshr_b32 s22, s27, 2
    s_and_b32 s21, s27, 3
    s_add_u32 s20, s16, 36
    s_lshr_b32 s30, s17, 5
    s_lshl_b32 s30, s30, 7
    s_add_u32 s30, s30, 69833728
    v_mov_b32 v9, s30
    s_cmp_eq_u32 s16, 0
    s_cbranch_scc0 wad_30
wa_29:
    buffer_load_dword v8, v9, s[4:7], 0 offen sc1
    s_waitcnt vmcnt(0)
    v_cmp_eq_u32 vcc, 0, v8
    s_cbranch_vccz wad_30
    s_sub_u32 s18, s18, 1
    s_cbranch_scc1 main_end2
    s_sleep 16
    s_branch wa_29
wad_30:
    s_waitcnt vmcnt(0)
    s_barrier
    s_lshr_b32 s28, s16, 1
    s_mul_i32 s28, s28, 7
    s_and_b32 s29, s16, 1
    s_cmp_eq_u32 s29, 0
    s_cselect_b32 s30, 4, 16
    s_add_u32 s30, s30, s28
    s_sub_u32 s31, s30, 14
    s_cselect_b32 s30, s30, s31
    s_sub_u32 s31, s30, 14
    s_cselect_b32 s30, s30, s31
    s_lshl_b32 s40, s30, 11
    s_cmp_eq_u32 s29, 0
    s_cselect_b32 s30, 5, 15
    s_add_u32 s30, s30, s28
    s_sub_u32 s31, s30, 14
    s_cselect_b32 s30, s30, s31
    s_sub_u32 s31, s30, 14
    s_cselect_b32 s30, s30, s31
    s_lshl_b32 s41, s30, 11
    s_cmp_eq_u32 s29, 0
    s_cselect_b32 s30, 6, 14
    s_add_u32 s30, s30, s28
    s_sub_u32 s31, s30, 14
    s_cselect_b32 s30, s30, s31
    s_sub_u32 s31, s30, 14
    s_cselect_b32 s30, s30, s31
    s_lshl_b32 s42, s30, 11
    s_cmp_eq_u32 s29, 0
    s_cselect_b32 s30, 7, 13
    s_add_u32 s30, s30, s28
    s_sub_u32 s31, s30, 14
    s_cselect_b32 s30, s30, s31
    s_sub_u32 s31, s30, 14
    s_cselect_b32 s30, s30, s31
    s_lshl_b32 s43, s30, 11
    s_cmp_eq_u32 s29, 0
    s_cselect_b32 s30, 8, 12
    s_add_u32 s30, s30, s28
    s_sub_u32 s31, s30, 14
    s_cselect_b32 s30, s30, s31
    s_sub_u32 s31, s30, 14
    s_cselect_b32 s30, s30, s31
    s_lshl_b32 s44, s30, 11
    s_cmp_eq_u32 s29, 0
    s_cselect_b32 s30, 9, 11
    s_add_u32 s30, s30, s28
    s_sub_u32 s31, s30, 14
    s_cselect_b32 s30, s30, s31
    s_sub_u32 s31, s30, 14
    s_cselect_b32 s30, s30, s31
    s_lshl_b32 s45, s30, 11
    s_cmp_eq_u32 s29, 0
    s_cselect_b32 s30, 10, 10
    s_add_u32 s30, s30, s28
    s_sub_u32 s31, s30, 14
    s_cselect_b32 s30, s30, s31
    s_sub_u32 s31, s30, 14
    s_cselect_b32 s30, s30, s31
    s_lshl_b32 s46, s30, 11
    s_cmp_eq_u32 s29, 0
    s_cselect_b32 s30, 11, 9
    s_add_u32 s30, s30, s28
    s_sub_u32 s31, s30, 14
    s_cselect_b32 s30, s30, s31
    s_sub_u32 s31, s30, 14
    s_cselect_b32 s30, s30, s31
    s_lshl_b32 s47, s30, 11
    s_cmp_eq_u32 s29, 0
    s_cselect_b32 s30, 12, 8
    s_add_u32 s30, s30, s28
    s_sub_u32 s31, s30, 14
    s_cselect_b32 s30, s30, s31
    s_sub_u32 s31, s30, 14
    s_cselect_b32 s30, s30, s31
    s_lshl_b32 s48, s30, 11
    s_cmp_eq_u32 s29, 0
    s_cselect_b32 s30, 13, 7
    s_add_u32 s30, s30, s28
    s_sub_u32 s31, s30, 14
    s_cselect_b32 s30, s30, s31
    s_sub_u32 s31, s30, 14
    s_cselect_b32 s30, s30, s31
    s_lshl_b32 s49, s30, 11
    s_cmp_eq_u32 s29, 0
    s_cselect_b32 s30, 14, 6
    s_add_u32 s30, s30, s28
    s_sub_u32 s31, s30, 14
    s_cselect_b32 s30, s30, s31
    s_sub_u32 s31, s30, 14
    s_cselect_b32 s30, s30, s31
    s_lshl_b32 s50, s30, 11
    s_cmp_eq_u32 s29, 0
    s_cselect_b32 s30, 15, 5
    s_add_u32 s30, s30, s28
    s_sub_u32 s31, s30, 14
    s_cselect_b32 s30, s30, s31
    s_sub_u32 s31, s30, 14
    s_cselect_b32 s30, s30, s31
    s_lshl_b32 s51, s30, 11
    s_cmp_eq_u32 s29, 0
    s_cselect_b32 s30, 16, 4
    s_add_u32 s30, s30, s28
    s_sub_u32 s31, s30, 14
    s_cselect_b32 s30, s30, s31
    s_sub_u32 s31, s30, 14
    s_cselect_b32 s30, s30, s31
    s_lshl_b32 s52, s30, 11
    s_cmp_eq_u32 s29, 0
    s_cselect_b32 s30, 17, 3
    s_add_u32 s30, s30, s28
    s_sub_u32 s31, s30, 14
    s_cselect_b32 s30, s30, s31
    s_sub_u32 s31, s30, 14
    s_cselect_b32 s30, s30, s31
    s_lshl_b32 s53, s30, 11
    s_mul_i32 s56, s22, 7
    s_add_u32 s56, s56, 0
    s_mul_i32 s57, s22, 7
    s_add_u32 s57, s57, 1
    s_mul_i32 s58, s22, 7
    s_add_u32 s58, s58, 2
    s_mul_i32 s59, s22, 7
    s_add_u32 s59, s59, 3
    s_mul_i32 s60, s22, 7
    s_add_u32 s60, s60, 4
    s_mul_i32 s61, s22, 7
    s_add_u32 s61, s61, 5
    s_mul_i32 s62, s22, 7
    s_add_u32 s62, s62, 6
    v_lshlrev_b32 v1, 4, v0
    v_lshrrev_b32 v3, 4, v0
    v_and_b32 v4, 15, v0
    v_lshlrev_b32 v2, 9, v3
    v_lshl_add_u32 v2, v4, 4, v2
    s_mul_i32 s30, s20, 401408
    s_mul_i32 s64, s56, 14336
    s_add_u32 s64, s64, s30
    s_mul_i32 s65, s57, 14336
    s_add_u32 s65, s65, s30
    s_mul_i32 s66, s58, 14336
    s_add_u32 s66, s66, s30
    s_mul_i32 s67, s59, 14336
    s_add_u32 s67, s67, s30
    s_mul_i32 s68, s60, 14336
    s_add_u32 s68, s68, s30
    s_mul_i32 s69, s61, 14336
    s_add_u32 s69, s69, s30
    s_mul_i32 s70, s62, 14336
    s_add_u32 s70, s70, s30
    s_lshr_b32 s31, s40, 1
    s_add_u32 s33, s31, s64
    buffer_load_dwordx4 a[0:3], v1, s[4:7], s33 offen
    s_add_u32 s33, s31, s65
    buffer_load_dwordx4 a[4:7], v1, s[4:7], s33 offen
    s_add_u32 s33, s31, s66
    buffer_load_dwordx4 a[8:11], v1, s[4:7], s33 offen
    s_add_u32 s33, s31, s67
    buffer_load_dwordx4 a[12:15], v1, s[4:7], s33 offen
    s_add_u32 s33, s31, s68
    buffer_load_dwordx4 a[16:19], v1, s[4:7], s33 offen
    s_add_u32 s33, s31, s69
    buffer_load_dwordx4 a[20:23], v1, s[4:7], s33 offen
    s_add_u32 s33, s31, s70
    buffer_load_dwordx4 a[24:27], v1, s[4:7], s33 offen
    s_lshr_b32 s31, s41, 1
    s_add_u32 s33, s31, s64
    buffer_load_dwordx4 a[28:31], v1, s[4:7], s33 offen
    s_add_u32 s33, s31, s65
    buffer_load_dwordx4 a[32:35], v1, s[4:7], s33 offen
    s_add_u32 s33, s31, s66
    buffer_load_dwordx4 a[36:39], v1, s[4:7], s33 offen
    s_add_u32 s33, s31, s67
    buffer_load_dwordx4 a[40:43], v1, s[4:7], s33 offen
    s_add_u32 s33, s31, s68
    buffer_load_dwordx4 a[44:47], v1, s[4:7], s33 offen
    s_add_u32 s33, s31, s69
    buffer_load_dwordx4 a[48:51], v1, s[4:7], s33 offen
    s_add_u32 s33, s31, s70
    buffer_load_dwordx4 a[52:55], v1, s[4:7], s33 offen
    s_lshr_b32 s31, s42, 1
    s_add_u32 s33, s31, s64
    buffer_load_dwordx4 a[56:59], v1, s[4:7], s33 offen
    s_add_u32 s33, s31, s65
    buffer_load_dwordx4 a[60:63], v1, s[4:7], s33 offen
    s_add_u32 s33, s31, s66
    buffer_load_dwordx4 a[64:67], v1, s[4:7], s33 offen
    s_add_u32 s33, s31, s67
    buffer_load_dwordx4 a[68:71], v1, s[4:7], s33 offen
    s_add_u32 s33, s31, s68
    buffer_load_dwordx4 a[72:75], v1, s[4:7], s33 offen
    s_add_u32 s33, s31, s69
    buffer_load_dwordx4 a[76:79], v1, s[4:7], s33 offen
    s_add_u32 s33, s31, s70
    buffer_load_dwordx4 a[80:83], v1, s[4:7], s33 offen
    s_lshr_b32 s31, s43, 1
    s_add_u32 s33, s31, s64
    buffer_load_dwordx4 a[84:87], v1, s[4:7], s33 offen
    s_add_u32 s33, s31, s65
    buffer_load_dwordx4 a[88:91], v1, s[4:7], s33 offen
    s_add_u32 s33, s31, s66
    buffer_load_dwordx4 a[92:95], v1, s[4:7], s33 offen
    s_add_u32 s33, s31, s67
    buffer_load_dwordx4 a[96:99], v1, s[4:7], s33 offen
    s_add_u32 s33, s31, s68
    buffer_load_dwordx4 a[100:103], v1, s[4:7], s33 offen
    s_add_u32 s33, s31, s69
    buffer_load_dwordx4 a[104:107], v1, s[4:7], s33 offen
    s_add_u32 s33, s31, s70
    buffer_load_dwordx4 a[108:111], v1, s[4:7], s33 offen
    s_lshr_b32 s31, s44, 1
    s_add_u32 s33, s31, s64
    buffer_load_dwordx4 a[112:115], v1, s[4:7], s33 offen
    s_add_u32 s33, s31, s65
    buffer_load_dwordx4 a[116:119], v1, s[4:7], s33 offen
    s_add_u32 s33, s31, s66
    buffer_load_dwordx4 a[120:123], v1, s[4:7], s33 offen
    s_add_u32 s33, s31, s67
    buffer_load_dwordx4 a[124:127], v1, s[4:7], s33 offen
    s_add_u32 s33, s31, s68
    buffer_load_dwordx4 a[128:131], v1, s[4:7], s33 offen
    s_add_u32 s33, s31, s69
    buffer_load_dwordx4 a[132:135], v1, s[4:7], s33 offen
    s_add_u32 s33, s31, s70
    buffer_load_dwordx4 a[136:139], v1, s[4:7], s33 offen
    s_lshr_b32 s31, s45, 1
    s_add_u32 s33, s31, s64
    buffer_load_dwordx4 a[140:143], v1, s[4:7], s33 offen
    s_add_u32 s33, s31, s65
    buffer_load_dwordx4 a[144:147], v1, s[4:7], s33 offen
    s_add_u32 s33, s31, s66
    buffer_load_dwordx4 a[148:151], v1, s[4:7], s33 offen
    s_add_u32 s33, s31, s67
    buffer_load_dwordx4 a[152:155], v1, s[4:7], s33 offen
    s_add_u32 s33, s31, s68
    buffer_load_dwordx4 a[156:159], v1, s[4:7], s33 offen
    s_add_u32 s33, s31, s69
    buffer_load_dwordx4 a[160:163], v1, s[4:7], s33 offen
    s_add_u32 s33, s31, s70
    buffer_load_dwordx4 a[164:167], v1, s[4:7], s33 offen
    s_lshr_b32 s31, s46, 1
    s_add_u32 s33, s31, s64
    buffer_load_dwordx4 a[168:171], v1, s[4:7], s33 offen
    s_add_u32 s33, s31, s65
    buffer_load_dwordx4 a[172:175], v1, s[4:7], s33 offen
    s_add_u32 s33, s31, s66
    buffer_load_dwordx4 a[176:179], v1, s[4:7], s33 offen
    s_add_u32 s33, s31, s67
    buffer_load_dwordx4 a[180:183], v1, s[4:7], s33 offen
    s_add_u32 s33, s31, s68
    buffer_load_dwordx4 a[184:187], v1, s[4:7], s33 offen
    s_add_u32 s33, s31, s69
    buffer_load_dwordx4 a[188:191], v1, s[4:7], s33 offen
    s_add_u32 s33, s31, s70
    buffer_load_dwordx4 a[192:195], v1, s[4:7], s33 offen
    s_lshr_b32 s31, s47, 1
    s_add_u32 s33, s31, s64
    buffer_load_dwordx4 a[196:199], v1, s[4:7], s33 offen
    s_add_u32 s33, s31, s65
    buffer_load_dwordx4 a[200:203], v1, s[4:7], s33 offen
    s_add_u32 s33, s31, s66
    buffer_load_dwordx4 a[204:207], v1, s[4:7], s33 offen
    s_add_u32 s33, s31, s67
    buffer_load_dwordx4 a[208:211], v1, s[4:7], s33 offen
    s_add_u32 s33, s31, s68
    buffer_load_dwordx4 a[212:215], v1, s[4:7], s33 offen
    s_add_u32 s33, s31, s69
    buffer_load_dwordx4 a[216:219], v1, s[4:7], s33 offen
    s_add_u32 s33, s31, s70
    buffer_load_dwordx4 a[220:223], v1, s[4:7], s33 offen
    s_lshr_b32 s31, s48, 1
    s_add_u32 s33, s31, s64
    buffer_load_dwordx4 a[224:227], v1, s[4:7], s33 offen
    s_add_u32 s33, s31, s65
    buffer_load_dwordx4 a[228:231], v1, s[4:7], s33 offen
    s_add_u32 s33, s31, s66
    buffer_load_dwordx4 a[232:235], v1, s[4:7], s33 offen
    s_add_u32 s33, s31, s67
    buffer_load_dwordx4 a[236:239], v1, s[4:7], s33 offen
    s_add_u32 s33, s31, s68
    buffer_load_dwordx4 a[240:243], v1, s[4:7], s33 offen
    s_add_u32 s33, s31, s69
    buffer_load_dwordx4 a[244:247], v1, s[4:7], s33 offen
    s_add_u32 s33, s31, s70
    buffer_load_dwordx4 a[248:251], v1, s[4:7], s33 offen
    s_lshr_b32 s31, s49, 1
    s_add_u32 s33, s31, s64
    buffer_load_dwordx4 a[252:255], v1, s[4:7], s33 offen
    s_add_u32 s33, s31, s65
    buffer_load_dwordx4 v[120:123], v1, s[4:7], s33 offen
    s_add_u32 s33, s31, s66
    buffer_load_dwordx4 v[124:127], v1, s[4:7], s33 offen
    s_add_u32 s33, s31, s67
    buffer_load_dwordx4 v[128:131], v1, s[4:7], s33 offen
    s_add_u32 s33, s31, s68
    buffer_load_dwordx4 v[132:135], v1, s[4:7], s33 offen
    s_add_u32 s33, s31, s69
    buffer_load_dwordx4 v[136:139], v1, s[4:7], s33 offen
    s_add_u32 s33, s31, s70
    buffer_load_dwordx4 v[140:143], v1, s[4:7], s33 offen
    s_lshr_b32 s31, s50, 1
    s_add_u32 s33, s31, s64
    buffer_load_dwordx4 v[144:147], v1, s[4:7], s33 offen
    s_add_u32 s33, s31, s65
    buffer_load_dwordx4 v[148:151], v1, s[4:7], s33 offen
    s_add_u32 s33, s31, s66
    buffer_load_dwordx4 v[152:155], v1, s[4:7], s33 offen
    s_add_u32 s33, s31, s67
    buffer_load_dwordx4 v[156:159], v1, s[4:7], s33 offen
    s_add_u32 s33, s31, s68
    buffer_load_dwordx4 v[160:163], v1, s[4:7], s33 offen
    s_add_u32 s33, s31, s69
    buffer_load_dwordx4 v[164:167], v1, s[4:7], s33 offen
    s_add_u32 s33, s31, s70
    buffer_load_dwordx4 v[168:171], v1, s[4:7], s33 offen
    s_lshr_b32 s31, s51, 1
    s_add_u32 s33, s31, s64
    buffer_load_dwordx4 v[172:175], v1, s[4:7], s33 offen
    s_add_u32 s33, s31, s65
    buffer_load_dwordx4 v[176:179], v1, s[4:7], s33 offen
    s_add_u32 s33, s31, s66
    buffer_load_dwordx4 v[180:183], v1, s[4:7], s33 offen
    s_add_u32 s33, s31, s67
    buffer_load_dwordx4 v[184:187], v1, s[4:7], s33 offen
    s_add_u32 s33, s31, s68
    buffer_load_dwordx4 v[188:191], v1, s[4:7], s33 offen
    s_add_u32 s33, s31, s69
    buffer_load_dwordx4 v[192:195], v1, s[4:7], s33 offen
    s_add_u32 s33, s31, s70
    buffer_load_dwordx4 v[196:199], v1, s[4:7], s33 offen
    s_lshr_b32 s31, s52, 1
    s_add_u32 s33, s31, s64
    buffer_load_dwordx4 v[200:203], v1, s[4:7], s33 offen
    s_add_u32 s33, s31, s65
    buffer_load_dwordx4 v[204:207], v1, s[4:7], s33 offen
    s_add_u32 s33, s31, s66
    buffer_load_dwordx4 v[208:211], v1, s[4:7], s33 offen
    s_add_u32 s33, s31, s67
    buffer_load_dwordx4 v[212:215], v1, s[4:7], s33 offen
    s_add_u32 s33, s31, s68
    buffer_load_dwordx4 v[216:219], v1, s[4:7], s33 offen
    s_add_u32 s33, s31, s69
    buffer_load_dwordx4 v[220:223], v1, s[4:7], s33 offen
    s_add_u32 s33, s31, s70
    buffer_load_dwordx4 v[224:227], v1, s[4:7], s33 offen
    s_lshr_b32 s31, s53, 1
    s_add_u32 s33, s31, s64
    buffer_load_dwordx4 v[228:231], v1, s[4:7], s33 offen
    s_add_u32 s33, s31, s65
    buffer_load_dwordx4 v[232:235], v1, s[4:7], s33 offen
    s_add_u32 s33, s31, s66
    buffer_load_dwordx4 v[236:239], v1, s[4:7], s33 offen
    s_add_u32 s33, s31, s67
    buffer_load_dwordx4 v[240:243], v1, s[4:7], s33 offen
    s_add_u32 s33, s31, s68
    buffer_load_dwordx4 v[244:247], v1, s[4:7], s33 offen
    s_add_u32 s33, s31, s69
    buffer_load_dwordx4 v[248:251], v1, s[4:7], s33 offen
    s_add_u32 s33, s31, s70
    buffer_load_dwordx4 v[252:255], v1, s[4:7], s33 offen
    s_mul_i32 s34, s16, 14336
    v_add_u32 v7, s34, v1
    s_lshl_b32 s34, s16, 10
    v_add_u32 v12, s34, v1
    v_lshlrev_b32 v13, 3, v0
F_loop:
    s_lshl_b32 s24, s21, 2
    s_add_u32 s24, s24, s16
    s_lshl_b32 s25, s24, 2
    s_add_u32 s25, s25, 69816320
    s_mul_i32 s23, s24, 28672
    s_add_u32 s23, s23, 49086464
    v_mov_b32 v6, 0
wf_31:
    buffer_load_dword v8, v6, s[4:7], s25 offen sc1
    s_waitcnt vmcnt(0)
    v_cmp_eq_u32 vcc, 0, v8
    s_cbranch_vccz wfd_32
    s_sub_u32 s18, s18, 1
    s_cbranch_scc1 main_end2
    s_sleep 2
    s_branch wf_31
wfd_32:
    s_add_u32 s33, s23, s40
    buffer_load_dwordx4 v[32:35], v2, s[4:7], s33 offen offset:0 sc1
    s_add_u32 s33, s23, s40
    buffer_load_dwordx4 v[36:39], v2, s[4:7], s33 offen offset:256 sc1
    s_add_u32 s33, s23, s41
    buffer_load_dwordx4 v[40:43], v2, s[4:7], s33 offen offset:0 sc1
    s_add_u32 s33, s23, s41
    buffer_load_dwordx4 v[44:47], v2, s[4:7], s33 offen offset:256 sc1
    s_add_u32 s33, s23, s42
    buffer_load_dwordx4 v[48:51], v2, s[4:7], s33 offen offset:0 sc1
    s_add_u32 s33, s23, s42
    buffer_load_dwordx4 v[52:55], v2, s[4:7], s33 offen offset:256 sc1
    s_add_u32 s33, s23, s43
    buffer_load_dwordx4 v[56:59], v2, s[4:7], s33 offen offset:0 sc1
    s_add_u32 s33, s23, s43
    buffer_load_dwordx4 v[60:63], v2, s[4:7], s33 offen offset:256 sc1
    s_waitcnt vmcnt(7)
    v_mfma_f32_16x16x32_bf16 v[64:67], a[0:3], v[32:35], 0
    v_mfma_f32_16x16x32_bf16 v[72:75], a[4:7], v[32:35], 0
    v_mfma_f32_16x16x32_bf16 v[80:83], a[8:11], v[32:35], 0
    v_mfma_f32_16x16x32_bf16 v[88:91], a[12:15], v[32:35], 0
    v_mfma_f32_16x16x32_bf16 v[96:99], a[16:19], v[32:35], 0
    v_mfma_f32_16x16x32_bf16 v[104:107], a[20:23], v[32:35], 0
    v_mfma_f32_16x16x32_bf16 v[112:115], a[24:27], v[32:35], 0
    s_add_u32 s33, s23, s44
    buffer_load_dwordx4 v[32:35], v2, s[4:7], s33 offen offset:0 sc1
    s_waitcnt vmcnt(7)
    v_mfma_f32_16x16x32_bf16 v[68:71], a[0:3], v[36:39], 0
    v_mfma_f32_16x16x32_bf16 v[76:79], a[4:7], v[36:39], 0
    v_mfma_f32_16x16x32_bf16 v[84:87], a[8:11], v[36:39], 0
    v_mfma_f32_16x16x32_bf16 v[92:95], a[12:15], v[36:39], 0
    v_mfma_f32_16x16x32_bf16 v[100:103], a[16:19], v[36:39], 0
    v_mfma_f32_16x16x32_bf16 v[108:111], a[20:23], v[36:39], 0
    v_mfma_f32_16x16x32_bf16 v[116:119], a[24:27], v[36:39], 0
    s_add_u32 s33, s23, s44
    buffer_load_dwordx4 v[36:39], v2, s[4:7], s33 offen offset:256 sc1
    s_waitcnt vmcnt(7)
    v_mfma_f32_16x16x32_bf16 v[64:67], a[28:31], v[40:43], v[64:67]
    v_mfma_f32_16x16x32_bf16 v[72:75], a[32:35], v[40:43], v[72:75]
    v_mfma_f32_16x16x32_bf16 v[80:83], a[36:39], v[40:43], v[80:83]
    v_mfma_f32_16x16x32_bf16 v[88:91], a[40:43], v[40:43], v[88:91]
    v_mfma_f32_16x16x32_bf16 v[96:99], a[44:47], v[40:43], v[96:99]
    v_mfma_f32_16x16x32_bf16 v[104:107], a[48:51], v[40:43], v[104:107]
    v_mfma_f32_16x16x32_bf16 v[112:115], a[52:55], v[40:43], v[112:115]
    s_add_u32 s33, s23, s45
    buffer_load_dwordx4 v[40:43], v2, s[4:7], s33 offen offset:0 sc1
    s_waitcnt vmcnt(7)
    v_mfma_f32_16x16x32_bf16 v[68:71], a[28:31], v[44:47], v[68:71]
    v_mfma_f32_16x16x32_bf16 v[76:79], a[32:35], v[44:47], v[76:79]
    v_mfma_f32_16x16x32_bf16 v[84:87], a[36:39], v[44:47], v[84:87]
    v_mfma_f32_16x16x32_bf16 v[92:95], a[40:43], v[44:47], v[92:95]
    v_mfma_f32_16x16x32_bf16 v[100:103], a[44:47], v[44:47], v[100:103]
    v_mfma_f32_16x16x32_bf16 v[108:111], a[48:51], v[44:47], v[108:111]
    v_mfma_f32_16x16x32_bf16 v[116:119], a[52:55], v[44:47], v[116:119]
    s_add_u32 s33, s23, s45
    buffer_load_dwordx4 v[44:47], v2, s[4:7], s33 offen offset:256 sc1
    s_waitcnt vmcnt(7)
    v_mfma_f32_16x16x32_bf16 v[64:67], a[56:59], v[48:51], v[64:67]
    v_mfma_f32_16x16x32_bf16 v[72:75], a[60:63], v[48:51], v[72:75]
    v_mfma_f32_16x16x32_bf16 v[80:83], a[64:67], v[48:51], v[80:83]
    v_mfma_f32_16x16x32_bf16 v[88:91], a[68:71], v[48:51], v[88:91]
    v_mfma_f32_16x16x32_bf16 v[96:99], a[72:75], v[48:51], v[96:99]
    v_mfma_f32_16x16x32_bf16 v[104:107], a[76:79], v[48:51], v[104:107]
    v_mfma_f32_16x16x32_bf16 v[112:115], a[80:83], v[48:51], v[112:115]
    s_add_u32 s33, s23, s46
    buffer_load_dwordx4 v[48:51], v2, s[4:7], s33 offen offset:0 sc1
    s_waitcnt vmcnt(7)
    v_mfma_f32_16x16x32_bf16 v[68:71], a[56:59], v[52:55], v[68:71]
    v_mfma_f32_16x16x32_bf16 v[76:79], a[60:63], v[52:55], v[76:79]
    v_mfma_f32_16x16x32_bf16 v[84:87], a[64:67], v[52:55], v[84:87]
    v_mfma_f32_16x16x32_bf16 v[92:95], a[68:71], v[52:55], v[92:95]
    v_mfma_f32_16x16x32_bf16 v[100:103], a[72:75], v[52:55], v[100:103]
    v_mfma_f32_16x16x32_bf16 v[108:111], a[76:79], v[52:55], v[108:111]
    v_mfma_f32_16x16x32_bf16 v[116:119], a[80:83], v[52:55], v[116:119]
    s_add_u32 s33, s23, s46
    buffer_load_dwordx4 v[52:55], v2, s[4:7], s33 offen offset:256 sc1
    s_waitcnt vmcnt(7)
    v_mfma_f32_16x16x32_bf16 v[64:67], a[84:87], v[56:59], v[64:67]
    v_mfma_f32_16x16x32_bf16 v[72:75], a[88:91], v[56:59], v[72:75]
    v_mfma_f32_16x16x32_bf16 v[80:83], a[92:95], v[56:59], v[80:83]
    v_mfma_f32_16x16x32_bf16 v[88:91], a[96:99], v[56:59], v[88:91]
    v_mfma_f32_16x16x32_bf16 v[96:99], a[100:103], v[56:59], v[96:99]
    v_mfma_f32_16x16x32_bf16 v[104:107], a[104:107], v[56:59], v[104:107]
    v_mfma_f32_16x16x32_bf16 v[112:115], a[108:111], v[56:59], v[112:115]
    s_add_u32 s33, s23, s47
    buffer_load_dwordx4 v[56:59], v2, s[4:7], s33 offen offset:0 sc1
    s_waitcnt vmcnt(7)
    v_mfma_f32_16x16x32_bf16 v[68:71], a[84:87], v[60:63], v[68:71]
    v_mfma_f32_16x16x32_bf16 v[76:79], a[88:91], v[60:63], v[76:79]
    v_mfma_f32_16x16x32_bf16 v[84:87], a[92:95], v[60:63], v[84:87]
    v_mfma_f32_16x16x32_bf16 v[92:95], a[96:99], v[60:63], v[92:95]
    v_mfma_f32_16x16x32_bf16 v[100:103], a[100:103], v[60:63], v[100:103]
    v_mfma_f32_16x16x32_bf16 v[108:111], a[104:107], v[60:63], v[108:111]
    v_mfma_f32_16x16x32_bf16 v[116:119], a[108:111], v[60:63], v[116:119]
    s_add_u32 s33, s23, s47
    buffer_load_dwordx4 v[60:63], v2, s[4:7], s33 offen offset:256 sc1
    s_waitcnt vmcnt(7)
    v_mfma_f32_16x16x32_bf16 v[64:67], a[112:115], v[32:35], v[64:67]
    v_mfma_f32_16x16x32_bf16 v[72:75], a[116:119], v[32:35], v[72:75]
    v_mfma_f32_16x16x32_bf16 v[80:83], a[120:123], v[32:35], v[80:83]
    v_mfma_f32_16x16x32_bf16 v[88:91], a[124:127], v[32:35], v[88:91]
    v_mfma_f32_16x16x32_bf16 v[96:99], a[128:131], v[32:35], v[96:99]
    v_mfma_f32_16x16x32_bf16 v[104:107], a[132:135], v[32:35], v[104:107]
    v_mfma_f32_16x16x32_bf16 v[112:115], a[136:139], v[32:35], v[112:115]
    s_add_u32 s33, s23, s48
    buffer_load_dwordx4 v[32:35], v2, s[4:7], s33 offen offset:0 sc1
    s_waitcnt vmcnt(7)
    v_mfma_f32_16x16x32_bf16 v[68:71], a[112:115], v[36:39], v[68:71]
    v_mfma_f32_16x16x32_bf16 v[76:79], a[116:119], v[36:39], v[76:79]
    v_mfma_f32_16x16x32_bf16 v[84:87], a[120:123], v[36:39], v[84:87]
    v_mfma_f32_16x16x32_bf16 v[92:95], a[124:127], v[36:39], v[92:95]
    v_mfma_f32_16x16x32_bf16 v[100:103], a[128:131], v[36:39], v[100:103]
    v_mfma_f32_16x16x32_bf16 v[108:111], a[132:135], v[36:39], v[108:111]
    v_mfma_f32_16x16x32_bf16 v[116:119], a[136:139], v[36:39], v[116:119]
    s_add_u32 s33, s23, s48
    buffer_load_dwordx4 v[36:39], v2, s[4:7], s33 offen offset:256 sc1
    s_waitcnt vmcnt(7)
    v_mfma_f32_16x16x32_bf16 v[64:67], a[140:143], v[40:43], v[64:67]
    v_mfma_f32_16x16x32_bf16 v[72:75], a[144:147], v[40:43], v[72:75]
    v_mfma_f32_16x16x32_bf16 v[80:83], a[148:151], v[40:43], v[80:83]
    v_mfma_f32_16x16x32_bf16 v[88:91], a[152:155], v[40:43], v[88:91]
    v_mfma_f32_16x16x32_bf16 v[96:99], a[156:159], v[40:43], v[96:99]
    v_mfma_f32_16x16x32_bf16 v[104:107], a[160:163], v[40:43], v[104:107]
    v_mfma_f32_16x16x32_bf16 v[112:115], a[164:167], v[40:43], v[112:115]
    s_add_u32 s33, s23, s49
    buffer_load_dwordx4 v[40:43], v2, s[4:7], s33 offen offset:0 sc1
    s_waitcnt vmcnt(7)
    v_mfma_f32_16x16x32_bf16 v[68:71], a[140:143], v[44:47], v[68:71]
    v_mfma_f32_16x16x32_bf16 v[76:79], a[144:147], v[44:47], v[76:79]
    v_mfma_f32_16x16x32_bf16 v[84:87], a[148:151], v[44:47], v[84:87]
    v_mfma_f32_16x16x32_bf16 v[92:95], a[152:155], v[44:47], v[92:95]
    v_mfma_f32_16x16x32_bf16 v[100:103], a[156:159], v[44:47], v[100:103]
    v_mfma_f32_16x16x32_bf16 v[108:111], a[160:163], v[44:47], v[108:111]
    v_mfma_f32_16x16x32_bf16 v[116:119], a[164:167], v[44:47], v[116:119]
    s_add_u32 s33, s23, s49
    buffer_load_dwordx4 v[44:47], v2, s[4:7], s33 offen offset:256 sc1
    s_waitcnt vmcnt(7)
    v_mfma_f32_16x16x32_bf16 v[64:67], a[168:171], v[48:51], v[64:67]
    v_mfma_f32_16x16x32_bf16 v[72:75], a[172:175], v[48:51], v[72:75]
    v_mfma_f32_16x16x32_bf16 v[80:83], a[176:179], v[48:51], v[80:83]
    v_mfma_f32_16x16x32_bf16 v[88:91], a[180:183], v[48:51], v[88:91]
    v_mfma_f32_16x16x32_bf16 v[96:99], a[184:187], v[48:51], v[96:99]
    v_mfma_f32_16x16x32_bf16 v[104:107], a[188:191], v[48:51], v[104:107]
    v_mfma_f32_16x16x32_bf16 v[112:115], a[192:195], v[48:51], v[112:115]
    s_add_u32 s33, s23, s50
    buffer_load_dwordx4 v[48:51], v2, s[4:7], s33 offen offset:0 sc1
    s_waitcnt vmcnt(7)
    v_mfma_f32_16x16x32_bf16 v[68:71], a[168:171], v[52:55], v[68:71]
    v_mfma_f32_16x16x32_bf16 v[76:79], a[172:175], v[52:55], v[76:79]
    v_mfma_f32_16x16x32_bf16 v[84:87], a[176:179], v[52:55], v[84:87]
    v_mfma_f32_16x16x32_bf16 v[92:95], a[180:183], v[52:55], v[92:95]
    v_mfma_f32_16x16x32_bf16 v[100:103], a[184:187], v[52:55], v[100:103]
    v_mfma_f32_16x16x32_bf16 v[108:111], a[188:191], v[52:55], v[108:111]
    v_mfma_f32_16x16x32_bf16 v[116:119], a[192:195], v[52:55], v[116:119]
    s_add_u32 s33, s23, s50
    buffer_load_dwordx4 v[52:55], v2, s[4:7], s33 offen offset:256 sc1
    s_waitcnt vmcnt(7)
    v_mfma_f32_16x16x32_bf16 v[64:67], a[196:199], v[56:59], v[64:67]
    v_mfma_f32_16x16x32_bf16 v[72:75], a[200:203], v[56:59], v[72:75]
    v_mfma_f32_16x16x32_bf16 v[80:83], a[204:207], v[56:59], v[80:83]
    v_mfma_f32_16x16x32_bf16 v[88:91], a[208:211], v[56:59], v[88:91]
    v_mfma_f32_16x16x32_bf16 v[96:99], a[212:215], v[56:59], v[96:99]
    v_mfma_f32_16x16x32_bf16 v[104:107], a[216:219], v[56:59], v[104:107]
    v_mfma_f32_16x16x32_bf16 v[112:115], a[220:223], v[56:59], v[112:115]
    s_add_u32 s33, s23, s51
    buffer_load_dwordx4 v[56:59], v2, s[4:7], s33 offen offset:0 sc1
    s_waitcnt vmcnt(7)
    v_mfma_f32_16x16x32_bf16 v[68:71], a[196:199], v[60:63], v[68:71]
    v_mfma_f32_16x16x32_bf16 v[76:79], a[200:203], v[60:63], v[76:79]
    v_mfma_f32_16x16x32_bf16 v[84:87], a[204:207], v[60:63], v[84:87]
    v_mfma_f32_16x16x32_bf16 v[92:95], a[208:211], v[60:63], v[92:95]
    v_mfma_f32_16x16x32_bf16 v[100:103], a[212:215], v[60:63], v[100:103]
    v_mfma_f32_16x16x32_bf16 v[108:111], a[216:219], v[60:63], v[108:111]
    v_mfma_f32_16x16x32_bf16 v[116:119], a[220:223], v[60:63], v[116:119]
    s_add_u32 s33, s23, s51
    buffer_load_dwordx4 v[60:63], v2, s[4:7], s33 offen offset:256 sc1
    s_waitcnt vmcnt(7)
    v_mfma_f32_16x16x32_bf16 v[64:67], a[224:227], v[32:35], v[64:67]
    v_mfma_f32_16x16x32_bf16 v[72:75], a[228:231], v[32:35], v[72:75]
    v_mfma_f32_16x16x32_bf16 v[80:83], a[232:235], v[32:35], v[80:83]
    v_mfma_f32_16x16x32_bf16 v[88:91], a[236:239], v[32:35], v[88:91]
    v_mfma_f32_16x16x32_bf16 v[96:99], a[240:243], v[32:35], v[96:99]
    v_mfma_f32_16x16x32_bf16 v[104:107], a[244:247], v[32:35], v[104:107]
    v_mfma_f32_16x16x32_bf16 v[112:115], a[248:251], v[32:35], v[112:115]
    s_add_u32 s33, s23, s52
    buffer_load_dwordx4 v[32:35], v2, s[4:7], s33 offen offset:0 sc1
    s_waitcnt vmcnt(7)
    v_mfma_f32_16x16x32_bf16 v[68:71], a[224:227], v[36:39], v[68:71]
    v_mfma_f32_16x16x32_bf16 v[76:79], a[228:231], v[36:39], v[76:79]
    v_mfma_f32_16x16x32_bf16 v[84:87], a[232:235], v[36:39], v[84:87]
    v_mfma_f32_16x16x32_bf16 v[92:95], a[236:239], v[36:39], v[92:95]
    v_mfma_f32_16x16x32_bf16 v[100:103], a[240:243], v[36:39], v[100:103]
    v_mfma_f32_16x16x32_bf16 v[108:111], a[244:247], v[36:39], v[108:111]
    v_mfma_f32_16x16x32_bf16 v[116:119], a[248:251], v[36:39], v[116:119]
    s_add_u32 s33, s23, s52
    buffer_load_dwordx4 v[36:39], v2, s[4:7], s33 offen offset:256 sc1
    s_waitcnt vmcnt(7)
    v_mfma_f32_16x16x32_bf16 v[64:67], a[252:255], v[40:43], v[64:67]
    v_mfma_f32_16x16x32_bf16 v[72:75], v[120:123], v[40:43], v[72:75]
    v_mfma_f32_16x16x32_bf16 v[80:83], v[124:127], v[40:43], v[80:83]
    v_mfma_f32_16x16x32_bf16 v[88:91], v[128:131], v[40:43], v[88:91]
    v_mfma_f32_16x16x32_bf16 v[96:99], v[132:135], v[40:43], v[96:99]
    v_mfma_f32_16x16x32_bf16 v[104:107], v[136:139], v[40:43], v[104:107]
    v_mfma_f32_16x16x32_bf16 v[112:115], v[140:143], v[40:43], v[112:115]
    s_add_u32 s33, s23, s53
    buffer_load_dwordx4 v[40:43], v2, s[4:7], s33 offen offset:0 sc1
    s_waitcnt vmcnt(7)
    v_mfma_f32_16x16x32_bf16 v[68:71], a[252:255], v[44:47], v[68:71]
    v_mfma_f32_16x16x32_bf16 v[76:79], v[120:123], v[44:47], v[76:79]
    v_mfma_f32_16x16x32_bf16 v[84:87], v[124:127], v[44:47], v[84:87]
    v_mfma_f32_16x16x32_bf16 v[92:95], v[128:131], v[44:47], v[92:95]
    v_mfma_f32_16x16x32_bf16 v[100:103], v[132:135], v[44:47], v[100:103]
    v_mfma_f32_16x16x32_bf16 v[108:111], v[136:139], v[44:47], v[108:111]
    v_mfma_f32_16x16x32_bf16 v[116:119], v[140:143], v[44:47], v[116:119]
    s_add_u32 s33, s23, s53
    buffer_load_dwordx4 v[44:47], v2, s[4:7], s33 offen offset:256 sc1
    s_waitcnt vmcnt(7)
    v_mfma_f32_16x16x32_bf16 v[64:67], v[144:147], v[48:51], v[64:67]
    v_mfma_f32_16x16x32_bf16 v[72:75], v[148:151], v[48:51], v[72:75]
    v_mfma_f32_16x16x32_bf16 v[80:83], v[152:155], v[48:51], v[80:83]
    v_mfma_f32_16x16x32_bf16 v[88:91], v[156:159], v[48:51], v[88:91]
    v_mfma_f32_16x16x32_bf16 v[96:99], v[160:163], v[48:51], v[96:99]
    v_mfma_f32_16x16x32_bf16 v[104:107], v[164:167], v[48:51], v[104:107]
    v_mfma_f32_16x16x32_bf16 v[112:115], v[168:171], v[48:51], v[112:115]
    s_waitcnt vmcnt(6)
    v_mfma_f32_16x16x32_bf16 v[68:71], v[144:147], v[52:55], v[68:71]
    v_mfma_f32_16x16x32_bf16 v[76:79], v[148:151], v[52:55], v[76:79]
    v_mfma_f32_16x16x32_bf16 v[84:87], v[152:155], v[52:55], v[84:87]
    v_mfma_f32_16x16x32_bf16 v[92:95], v[156:159], v[52:55], v[92:95]
    v_mfma_f32_16x16x32_bf16 v[100:103], v[160:163], v[52:55], v[100:103]
    v_mfma_f32_16x16x32_bf16 v[108:111], v[164:167], v[52:55], v[108:111]
    v_mfma_f32_16x16x32_bf16 v[116:119], v[168:171], v[52:55], v[116:119]
    s_waitcnt vmcnt(5)
    v_mfma_f32_16x16x32_bf16 v[64:67], v[172:175], v[56:59], v[64:67]
    v_mfma_f32_16x16x32_bf16 v[72:75], v[176:179], v[56:59], v[72:75]
    v_mfma_f32_16x16x32_bf16 v[80:83], v[180:183], v[56:59], v[80:83]
    v_mfma_f32_16x16x32_bf16 v[88:91], v[184:187], v[56:59], v[88:91]
    v_mfma_f32_16x16x32_bf16 v[96:99], v[188:191], v[56:59], v[96:99]
    v_mfma_f32_16x16x32_bf16 v[104:107], v[192:195], v[56:59], v[104:107]
    v_mfma_f32_16x16x32_bf16 v[112:115], v[196:199], v[56:59], v[112:115]
    s_waitcnt vmcnt(4)
    v_mfma_f32_16x16x32_bf16 v[68:71], v[172:175], v[60:63], v[68:71]
    v_mfma_f32_16x16x32_bf16 v[76:79], v[176:179], v[60:63], v[76:79]
    v_mfma_f32_16x16x32_bf16 v[84:87], v[180:183], v[60:63], v[84:87]
    v_mfma_f32_16x16x32_bf16 v[92:95], v[184:187], v[60:63], v[92:95]
    v_mfma_f32_16x16x32_bf16 v[100:103], v[188:191], v[60:63], v[100:103]
    v_mfma_f32_16x16x32_bf16 v[108:111], v[192:195], v[60:63], v[108:111]
    v_mfma_f32_16x16x32_bf16 v[116:119], v[196:199], v[60:63], v[116:119]
    s_waitcnt vmcnt(3)
    v_mfma_f32_16x16x32_bf16 v[64:67], v[200:203], v[32:35], v[64:67]
    v_mfma_f32_16x16x32_bf16 v[72:75], v[204:207], v[32:35], v[72:75]
    v_mfma_f32_16x16x32_bf16 v[80:83], v[208:211], v[32:35], v[80:83]
    v_mfma_f32_16x16x32_bf16 v[88:91], v[212:215], v[32:35], v[88:91]
    v_mfma_f32_16x16x32_bf16 v[96:99], v[216:219], v[32:35], v[96:99]
    v_mfma_f32_16x16x32_bf16 v[104:107], v[220:223], v[32:35], v[104:107]
    v_mfma_f32_16x16x32_bf16 v[112:115], v[224:227], v[32:35], v[112:115]
    s_waitcnt vmcnt(2)
    v_mfma_f32_16x16x32_bf16 v[68:71], v[200:203], v[36:39], v[68:71]
    v_mfma_f32_16x16x32_bf16 v[76:79], v[204:207], v[36:39], v[76:79]
    v_mfma_f32_16x16x32_bf16 v[84:87], v[208:211], v[36:39], v[84:87]
    v_mfma_f32_16x16x32_bf16 v[92:95], v[212:215], v[36:39], v[92:95]
    v_mfma_f32_16x16x32_bf16 v[100:103], v[216:219], v[36:39], v[100:103]
    v_mfma_f32_16x16x32_bf16 v[108:111], v[220:223], v[36:39], v[108:111]
    v_mfma_f32_16x16x32_bf16 v[116:119], v[224:227], v[36:39], v[116:119]
    s_waitcnt vmcnt(1)
    v_mfma_f32_16x16x32_bf16 v[64:67], v[228:231], v[40:43], v[64:67]
    v_mfma_f32_16x16x32_bf16 v[72:75], v[232:235], v[40:43], v[72:75]
    v_mfma_f32_16x16x32_bf16 v[80:83], v[236:239], v[40:43], v[80:83]
    v_mfma_f32_16x16x32_bf16 v[88:91], v[240:243], v[40:43], v[88:91]
    v_mfma_f32_16x16x32_bf16 v[96:99], v[244:247], v[40:43], v[96:99]
    v_mfma_f32_16x16x32_bf16 v[104:107], v[248:251], v[40:43], v[104:107]
    v_mfma_f32_16x16x32_bf16 v[112:115], v[252:255], v[40:43], v[112:115]
    s_waitcnt vmcnt(0)
    v_mfma_f32_16x16x32_bf16 v[68:71], v[228:231], v[44:47], v[68:71]
    v_mfma_f32_16x16x32_bf16 v[76:79], v[232:235], v[44:47], v[76:79]
    v_mfma_f32_16x16x32_bf16 v[84:87], v[236:239], v[44:47], v[84:87]
    v_mfma_f32_16x16x32_bf16 v[92:95], v[240:243], v[44:47], v[92:95]
    v_mfma_f32_16x16x32_bf16 v[100:103], v[244:247], v[44:47], v[100:103]
    v_mfma_f32_16x16x32_bf16 v[108:111], v[248:251], v[44:47], v[108:111]
    v_mfma_f32_16x16x32_bf16 v[116:119], v[252:255], v[44:47], v[116:119]
    ds_write_b128 v7, v[64:67] offset:0
    s_nop 0
    ds_write_b128 v7, v[68:71] offset:1024
    ds_write_b128 v7, v[72:75] offset:2048
    ds_write_b128 v7, v[76:79] offset:3072
    ds_write_b128 v7, v[80:83] offset:4096
    ds_write_b128 v7, v[84:87] offset:5120
    ds_write_b128 v7, v[88:91] offset:6144
    ds_write_b128 v7, v[92:95] offset:7168
    ds_write_b128 v7, v[96:99] offset:8192
    ds_write_b128 v7, v[100:103] offset:9216
    ds_write_b128 v7, v[104:107] offset:10240
    ds_write_b128 v7, v[108:111] offset:11264
    ds_write_b128 v7, v[112:115] offset:12288
    ds_write_b128 v7, v[116:119] offset:13312
    s_lshl_b32 s25, s21, 2
    s_add_u32 s25, s25, s22
    s_lshl_b32 s25, s25, 2
    s_add_u32 s25, s25, 69817344
    s_mul_i32 s24, s21, 28672
    s_add_u32 s24, s24, 56426496
    s_mul_i32 s33, s22, 7168
    s_add_u32 s24, s24, s33
    s_lshl_b32 s33, s16, 9
    s_add_u32 s24, s24, s33
    s_waitcnt lgkmcnt(0)
    s_barrier
    ds_read_b128 v[32:35], v12 offset:0
    ds_read_b128 v[36:39], v12 offset:14336
    ds_read_b128 v[40:43], v12 offset:28672
    ds_read_b128 v[44:47], v12 offset:43008
    s_waitcnt lgkmcnt(0)
    v_add_f32 v32, v32, v36
    v_add_f32 v40, v40, v44
    v_add_f32 v32, v32, v40
    v_add_f32 v33, v33, v37
    v_add_f32 v41, v41, v45
    v_add_f32 v33, v33, v41
    v_add_f32 v34, v34, v38
    v_add_f32 v42, v42, v46
    v_add_f32 v34, v34, v42
    v_add_f32 v35, v35, v39
    v_add_f32 v43, v43, v47
    v_add_f32 v35, v35, v43
    v_cvt_pk_bf16_f32 v48, v32, v33
    v_cvt_pk_bf16_f32 v49, v34, v35
    buffer_store_dwordx2 v[48:49], v13, s[4:7], s24 offen offset:0 sc1
    ds_read_b128 v[32:35], v12 offset:4096
    ds_read_b128 v[36:39], v12 offset:18432
    ds_read_b128 v[40:43], v12 offset:32768
    ds_read_b128 v[44:47], v12 offset:47104
    s_waitcnt lgkmcnt(0)
    v_add_f32 v32, v32, v36
    v_add_f32 v40, v40, v44
    v_add_f32 v32, v32, v40
    v_add_f32 v33, v33, v37
    v_add_f32 v41, v41, v45
    v_add_f32 v33, v33, v41
    v_add_f32 v34, v34, v38
    v_add_f32 v42, v42, v46
    v_add_f32 v34, v34, v42
    v_add_f32 v35, v35, v39
    v_add_f32 v43, v43, v47
    v_add_f32 v35, v35, v43
    v_cvt_pk_bf16_f32 v50, v32, v33
    v_cvt_pk_bf16_f32 v51, v34, v35
    buffer_store_dwordx2 v[50:51], v13, s[4:7], s24 offen offset:2048 sc1
    ds_read_b128 v[32:35], v12 offset:8192
    ds_read_b128 v[36:39], v12 offset:22528
    ds_read_b128 v[40:43], v12 offset:36864
    ds_read_b128 v[44:47], v12 offset:51200
    s_waitcnt lgkmcnt(0)
    v_add_f32 v32, v32, v36
    v_add_f32 v40, v40, v44
    v_add_f32 v32, v32, v40
    v_add_f32 v33, v33, v37
    v_add_f32 v41, v41, v45
    v_add_f32 v33, v33, v41
    v_add_f32 v34, v34, v38
    v_add_f32 v42, v42, v46
    v_add_f32 v34, v34, v42
    v_add_f32 v35, v35, v39
    v_add_f32 v43, v43, v47
    v_add_f32 v35, v35, v43
    v_cvt_pk_bf16_f32 v52, v32, v33
    v_cvt_pk_bf16_f32 v53, v34, v35
    s_add_u32 s24, s24, 4096
    buffer_store_dwordx2 v[52:53], v13, s[4:7], s24 offen offset:0 sc1
    s_cmp_lt_u32 s16, 2
    s_cbranch_scc0 F_skip
    ds_read_b128 v[32:35], v12 offset:12288
    ds_read_b128 v[36:39], v12 offset:26624
    ds_read_b128 v[40:43], v12 offset:40960
    ds_read_b128 v[44:47], v12 offset:55296
    s_waitcnt lgkmcnt(0)
    v_add_f32 v32, v32, v36
    v_add_f32 v40, v40, v44
    v_add_f32 v32, v32, v40
    v_add_f32 v33, v33, v37
    v_add_f32 v41, v41, v45
    v_add_f32 v33, v33, v41
    v_add_f32 v34, v34, v38
    v_add_f32 v42, v42, v46
    v_add_f32 v34, v34, v42
    v_add_f32 v35, v35, v39
    v_add_f32 v43, v43, v47
    v_add_f32 v35, v35, v43
    v_cvt_pk_bf16_f32 v54, v32, v33
    v_cvt_pk_bf16_f32 v55, v34, v35
    buffer_store_dwordx2 v[54:55], v13, s[4:7], s24 offen offset:2048 sc1
F_skip:
    s_waitcnt vmcnt(0)
    s_barrier
    s_cmp_eq_u32 s16, 0
    s_cbranch_scc0 noflag_33
    v_mov_b32 v5, 1
    v_mov_b32 v6, 0
    s_mov_b64 exec, 1
    buffer_store_dword v5, v6, s[4:7], s25 offen sc1
    s_mov_b64 exec, -1
noflag_33:
    s_add_u32 s21, s21, 4
    s_cmp_lt_u32 s21, 64
    s_cbranch_scc1 F_loop
    s_endpgm
role_O:
    s_cmp_lt_u32 s27, 14
    s_cselect_b32 s28, 0, 14
    s_cselect_b32 s21, 0, 1
    s_sub_u32 s22, s27, s28
    s_sub_u32 s26, s26, 6
    s_lshl_b32 s26, s26, 1
    s_add_u32 s21, s21, s26
    v_lshlrev_b32 v1, 4, v0
    v_lshrrev_b32 v3, 4, v0
    v_and_b32 v4, 15, v0
    v_and_b32 v2, 31, v0
    v_lshlrev_b32 v2, 4, v2
    s_and_b32 s28, s16, 1
    s_lshr_b32 s29, s16, 1
    s_lshl_b32 s30, s28, 4
    v_add_u32 v7, s30, v4
    v_mul_u32_u24 v7, 896, v7
    v_lshl_add_u32 v7, v3, 3, v7
    s_lshl_b32 s30, s22, 6
    s_lshl_b32 s31, s29, 5
    s_add_u32 s30, s30, s31
    v_add_u32 v7, s30, v7
    v_lshlrev_b32 v13, 3, v0
    s_lshl_b32 s30, s16, 12
    v_add_u32 v14, s30, v1
    s_lshl_b32 s30, s29, 1
    s_add_u32 s30, s30, s28
    s_lshl_b32 s30, s30, 10
    v_add_u32 v15, s30, v1
    s_lshr_b32 s30, s17, 5
    s_lshl_b32 s30, s30, 7
    s_add_u32 s30, s30, 69833728
    v_mov_b32 v9, s30
    s_cmp_eq_u32 s16, 0
    s_cbranch_scc0 wad_35
wa_34:
    buffer_load_dword v8, v9, s[4:7], 0 offen sc1
    s_waitcnt vmcnt(0)
    v_cmp_eq_u32 vcc, 0, v8
    s_cbranch_vccz wad_35
    s_sub_u32 s18, s18, 1
    s_cbranch_scc1 main_end2
    s_sleep 16
    s_branch wa_34
wad_35:
    s_waitcnt vmcnt(0)
    s_barrier
    v_mov_b32 v64, 0
    v_mov_b32 v65, 0
    v_mov_b32 v66, 0
    v_mov_b32 v67, 0
    v_mov_b32 v68, 0
    v_mov_b32 v69, 0
    v_mov_b32 v70, 0
    v_mov_b32 v71, 0
O_loop:
    s_lshl_b32 s24, s21, 6
    s_lshl_b32 s25, s16, 4
    s_add_u32 s24, s24, s25
    s_add_u32 s24, s24, 69812224
    v_mov_b32 v6, 0
wf_36:
    buffer_load_dwordx4 v[8:11], v6, s[4:7], s24 offen sc1
    s_waitcnt vmcnt(0)
    v_min3_u32 v8, v8, v9, v10
    v_min_u32 v8, v8, v11
    v_cmp_eq_u32 vcc, 0, v8
    s_cbranch_vccz wfd_37
    s_sub_u32 s18, s18, 1
    s_cbranch_scc1 main_end2
    s_sleep 8
    s_branch wf_36
wfd_37:
    s_lshl_b32 s24, s21, 4
    s_lshl_b32 s25, s16, 2
    s_add_u32 s24, s24, s25
    s_mul_i32 s24, s24, 28672
    s_lshl_b32 s25, s22, 11
    s_add_u32 s24, s24, s25
    s_add_u32 s24, s24, 19726336
    buffer_load_dwordx4 v[32:35], v1, s[4:7], s24 offen offset:0 sc1
    buffer_load_dwordx4 v[36:39], v1, s[4:7], s24 offen offset:1024 sc1
    s_add_u32 s24, s24, 28672
    buffer_load_dwordx4 v[40:43], v1, s[4:7], s24 offen offset:0 sc1
    buffer_load_dwordx4 v[44:47], v1, s[4:7], s24 offen offset:1024 sc1
    s_add_u32 s24, s24, 28672
    buffer_load_dwordx4 v[48:51], v1, s[4:7], s24 offen offset:0 sc1
    buffer_load_dwordx4 v[52:55], v1, s[4:7], s24 offen offset:1024 sc1
    s_add_u32 s24, s24, 28672
    buffer_load_dwordx4 v[56:59], v1, s[4:7], s24 offen offset:0 sc1
    buffer_load_dwordx4 v[60:63], v1, s[4:7], s24 offen offset:1024 sc1
    s_add_u32 s24, s24, 28672
    s_mul_i32 s34, s21, 28672
    buffer_load_dwordx2 v[16:17], v7, s[8:11], s34 offen
    s_lshl_b32 s24, s21, 4
    s_add_u32 s24, s24, 69817344
    v_mov_b32 v6, 0
wf_38:
    buffer_load_dwordx4 v[8:11], v6, s[4:7], s24 offen sc1
    s_waitcnt vmcnt(0)
    v_min3_u32 v8, v8, v9, v10
    v_min_u32 v8, v8, v11
    v_cmp_eq_u32 vcc, 0, v8
    s_cbranch_vccz wfd_39
    s_sub_u32 s18, s18, 1
    s_cbranch_scc1 main_end2
    s_sleep 8
    s_branch wf_38
wfd_39:
    s_lshl_b32 s24, s22, 1
    s_add_u32 s24, s24, s29
    s_lshl_b32 s24, s24, 1
    s_add_u32 s24, s24, s28
    s_lshl_b32 s24, s24, 9
    s_add_u32 s24, s24, s34
    s_add_u32 s24, s24, 56426496
    buffer_load_dwordx2 v[18:19], v13, s[4:7], s24 offen sc1
    s_mul_i32 s24, s21, 40960
    s_add_u32 s24, s24, 67174400
    s_lshl_b32 s25, s16, 11
    s_add_u32 s25, s25, s24
    s_add_u32 s25, s25, 32768
    s_lshl_b32 s33, s16, 13
    s_add_u32 s24, s24, s33
    s_add_u32 s35, s24, 4096
    s_mul_i32 s36, s21, 114688
    s_lshl_b32 s37, s22, 13
    s_add_u32 s36, s36, s37
    s_lshl_b32 s37, s16, 10
    s_add_u32 s36, s36, s37
    s_add_u32 s36, s36, 58261504
    s_add_u32 s37, s36, 4096
O_poll:
    buffer_load_dwordx4 v[80:83], v1, s[4:7], s24 offen offset:0 sc1
    buffer_load_dwordx4 v[84:87], v1, s[4:7], s24 offen offset:1024 sc1
    buffer_load_dwordx4 v[88:91], v1, s[4:7], s24 offen offset:2048 sc1
    buffer_load_dwordx4 v[92:95], v1, s[4:7], s24 offen offset:3072 sc1
    buffer_load_dwordx4 v[96:99], v1, s[4:7], s35 offen offset:0 sc1
    buffer_load_dwordx4 v[100:103], v1, s[4:7], s35 offen offset:1024 sc1
    buffer_load_dwordx4 v[104:107], v1, s[4:7], s35 offen offset:2048 sc1
    buffer_load_dwordx4 v[108:111], v1, s[4:7], s35 offen offset:3072 sc1
    buffer_load_dwordx4 v[112:115], v1, s[4:7], s25 offen offset:0 sc1
    buffer_load_dwordx4 v[116:119], v1, s[4:7], s25 offen offset:1024 sc1
    s_cmp_ge_u32 s21, 60
    s_cbranch_scc0 O_nog
    buffer_load_dwordx4 v[64:67], v1, s[4:7], s36 offen sc1
    buffer_load_dwordx4 v[68:71], v1, s[4:7], s37 offen sc1
O_nog:
    s_waitcnt vmcnt(0)
    v_max3_u32 v8, v80, v81, v82
    v_max3_u32 v8, v8, v83, v84
    v_max3_u32 v8, v8, v85, v86
    v_max3_u32 v8, v8, v87, v88
    v_max3_u32 v8, v8, v89, v90
    v_max3_u32 v8, v8, v91, v92
    v_max3_u32 v8, v8, v93, v94
    v_max3_u32 v8, v8, v95, v96
    v_max3_u32 v8, v8, v97, v98
    v_max3_u32 v8, v8, v99, v100
    v_max3_u32 v8, v8, v101, v102
    v_max3_u32 v8, v8, v103, v104
    v_max3_u32 v8, v8, v105, v106
    v_max3_u32 v8, v8, v107, v108
    v_max3_u32 v8, v8, v109, v110
    v_max3_u32 v8, v8, v111, v112
    v_max3_u32 v8, v8, v113, v114
    v_max3_u32 v8, v8, v115, v116
    v_max3_u32 v8, v8, v117, v118
    v_max3_u32 v8, v8, v119, v64
    v_max3_u32 v8, v8, v65, v66
    v_max3_u32 v8, v8, v67, v68
    v_max3_u32 v8, v8, v69, v70
    v_max_u32 v8, v8, v71
    v_cmp_eq_u32 vcc, -1, v8
    s_cbranch_vccz O_got
    s_sub_u32 s18, s18, 1
    s_cbranch_scc1 main_end2
    s_sleep 2
    s_branch O_poll
O_got:
    v_mfma_f32_16x16x32_bf16 v[128:131], v[32:35], v[80:83], 0
    v_mfma_f32_16x16x32_bf16 v[128:131], v[40:43], v[88:91], v[128:131]
    v_mfma_f32_16x16x32_bf16 v[128:131], v[48:51], v[96:99], v[128:131]
    v_mfma_f32_16x16x32_bf16 v[128:131], v[56:59], v[104:107], v[128:131]
    v_mfma_f32_16x16x32_bf16 v[132:135], v[32:35], v[84:87], 0
    v_mfma_f32_16x16x32_bf16 v[132:135], v[40:43], v[92:95], v[132:135]
    v_mfma_f32_16x16x32_bf16 v[132:135], v[48:51], v[100:103], v[132:135]
    v_mfma_f32_16x16x32_bf16 v[132:135], v[56:59], v[108:111], v[132:135]
    v_mfma_f32_16x16x32_bf16 v[136:139], v[36:39], v[80:83], 0
    v_mfma_f32_16x16x32_bf16 v[136:139], v[44:47], v[88:91], v[136:139]
    v_mfma_f32_16x16x32_bf16 v[136:139], v[52:55], v[96:99], v[136:139]
    v_mfma_f32_16x16x32_bf16 v[136:139], v[60:63], v[104:107], v[136:139]
    v_mfma_f32_16x16x32_bf16 v[140:143], v[36:39], v[84:87], 0
    v_mfma_f32_16x16x32_bf16 v[140:143], v[44:47], v[92:95], v[140:143]
    v_mfma_f32_16x16x32_bf16 v[140:143], v[52:55], v[100:103], v[140:143]
    v_mfma_f32_16x16x32_bf16 v[140:143], v[60:63], v[108:111], v[140:143]
    s_lshl_b32 s24, s21, 6
    s_lshl_b32 s25, s16, 4
    s_add_u32 s24, s24, s25
    s_add_u32 s24, s24, 69820416
    s_cmp_ge_u32 s21, 60
    s_cbranch_scc1 O_gok
    v_mov_b32 v6, 0
wf_40:
    buffer_load_dwordx4 v[8:11], v6, s[4:7], s24 offen sc1
    s_waitcnt vmcnt(0)
    v_min3_u32 v8, v8, v9, v10
    v_min_u32 v8, v8, v11
    v_cmp_eq_u32 vcc, 0, v8
    s_cbranch_vccz wfd_41
    s_sub_u32 s18, s18, 1
    s_cbranch_scc1 main_end2
    s_sleep 1
    s_branch wf_40
wfd_41:
    buffer_load_dwordx4 v[64:67], v1, s[4:7], s36 offen sc1
    buffer_load_dwordx4 v[68:71], v1, s[4:7], s37 offen sc1
    s_waitcnt vmcnt(0)
O_gok:
    v_mfma_f32_16x16x32_bf16 v[128:131], v[64:67], v[112:115], v[128:131]
    v_mfma_f32_16x16x32_bf16 v[132:135], v[64:67], v[116:119], v[132:135]
    v_mfma_f32_16x16x32_bf16 v[136:139], v[68:71], v[112:115], v[136:139]
    v_mfma_f32_16x16x32_bf16 v[140:143], v[68:71], v[116:119], v[140:143]
    s_nop 4
    ds_write_b128 v14, v[128:131] offset:0
    ds_write_b128 v14, v[132:135] offset:1024
    ds_write_b128 v14, v[136:139] offset:2048
    ds_write_b128 v14, v[140:143] offset:3072
    v_xor_b32 v14, 0x4000, v14
    s_waitcnt lgkmcnt(0)
    s_barrier
    ds_read_b128 v[32:35], v15 offset:0
    ds_read_b128 v[36:39], v15 offset:4096
    ds_read_b128 v[40:43], v15 offset:8192
    ds_read_b128 v[44:47], v15 offset:12288
    v_xor_b32 v15, 0x4000, v15
    s_mov_b32 s33, 0xffff0000
    v_lshlrev_b32 v20, 16, v16
    v_and_b32 v21, s33, v16
    v_lshlrev_b32 v22, 16, v17
    v_and_b32 v23, s33, v17
    v_lshlrev_b32 v24, 16, v18
    v_and_b32 v25, s33, v18
    v_lshlrev_b32 v26, 16, v19
    v_and_b32 v27, s33, v19
    v_add_f32 v20, v20, v24
    v_add_f32 v21, v21, v25
    v_add_f32 v22, v22, v26
    v_add_f32 v23, v23, v27
    s_waitcnt lgkmcnt(0)
    v_add_f32 v32, v32, v36
    v_add_f32 v40, v40, v44
    v_add_f32 v32, v32, v40
    v_add_f32 v20, v20, v32
    v_add_f32 v33, v33, v37
    v_add_f32 v41, v41, v45
    v_add_f32 v33, v33, v41
    v_add_f32 v21, v21, v33
    v_add_f32 v34, v34, v38
    v_add_f32 v42, v42, v46
    v_add_f32 v34, v34, v42
    v_add_f32 v22, v22, v34
    v_add_f32 v35, v35, v39
    v_add_f32 v43, v43, v47
    v_add_f32 v35, v35, v43
    v_add_f32 v23, v23, v35
    v_cvt_pk_bf16_f32 v28, v20, v21
    v_cvt_pk_bf16_f32 v29, v22, v23
    buffer_store_dwordx2 v[28:29], v7, s[12:15], s34 offen
    s_add_u32 s21, s21, 4
    s_cmp_lt_u32 s21, 64
    s_cbranch_scc1 O_loop
    s_endpgm
.section .rodata,"a"
.p2align 6
.amdhsa_kernel main_kernel
  .amdhsa_next_free_vgpr 512
  .amdhsa_next_free_sgpr 102
  .amdhsa_accum_offset 256
  .amdhsa_group_segment_fixed_size 0
  .amdhsa_kernarg_size 104
  .amdhsa_user_sgpr_count 2
  .amdhsa_user_sgpr_kernarg_segment_ptr 1
  .amdhsa_system_sgpr_workgroup_id_x 1
.end_amdhsa_kernel
```
